```python
import torch

def _softmax(x, axis=-1):
    return torch.softmax(x, dim=axis)

def _gelu(x):
    return torch.nn.functional.gelu(x, approximate='tanh')

def _silu(x):
    return torch.nn.functional.silu(x)

def _sigmoid(x):
    return torch.sigmoid(x)

def _layernorm(x, axis=-1, eps=1e-05):
    m = x.mean(dim=axis, keepdim=True)
    v = x.var(dim=axis, keepdim=True, unbiased=False)
    return (x - m) / torch.sqrt(v + eps)

def _scatter_add(tgt, idx, src, axis=0):
    return tgt.clone().index_add_(axis, idx, src)

def _segment_sum(src, seg, n):
    out = torch.zeros((n,) + src.shape[1:], dtype=src.dtype)
    return out.index_add_(0, seg, src)

def _pad(x, pw):
    flat = tuple((v for pair in reversed(pw) for v in pair))
    return torch.nn.functional.pad(x, flat)
kernel_name = 'adaLN_cond__grouped_kv_mqa__geglu_ffn__prompt'

def setup_inputs():

    _w = lambda a: (lambda t: t.to(torch.bfloat16) if t.is_floating_point() else t)(torch.as_tensor(a))

    def _A_setup():
        B, S, D, H = (1, 2048, 1024, 32)
        Dh = D // H
        return {'x': _w((lambda *s: torch.randn(*s, dtype=torch.bfloat16) * 0.05)(B, S, D)), 'wq': _w((lambda *s: torch.randn(*s, dtype=torch.bfloat16) * 0.05)(D, H * Dh)), 'wk': _w((lambda *s: torch.randn(*s, dtype=torch.bfloat16) * 0.05)(D, Dh)), 'wv': _w((lambda *s: torch.randn(*s, dtype=torch.bfloat16) * 0.05)(D, Dh)), 'wo': _w((lambda *s: torch.randn(*s, dtype=torch.bfloat16) * 0.05)(H * Dh, D))}
    _A_in = _A_setup()

    def _B_setup():
        B, S, D, F = (1, 2048, 1024, 3584)
        return {'x': _w((lambda *s: torch.randn(*s, dtype=torch.bfloat16) * 0.05)(B, S, D)), 'w_gate': _w((lambda *s: torch.randn(*s, dtype=torch.bfloat16) * 0.05)(D, F)), 'w_up': _w((lambda *s: torch.randn(*s, dtype=torch.bfloat16) * 0.05)(D, F)), 'w_down': _w((lambda *s: torch.randn(*s, dtype=torch.bfloat16) * 0.05)(F, D))}
    _B_in = _B_setup()
    return {'A_x': _A_in['x'], 'A_wq': _A_in['wq'], 'A_wk': _A_in['wk'], 'A_wv': _A_in['wv'], 'A_wo': _A_in['wo'], 'B_x': _B_in['x'], 'B_w_gate': _B_in['w_gate'], 'B_w_up': _B_in['w_up'], 'B_w_down': _B_in['w_down'], 'c': _w((lambda *s: torch.randn(*s, dtype=torch.bfloat16) * 0.1)(1, 1024) * 8.0), 'w_mod': _w((lambda *s: torch.randn(*s, dtype=torch.bfloat16) * 0.1)(1024, 6 * 1024) * 1024 ** (-0.5) * 8.0)}

def reference(A_x, A_wq, A_wk, A_wv, A_wo, B_x, B_w_gate, B_w_up, B_w_down, c, w_mod):

    def _A_ref(x, wq, wk, wv, wo):
        B, S, D = x.shape
        H = 32
        Dh = D // H
        q = (lambda x, *d: x.permute(*d))((x @ wq).reshape(B, S, H, Dh), 0, 2, 1, 3)
        k = x @ wk
        v = x @ wv
        scores = torch.einsum('bhqd,bkd->bhqk', q, k) * Dh ** (-0.5)
        p = _softmax(scores, axis=-1)
        o = torch.einsum('bhqk,bkd->bhqd', p, v)
        return (lambda x, *d: x.permute(*d))(o, 0, 2, 1, 3).reshape(B, S, H * Dh) @ wo

    def _B_ref(x, w_gate, w_up, w_down):
        return _gelu(x @ w_gate) * (x @ w_up) @ w_down
    x = A_x
    mod = (_silu(c) @ w_mod).reshape(c.shape[0], 6, 1, -1)
    sa, ca, ga, sb, cb, gb = (mod[:, 0].clone(), mod[:, 1].clone(), mod[:, 2].clone(), mod[:, 3].clone(), mod[:, 4].clone(), mod[:, 5].clone())
    h = _layernorm(x, axis=-1) * (1 + ca) + sa
    x = x + ga * _A_ref(h, A_wq, A_wk, A_wv, A_wo)
    h = _layernorm(x, axis=-1) * (1 + cb) + sb
    x = x + gb * _B_ref(h, B_w_gate, B_w_up, B_w_down)
    return x
```

```asm
; @launch kernel=prep_kernel grid=(460,1,1) block=(256,1,1) lds=32768
; @launch kernel=qkv_kernel grid=(256,1,1) block=(256,1,1) lds=147456
; @launch kernel=attn_kernel grid=(256,1,1) block=(704,1,1) lds=147584
; @launch kernel=ffn_kernel grid=(256,1,1) block=(512,1,1) lds=157760
.amdgcn_target "amdgcn-amd-amdhsa--gfx950"
.text
.globl prep_kernel
.p2align 8
.type prep_kernel,@function
prep_kernel:
    s_load_dwordx16 s[16:31], s[0:1], 0
    s_load_dwordx8 s[32:39], s[0:1], 64
    s_load_dwordx4 s[40:43], s[0:1], 96
    v_and_b32 v1, 63, v0
    v_lshrrev_b32 v2, 6, v0
    s_nop 0
    v_readfirstlane_b32 s3, v2
    s_nop 0
    s_lshl_b32 s4, s3, 13
    s_cmp_ge_u32 s2, 8
    s_cbranch_scc1 prep_nocpf
    s_cmp_ge_u32 s2, 3
    s_cbranch_scc1 prep_noflag
    s_lshl_b32 s5, s2, 16
    s_add_u32 s5, s5, 81723392
    s_cmp_eq_u32 s2, 0
    s_cselect_b32 s5, 655360, s5
    s_cselect_b32 s6, 6, 8
    v_lshlrev_b32 v2, s6, v0
    v_mov_b32 v3, 0
    s_waitcnt lgkmcnt(0)
    s_add_u32 s44, s42, s5
    s_addc_u32 s45, s43, 0
    global_store_dword v2, v3, s[44:45] sc1
prep_noflag:
    s_getpc_b64 s[6:7]
prep_kernel_pc1:
    s_add_u32 s6, s6, qkv_kernel-prep_kernel_pc1
    s_addc_u32 s7, s7, (qkv_kernel-prep_kernel_pc1)>>32
    v_lshlrev_b32 v2, 7, v0
    v_min_u32 v3, code_end-qkv_kernel-4, v2
    global_load_dword v4, v3, s[6:7]
    v_add_u32 v2, 32768, v2
    v_min_u32 v3, code_end-qkv_kernel-4, v2
    global_load_dword v4, v3, s[6:7]
    v_add_u32 v2, 32768, v2
    s_endpgm
prep_nocpf:
    s_sub_u32 s2, s2, 8
    s_cmp_ge_u32 s2, 452
    s_cbranch_scc1 prep_end
    s_cmp_ge_u32 s2, 384
    s_cbranch_scc1 prep_repack
    s_cmp_ge_u32 s2, 256
    s_cbranch_scc1 prep_stats
    s_cmp_ge_u32 s2, 128
    s_cselect_b32 s5, 64, 0
    s_add_u32 s5, s5, s2
    s_lshr_b32 s44, s5, 2
    s_and_b32 s45, s5, 3
    s_lshl_b32 s46, s45, 8
    s_lshl_b32 s47, s3, 6
    s_add_u32 s46, s46, s47
    s_mul_i32 s47, s46, 12288
    s_lshl_b32 s48, s44, 7
    s_add_u32 s47, s47, s48
    v_lshrrev_b32 v12, 3, v1
    v_mul_u32_u24 v12, 12288, v12
    v_lshrrev_b32 v13, 3, v1
    v_and_b32 v13, 2, v13
    v_xor_b32 v13, v13, v1
    v_and_b32 v13, 7, v13
    v_lshlrev_b32 v13, 4, v13
    v_add_u32 v4, v12, v13
    v_xor_b32 v13, 64, v13
    v_add_u32 v5, v12, v13
    v_add_u32 v5, 98304, v5
    v_add_u32 v6, 196608, v4
    v_add_u32 v7, 196608, v5
    v_lshrrev_b32 v12, 4, v1
    v_lshlrev_b32 v12, 4, v12
    s_lshl_b32 s48, s46, 1
    v_add_u32 v12, s48, v12
    v_mov_b32 v15, v12
    s_waitcnt lgkmcnt(0)
    global_load_dwordx4 v[16:19], v12, s[34:35]
    global_load_dwordx4 v[20:23], v12, s[34:35] offset:64
    s_add_u32 s50, s36, s47
    s_addc_u32 s51, s37, 0
    s_add_u32 s52, s50, 393216
    s_addc_u32 s53, s51, 0
    s_add_u32 m0, s4, 0
    s_nop 0
    global_load_lds_dwordx4 v4, s[50:51]
    s_add_u32 m0, s4, 1024
    s_nop 0
    global_load_lds_dwordx4 v5, s[50:51]
    s_add_u32 m0, s4, 2048
    s_nop 0
    global_load_lds_dwordx4 v6, s[50:51]
    s_add_u32 m0, s4, 3072
    s_nop 0
    global_load_lds_dwordx4 v7, s[50:51]
    s_add_u32 m0, s4, 4096
    s_nop 0
    global_load_lds_dwordx4 v4, s[52:53]
    s_add_u32 m0, s4, 5120
    s_nop 0
    global_load_lds_dwordx4 v5, s[52:53]
    s_add_u32 m0, s4, 6144
    s_nop 0
    global_load_lds_dwordx4 v6, s[52:53]
    s_add_u32 m0, s4, 7168
    s_nop 0
    global_load_lds_dwordx4 v7, s[52:53]
    v_lshrrev_b32 v12, 4, v1
    v_bfe_u32 v13, v1, 2, 2
    v_lshlrev_b32 v14, 3, v12
    v_add_u32 v14, v14, v13
    v_lshlrev_b32 v14, 7, v14
    v_add_u32 v14, s4, v14
    v_lshrrev_b32 v13, 1, v13
    v_and_b32 v12, 1, v12
    v_lshl_or_b32 v12, v12, 1, v13
    v_lshlrev_b32 v12, 5, v12
    v_and_b32 v13, 3, v1
    v_lshl_add_u32 v14, v13, 3, v14
    v_xor_b32 v13, 0, v12
    v_add_u32 v8, v14, v13
    v_xor_b32 v13, 32, v12
    v_add_u32 v9, v14, v13
    v_xor_b32 v13, 64, v12
    v_add_u32 v10, v14, v13
    v_xor_b32 v13, 96, v12
    v_add_u32 v11, v14, v13
    s_waitcnt vmcnt(8)
    v_lshlrev_b32 v32, 16, v16
    v_and_b32 v33, 0xffff0000, v16
    v_lshlrev_b32 v34, 16, v17
    v_and_b32 v35, 0xffff0000, v17
    v_lshlrev_b32 v36, 16, v18
    v_and_b32 v37, 0xffff0000, v18
    v_lshlrev_b32 v38, 16, v19
    v_and_b32 v39, 0xffff0000, v19
    v_mul_f32 v40, 0xbfb8aa3b, v32
    v_mul_f32 v41, 0xbfb8aa3b, v33
    v_mul_f32 v42, 0xbfb8aa3b, v34
    v_mul_f32 v43, 0xbfb8aa3b, v35
    v_mul_f32 v44, 0xbfb8aa3b, v36
    v_mul_f32 v45, 0xbfb8aa3b, v37
    v_mul_f32 v46, 0xbfb8aa3b, v38
    v_mul_f32 v47, 0xbfb8aa3b, v39
    v_exp_f32 v40, v40
    v_exp_f32 v41, v41
    v_exp_f32 v42, v42
    v_exp_f32 v43, v43
    v_exp_f32 v44, v44
    v_exp_f32 v45, v45
    v_exp_f32 v46, v46
    v_exp_f32 v47, v47
    v_add_f32 v40, 1.0, v40
    v_add_f32 v41, 1.0, v41
    v_add_f32 v42, 1.0, v42
    v_add_f32 v43, 1.0, v43
    v_add_f32 v44, 1.0, v44
    v_add_f32 v45, 1.0, v45
    v_add_f32 v46, 1.0, v46
    v_add_f32 v47, 1.0, v47
    v_rcp_f32 v40, v40
    v_rcp_f32 v41, v41
    v_rcp_f32 v42, v42
    v_rcp_f32 v43, v43
    v_rcp_f32 v44, v44
    v_rcp_f32 v45, v45
    v_rcp_f32 v46, v46
    v_rcp_f32 v47, v47
    v_mul_f32 v32, v32, v40
    v_mul_f32 v33, v33, v41
    v_mul_f32 v34, v34, v42
    v_mul_f32 v35, v35, v43
    v_mul_f32 v36, v36, v44
    v_mul_f32 v37, v37, v45
    v_mul_f32 v38, v38, v46
    v_mul_f32 v39, v39, v47
    v_cvt_pk_bf16_f32 v24, v32, v33
    v_cvt_pk_bf16_f32 v25, v34, v35
    v_cvt_pk_bf16_f32 v26, v36, v37
    v_cvt_pk_bf16_f32 v27, v38, v39
    v_lshlrev_b32 v32, 16, v20
    v_and_b32 v33, 0xffff0000, v20
    v_lshlrev_b32 v34, 16, v21
    v_and_b32 v35, 0xffff0000, v21
    v_lshlrev_b32 v36, 16, v22
    v_and_b32 v37, 0xffff0000, v22
    v_lshlrev_b32 v38, 16, v23
    v_and_b32 v39, 0xffff0000, v23
    v_mul_f32 v40, 0xbfb8aa3b, v32
    v_mul_f32 v41, 0xbfb8aa3b, v33
    v_mul_f32 v42, 0xbfb8aa3b, v34
    v_mul_f32 v43, 0xbfb8aa3b, v35
    v_mul_f32 v44, 0xbfb8aa3b, v36
    v_mul_f32 v45, 0xbfb8aa3b, v37
    v_mul_f32 v46, 0xbfb8aa3b, v38
    v_mul_f32 v47, 0xbfb8aa3b, v39
    v_exp_f32 v40, v40
    v_exp_f32 v41, v41
    v_exp_f32 v42, v42
    v_exp_f32 v43, v43
    v_exp_f32 v44, v44
    v_exp_f32 v45, v45
    v_exp_f32 v46, v46
    v_exp_f32 v47, v47
    v_add_f32 v40, 1.0, v40
    v_add_f32 v41, 1.0, v41
    v_add_f32 v42, 1.0, v42
    v_add_f32 v43, 1.0, v43
    v_add_f32 v44, 1.0, v44
    v_add_f32 v45, 1.0, v45
    v_add_f32 v46, 1.0, v46
    v_add_f32 v47, 1.0, v47
    v_rcp_f32 v40, v40
    v_rcp_f32 v41, v41
    v_rcp_f32 v42, v42
    v_rcp_f32 v43, v43
    v_rcp_f32 v44, v44
    v_rcp_f32 v45, v45
    v_rcp_f32 v46, v46
    v_rcp_f32 v47, v47
    v_mul_f32 v32, v32, v40
    v_mul_f32 v33, v33, v41
    v_mul_f32 v34, v34, v42
    v_mul_f32 v35, v35, v43
    v_mul_f32 v36, v36, v44
    v_mul_f32 v37, v37, v45
    v_mul_f32 v38, v38, v46
    v_mul_f32 v39, v39, v47
    v_cvt_pk_bf16_f32 v28, v32, v33
    v_cvt_pk_bf16_f32 v29, v34, v35
    v_cvt_pk_bf16_f32 v30, v36, v37
    v_cvt_pk_bf16_f32 v31, v38, v39
    s_cmp_lg_u32 s44, 0
    s_cbranch_scc1 prep_nosilu
    s_add_u32 s54, s42, 126976
    s_addc_u32 s55, s43, 0
    global_store_dwordx4 v15, v[24:27], s[54:55] sc1
    global_store_dwordx4 v15, v[28:31], s[54:55] offset:64 sc1
prep_nosilu:
    s_waitcnt vmcnt(0)
    ds_read_b64_tr_b16 v[32:33], v8 offset:0
    ds_read_b64_tr_b16 v[34:35], v8 offset:512
    ds_read_b64_tr_b16 v[36:37], v9 offset:0
    ds_read_b64_tr_b16 v[38:39], v9 offset:512
    ds_read_b64_tr_b16 v[40:41], v10 offset:0
    ds_read_b64_tr_b16 v[42:43], v10 offset:512
    ds_read_b64_tr_b16 v[44:45], v11 offset:0
    ds_read_b64_tr_b16 v[46:47], v11 offset:512
    ds_read_b64_tr_b16 v[48:49], v8 offset:4096
    ds_read_b64_tr_b16 v[50:51], v8 offset:4608
    ds_read_b64_tr_b16 v[52:53], v9 offset:4096
    ds_read_b64_tr_b16 v[54:55], v9 offset:4608
    ds_read_b64_tr_b16 v[56:57], v10 offset:4096
    ds_read_b64_tr_b16 v[58:59], v10 offset:4608
    ds_read_b64_tr_b16 v[60:61], v11 offset:4096
    ds_read_b64_tr_b16 v[62:63], v11 offset:4608
    s_waitcnt lgkmcnt(0)
    v_mfma_f32_16x16x32_bf16 v[64:67], v[32:35], v[24:27], 0
    v_mfma_f32_16x16x32_bf16 v[68:71], v[36:39], v[24:27], 0
    v_mfma_f32_16x16x32_bf16 v[72:75], v[40:43], v[24:27], 0
    v_mfma_f32_16x16x32_bf16 v[76:79], v[44:47], v[24:27], 0
    v_mfma_f32_16x16x32_bf16 v[64:67], v[48:51], v[28:31], v[64:67]
    v_mfma_f32_16x16x32_bf16 v[68:71], v[52:55], v[28:31], v[68:71]
    v_mfma_f32_16x16x32_bf16 v[72:75], v[56:59], v[28:31], v[72:75]
    v_mfma_f32_16x16x32_bf16 v[76:79], v[60:63], v[28:31], v[76:79]
    v_lshrrev_b32 v12, 4, v1
    v_lshlrev_b32 v12, 4, v12
    v_add_u32 v12, s4, v12
    s_nop 1
    ds_write_b128 v12, v[64:67] offset:0
    ds_write_b128 v12, v[68:71] offset:64
    ds_write_b128 v12, v[72:75] offset:128
    ds_write_b128 v12, v[76:79] offset:192
    s_waitcnt lgkmcnt(0)
    s_barrier
    s_cmp_lg_u32 s3, 0
    s_cbranch_scc1 prep_end
    v_lshlrev_b32 v12, 2, v1
    ds_read_b32 v16, v12 offset:0
    ds_read_b32 v17, v12 offset:8192
    ds_read_b32 v18, v12 offset:16384
    ds_read_b32 v19, v12 offset:24576
    s_mul_i32 s45, s45, 24576
    s_lshl_b32 s44, s44, 8
    s_add_u32 s44, s44, s45
    s_add_u32 s44, s44, 0
    s_add_u32 s50, s42, s44
    s_addc_u32 s51, s43, 0
    s_waitcnt lgkmcnt(0)
    v_add_f32 v16, v16, v17
    v_add_f32 v18, v18, v19
    v_add_f32 v16, v16, v18
    global_store_dword v12, v16, s[50:51] sc1
    s_endpgm
prep_stats:
    s_sub_u32 s5, s2, 256
    s_and_b32 s6, s5, 7
    s_lshl_b32 s6, s6, 4
    s_lshr_b32 s5, s5, 3
    s_add_u32 s5, s5, s6
    s_lshl_b32 s5, s5, 4
    s_lshl_b32 s6, s3, 2
    s_add_u32 s5, s5, s6
    s_lshl_b32 s6, s5, 11
    v_lshlrev_b32 v2, 4, v1
    v_add_u32 v3, 0x1000, v2
    s_waitcnt lgkmcnt(0)
    s_add_u32 s44, s16, s6
    s_addc_u32 s45, s17, 0
    global_load_dwordx4 v[4:7], v2, s[44:45] offset:0
    global_load_dwordx4 v[8:11], v2, s[44:45] offset:1024
    global_load_dwordx4 v[12:15], v2, s[44:45] offset:2048
    global_load_dwordx4 v[16:19], v2, s[44:45] offset:3072
    global_load_dwordx4 v[20:23], v3, s[44:45] offset:0
    global_load_dwordx4 v[24:27], v3, s[44:45] offset:1024
    global_load_dwordx4 v[28:31], v3, s[44:45] offset:2048
    global_load_dwordx4 v[32:35], v3, s[44:45] offset:3072
    s_lshl_b32 s6, s5, 3
    s_add_u32 s6, s6, 131072
    s_add_u32 s46, s42, s6
    s_addc_u32 s47, s43, 0
    s_waitcnt vmcnt(4)
    v_lshlrev_b32 v36, 16, v4
    v_and_b32 v37, 0xffff0000, v4
    v_lshlrev_b32 v38, 16, v5
    v_and_b32 v39, 0xffff0000, v5
    v_lshlrev_b32 v40, 16, v6
    v_and_b32 v41, 0xffff0000, v6
    v_lshlrev_b32 v42, 16, v7
    v_and_b32 v43, 0xffff0000, v7
    v_lshlrev_b32 v44, 16, v8
    v_and_b32 v45, 0xffff0000, v8
    v_lshlrev_b32 v46, 16, v9
    v_and_b32 v47, 0xffff0000, v9
    v_lshlrev_b32 v48, 16, v10
    v_and_b32 v49, 0xffff0000, v10
    v_lshlrev_b32 v50, 16, v11
    v_and_b32 v51, 0xffff0000, v11
    v_lshlrev_b32 v52, 16, v12
    v_and_b32 v53, 0xffff0000, v12
    v_lshlrev_b32 v54, 16, v13
    v_and_b32 v55, 0xffff0000, v13
    v_lshlrev_b32 v56, 16, v14
    v_and_b32 v57, 0xffff0000, v14
    v_lshlrev_b32 v58, 16, v15
    v_and_b32 v59, 0xffff0000, v15
    v_lshlrev_b32 v60, 16, v16
    v_and_b32 v61, 0xffff0000, v16
    v_lshlrev_b32 v62, 16, v17
    v_and_b32 v63, 0xffff0000, v17
    v_lshlrev_b32 v64, 16, v18
    v_and_b32 v65, 0xffff0000, v18
    v_lshlrev_b32 v66, 16, v19
    v_and_b32 v67, 0xffff0000, v19
    v_add_f32 v70, v36, v37
    v_add_f32 v71, v52, v53
    v_add_f32 v70, v70, v38
    v_add_f32 v71, v71, v54
    v_add_f32 v70, v70, v39
    v_add_f32 v71, v71, v55
    v_add_f32 v70, v70, v40
    v_add_f32 v71, v71, v56
    v_add_f32 v70, v70, v41
    v_add_f32 v71, v71, v57
    v_add_f32 v70, v70, v42
    v_add_f32 v71, v71, v58
    v_add_f32 v70, v70, v43
    v_add_f32 v71, v71, v59
    v_add_f32 v70, v70, v44
    v_add_f32 v71, v71, v60
    v_add_f32 v70, v70, v45
    v_add_f32 v71, v71, v61
    v_add_f32 v70, v70, v46
    v_add_f32 v71, v71, v62
    v_add_f32 v70, v70, v47
    v_add_f32 v71, v71, v63
    v_add_f32 v70, v70, v48
    v_add_f32 v71, v71, v64
    v_add_f32 v70, v70, v49
    v_add_f32 v71, v71, v65
    v_add_f32 v70, v70, v50
    v_add_f32 v71, v71, v66
    v_add_f32 v70, v70, v51
    v_add_f32 v71, v71, v67
    s_nop 0
    v_add_f32 v70, v70, v70 quad_perm:[1,0,3,2] row_mask:0xf bank_mask:0xf
    v_add_f32 v71, v71, v71 quad_perm:[1,0,3,2] row_mask:0xf bank_mask:0xf
    s_nop 0
    v_add_f32 v70, v70, v70 quad_perm:[2,3,0,1] row_mask:0xf bank_mask:0xf
    v_add_f32 v71, v71, v71 quad_perm:[2,3,0,1] row_mask:0xf bank_mask:0xf
    s_nop 0
    v_add_f32 v70, v70, v70 row_half_mirror row_mask:0xf bank_mask:0xf
    v_add_f32 v71, v71, v71 row_half_mirror row_mask:0xf bank_mask:0xf
    s_nop 0
    v_add_f32 v70, v70, v70 row_mirror row_mask:0xf bank_mask:0xf
    v_add_f32 v71, v71, v71 row_mirror row_mask:0xf bank_mask:0xf
    v_mov_b32 v72, v70
    v_mov_b32 v73, v71
    s_nop 0
    v_permlane16_swap_b32 v70, v72
    v_permlane16_swap_b32 v71, v73
    v_add_f32 v70, v70, v72
    v_add_f32 v71, v71, v73
    v_mov_b32 v72, v70
    v_mov_b32 v73, v71
    s_nop 0
    v_permlane32_swap_b32 v70, v72
    v_permlane32_swap_b32 v71, v73
    v_add_f32 v70, v70, v72
    v_add_f32 v71, v71, v73
    v_mul_f32 v70, 0x3a800000, v70
    v_mul_f32 v71, 0x3a800000, v71
    v_sub_f32 v36, v36, v70
    v_sub_f32 v52, v52, v71
    v_sub_f32 v37, v37, v70
    v_sub_f32 v53, v53, v71
    v_sub_f32 v38, v38, v70
    v_sub_f32 v54, v54, v71
    v_sub_f32 v39, v39, v70
    v_sub_f32 v55, v55, v71
    v_sub_f32 v40, v40, v70
    v_sub_f32 v56, v56, v71
    v_sub_f32 v41, v41, v70
    v_sub_f32 v57, v57, v71
    v_sub_f32 v42, v42, v70
    v_sub_f32 v58, v58, v71
    v_sub_f32 v43, v43, v70
    v_sub_f32 v59, v59, v71
    v_sub_f32 v44, v44, v70
    v_sub_f32 v60, v60, v71
    v_sub_f32 v45, v45, v70
    v_sub_f32 v61, v61, v71
    v_sub_f32 v46, v46, v70
    v_sub_f32 v62, v62, v71
    v_sub_f32 v47, v47, v70
    v_sub_f32 v63, v63, v71
    v_sub_f32 v48, v48, v70
    v_sub_f32 v64, v64, v71
    v_sub_f32 v49, v49, v70
    v_sub_f32 v65, v65, v71
    v_sub_f32 v50, v50, v70
    v_sub_f32 v66, v66, v71
    v_sub_f32 v51, v51, v70
    v_sub_f32 v67, v67, v71
    v_mul_f32 v74, v36, v36
    v_mul_f32 v75, v52, v52
    v_fmac_f32 v74, v37, v37
    v_fmac_f32 v75, v53, v53
    v_fmac_f32 v74, v38, v38
    v_fmac_f32 v75, v54, v54
    v_fmac_f32 v74, v39, v39
    v_fmac_f32 v75, v55, v55
    v_fmac_f32 v74, v40, v40
    v_fmac_f32 v75, v56, v56
    v_fmac_f32 v74, v41, v41
    v_fmac_f32 v75, v57, v57
    v_fmac_f32 v74, v42, v42
    v_fmac_f32 v75, v58, v58
    v_fmac_f32 v74, v43, v43
    v_fmac_f32 v75, v59, v59
    v_fmac_f32 v74, v44, v44
    v_fmac_f32 v75, v60, v60
    v_fmac_f32 v74, v45, v45
    v_fmac_f32 v75, v61, v61
    v_fmac_f32 v74, v46, v46
    v_fmac_f32 v75, v62, v62
    v_fmac_f32 v74, v47, v47
    v_fmac_f32 v75, v63, v63
    v_fmac_f32 v74, v48, v48
    v_fmac_f32 v75, v64, v64
    v_fmac_f32 v74, v49, v49
    v_fmac_f32 v75, v65, v65
    v_fmac_f32 v74, v50, v50
    v_fmac_f32 v75, v66, v66
    v_fmac_f32 v74, v51, v51
    v_fmac_f32 v75, v67, v67
    s_nop 0
    v_add_f32 v74, v74, v74 quad_perm:[1,0,3,2] row_mask:0xf bank_mask:0xf
    v_add_f32 v75, v75, v75 quad_perm:[1,0,3,2] row_mask:0xf bank_mask:0xf
    s_nop 0
    v_add_f32 v74, v74, v74 quad_perm:[2,3,0,1] row_mask:0xf bank_mask:0xf
    v_add_f32 v75, v75, v75 quad_perm:[2,3,0,1] row_mask:0xf bank_mask:0xf
    s_nop 0
    v_add_f32 v74, v74, v74 row_half_mirror row_mask:0xf bank_mask:0xf
    v_add_f32 v75, v75, v75 row_half_mirror row_mask:0xf bank_mask:0xf
    s_nop 0
    v_add_f32 v74, v74, v74 row_mirror row_mask:0xf bank_mask:0xf
    v_add_f32 v75, v75, v75 row_mirror row_mask:0xf bank_mask:0xf
    v_mov_b32 v72, v74
    v_mov_b32 v73, v75
    s_nop 0
    v_permlane16_swap_b32 v74, v72
    v_permlane16_swap_b32 v75, v73
    v_add_f32 v74, v74, v72
    v_add_f32 v75, v75, v73
    v_mov_b32 v72, v74
    v_mov_b32 v73, v75
    s_nop 0
    v_permlane32_swap_b32 v74, v72
    v_permlane32_swap_b32 v75, v73
    v_add_f32 v74, v74, v72
    v_add_f32 v75, v75, v73
    v_mul_f32 v74, 0x3a800000, v74
    v_cvt_pk_bf16_f32 v74, v74, v74
    v_lshlrev_b32 v74, 16, v74
    v_add_f32 v74, 0x3727c5ac, v74
    v_cvt_pk_bf16_f32 v74, v74, v74
    v_lshlrev_b32 v74, 16, v74
    v_sqrt_f32 v74, v74
    s_nop 0
    v_cvt_pk_bf16_f32 v74, v74, v74
    v_lshlrev_b32 v74, 16, v74
    v_rcp_f32 v81, v74
    v_cvt_pk_bf16_f32 v80, v70, v70
    v_lshlrev_b32 v80, 16, v80
    v_mul_f32 v75, 0x3a800000, v75
    v_cvt_pk_bf16_f32 v75, v75, v75
    v_lshlrev_b32 v75, 16, v75
    v_add_f32 v75, 0x3727c5ac, v75
    v_cvt_pk_bf16_f32 v75, v75, v75
    v_lshlrev_b32 v75, 16, v75
    v_sqrt_f32 v75, v75
    s_nop 0
    v_cvt_pk_bf16_f32 v75, v75, v75
    v_lshlrev_b32 v75, 16, v75
    v_rcp_f32 v83, v75
    v_cvt_pk_bf16_f32 v82, v71, v71
    v_lshlrev_b32 v82, 16, v82
    s_waitcnt vmcnt(0)
    v_lshlrev_b32 v36, 16, v20
    v_and_b32 v37, 0xffff0000, v20
    v_lshlrev_b32 v38, 16, v21
    v_and_b32 v39, 0xffff0000, v21
    v_lshlrev_b32 v40, 16, v22
    v_and_b32 v41, 0xffff0000, v22
    v_lshlrev_b32 v42, 16, v23
    v_and_b32 v43, 0xffff0000, v23
    v_lshlrev_b32 v44, 16, v24
    v_and_b32 v45, 0xffff0000, v24
    v_lshlrev_b32 v46, 16, v25
    v_and_b32 v47, 0xffff0000, v25
    v_lshlrev_b32 v48, 16, v26
    v_and_b32 v49, 0xffff0000, v26
    v_lshlrev_b32 v50, 16, v27
    v_and_b32 v51, 0xffff0000, v27
    v_lshlrev_b32 v52, 16, v28
    v_and_b32 v53, 0xffff0000, v28
    v_lshlrev_b32 v54, 16, v29
    v_and_b32 v55, 0xffff0000, v29
    v_lshlrev_b32 v56, 16, v30
    v_and_b32 v57, 0xffff0000, v30
    v_lshlrev_b32 v58, 16, v31
    v_and_b32 v59, 0xffff0000, v31
    v_lshlrev_b32 v60, 16, v32
    v_and_b32 v61, 0xffff0000, v32
    v_lshlrev_b32 v62, 16, v33
    v_and_b32 v63, 0xffff0000, v33
    v_lshlrev_b32 v64, 16, v34
    v_and_b32 v65, 0xffff0000, v34
    v_lshlrev_b32 v66, 16, v35
    v_and_b32 v67, 0xffff0000, v35
    v_add_f32 v70, v36, v37
    v_add_f32 v71, v52, v53
    v_add_f32 v70, v70, v38
    v_add_f32 v71, v71, v54
    v_add_f32 v70, v70, v39
    v_add_f32 v71, v71, v55
    v_add_f32 v70, v70, v40
    v_add_f32 v71, v71, v56
    v_add_f32 v70, v70, v41
    v_add_f32 v71, v71, v57
    v_add_f32 v70, v70, v42
    v_add_f32 v71, v71, v58
    v_add_f32 v70, v70, v43
    v_add_f32 v71, v71, v59
    v_add_f32 v70, v70, v44
    v_add_f32 v71, v71, v60
    v_add_f32 v70, v70, v45
    v_add_f32 v71, v71, v61
    v_add_f32 v70, v70, v46
    v_add_f32 v71, v71, v62
    v_add_f32 v70, v70, v47
    v_add_f32 v71, v71, v63
    v_add_f32 v70, v70, v48
    v_add_f32 v71, v71, v64
    v_add_f32 v70, v70, v49
    v_add_f32 v71, v71, v65
    v_add_f32 v70, v70, v50
    v_add_f32 v71, v71, v66
    v_add_f32 v70, v70, v51
    v_add_f32 v71, v71, v67
    s_nop 0
    v_add_f32 v70, v70, v70 quad_perm:[1,0,3,2] row_mask:0xf bank_mask:0xf
    v_add_f32 v71, v71, v71 quad_perm:[1,0,3,2] row_mask:0xf bank_mask:0xf
    s_nop 0
    v_add_f32 v70, v70, v70 quad_perm:[2,3,0,1] row_mask:0xf bank_mask:0xf
    v_add_f32 v71, v71, v71 quad_perm:[2,3,0,1] row_mask:0xf bank_mask:0xf
    s_nop 0
    v_add_f32 v70, v70, v70 row_half_mirror row_mask:0xf bank_mask:0xf
    v_add_f32 v71, v71, v71 row_half_mirror row_mask:0xf bank_mask:0xf
    s_nop 0
    v_add_f32 v70, v70, v70 row_mirror row_mask:0xf bank_mask:0xf
    v_add_f32 v71, v71, v71 row_mirror row_mask:0xf bank_mask:0xf
    v_mov_b32 v72, v70
    v_mov_b32 v73, v71
    s_nop 0
    v_permlane16_swap_b32 v70, v72
    v_permlane16_swap_b32 v71, v73
    v_add_f32 v70, v70, v72
    v_add_f32 v71, v71, v73
    v_mov_b32 v72, v70
    v_mov_b32 v73, v71
    s_nop 0
    v_permlane32_swap_b32 v70, v72
    v_permlane32_swap_b32 v71, v73
    v_add_f32 v70, v70, v72
    v_add_f32 v71, v71, v73
    v_mul_f32 v70, 0x3a800000, v70
    v_mul_f32 v71, 0x3a800000, v71
    v_sub_f32 v36, v36, v70
    v_sub_f32 v52, v52, v71
    v_sub_f32 v37, v37, v70
    v_sub_f32 v53, v53, v71
    v_sub_f32 v38, v38, v70
    v_sub_f32 v54, v54, v71
    v_sub_f32 v39, v39, v70
    v_sub_f32 v55, v55, v71
    v_sub_f32 v40, v40, v70
    v_sub_f32 v56, v56, v71
    v_sub_f32 v41, v41, v70
    v_sub_f32 v57, v57, v71
    v_sub_f32 v42, v42, v70
    v_sub_f32 v58, v58, v71
    v_sub_f32 v43, v43, v70
    v_sub_f32 v59, v59, v71
    v_sub_f32 v44, v44, v70
    v_sub_f32 v60, v60, v71
    v_sub_f32 v45, v45, v70
    v_sub_f32 v61, v61, v71
    v_sub_f32 v46, v46, v70
    v_sub_f32 v62, v62, v71
    v_sub_f32 v47, v47, v70
    v_sub_f32 v63, v63, v71
    v_sub_f32 v48, v48, v70
    v_sub_f32 v64, v64, v71
    v_sub_f32 v49, v49, v70
    v_sub_f32 v65, v65, v71
    v_sub_f32 v50, v50, v70
    v_sub_f32 v66, v66, v71
    v_sub_f32 v51, v51, v70
    v_sub_f32 v67, v67, v71
    v_mul_f32 v74, v36, v36
    v_mul_f32 v75, v52, v52
    v_fmac_f32 v74, v37, v37
    v_fmac_f32 v75, v53, v53
    v_fmac_f32 v74, v38, v38
    v_fmac_f32 v75, v54, v54
    v_fmac_f32 v74, v39, v39
    v_fmac_f32 v75, v55, v55
    v_fmac_f32 v74, v40, v40
    v_fmac_f32 v75, v56, v56
    v_fmac_f32 v74, v41, v41
    v_fmac_f32 v75, v57, v57
    v_fmac_f32 v74, v42, v42
    v_fmac_f32 v75, v58, v58
    v_fmac_f32 v74, v43, v43
    v_fmac_f32 v75, v59, v59
    v_fmac_f32 v74, v44, v44
    v_fmac_f32 v75, v60, v60
    v_fmac_f32 v74, v45, v45
    v_fmac_f32 v75, v61, v61
    v_fmac_f32 v74, v46, v46
    v_fmac_f32 v75, v62, v62
    v_fmac_f32 v74, v47, v47
    v_fmac_f32 v75, v63, v63
    v_fmac_f32 v74, v48, v48
    v_fmac_f32 v75, v64, v64
    v_fmac_f32 v74, v49, v49
    v_fmac_f32 v75, v65, v65
    v_fmac_f32 v74, v50, v50
    v_fmac_f32 v75, v66, v66
    v_fmac_f32 v74, v51, v51
    v_fmac_f32 v75, v67, v67
    s_nop 0
    v_add_f32 v74, v74, v74 quad_perm:[1,0,3,2] row_mask:0xf bank_mask:0xf
    v_add_f32 v75, v75, v75 quad_perm:[1,0,3,2] row_mask:0xf bank_mask:0xf
    s_nop 0
    v_add_f32 v74, v74, v74 quad_perm:[2,3,0,1] row_mask:0xf bank_mask:0xf
    v_add_f32 v75, v75, v75 quad_perm:[2,3,0,1] row_mask:0xf bank_mask:0xf
    s_nop 0
    v_add_f32 v74, v74, v74 row_half_mirror row_mask:0xf bank_mask:0xf
    v_add_f32 v75, v75, v75 row_half_mirror row_mask:0xf bank_mask:0xf
    s_nop 0
    v_add_f32 v74, v74, v74 row_mirror row_mask:0xf bank_mask:0xf
    v_add_f32 v75, v75, v75 row_mirror row_mask:0xf bank_mask:0xf
    v_mov_b32 v72, v74
    v_mov_b32 v73, v75
    s_nop 0
    v_permlane16_swap_b32 v74, v72
    v_permlane16_swap_b32 v75, v73
    v_add_f32 v74, v74, v72
    v_add_f32 v75, v75, v73
    v_mov_b32 v72, v74
    v_mov_b32 v73, v75
    s_nop 0
    v_permlane32_swap_b32 v74, v72
    v_permlane32_swap_b32 v75, v73
    v_add_f32 v74, v74, v72
    v_add_f32 v75, v75, v73
    v_mul_f32 v74, 0x3a800000, v74
    v_cvt_pk_bf16_f32 v74, v74, v74
    v_lshlrev_b32 v74, 16, v74
    v_add_f32 v74, 0x3727c5ac, v74
    v_cvt_pk_bf16_f32 v74, v74, v74
    v_lshlrev_b32 v74, 16, v74
    v_sqrt_f32 v74, v74
    s_nop 0
    v_cvt_pk_bf16_f32 v74, v74, v74
    v_lshlrev_b32 v74, 16, v74
    v_rcp_f32 v85, v74
    v_cvt_pk_bf16_f32 v84, v70, v70
    v_lshlrev_b32 v84, 16, v84
    v_mul_f32 v75, 0x3a800000, v75
    v_cvt_pk_bf16_f32 v75, v75, v75
    v_lshlrev_b32 v75, 16, v75
    v_add_f32 v75, 0x3727c5ac, v75
    v_cvt_pk_bf16_f32 v75, v75, v75
    v_lshlrev_b32 v75, 16, v75
    v_sqrt_f32 v75, v75
    s_nop 0
    v_cvt_pk_bf16_f32 v75, v75, v75
    v_lshlrev_b32 v75, 16, v75
    v_rcp_f32 v87, v75
    v_cvt_pk_bf16_f32 v86, v71, v71
    v_lshlrev_b32 v86, 16, v86
    v_mov_b32 v2, 0
    s_mov_b64 exec, 1
    global_store_dwordx4 v2, v[80:83], s[46:47] sc1
    global_store_dwordx4 v2, v[84:87], s[46:47] offset:16 sc1
    s_endpgm
prep_repack:
    s_sub_u32 s5, s2, 384
    s_lshl_b32 s5, s5, 2
    s_add_u32 s5, s5, s3
    s_and_b32 s6, s5, 15
    s_lshr_b32 s7, s5, 4
    s_mul_i32 s8, s6, 136
    s_lshl_b32 s9, s7, 2
    s_add_u32 s8, s8, s9
    s_lshl_b32 s8, s8, 10
    s_add_u32 s8, s8, 1048576
    v_lshrrev_b32 v12, 4, v1
    v_bfe_u32 v13, v1, 2, 2
    v_lshlrev_b32 v14, 3, v12
    v_add_u32 v14, v14, v13
    v_lshlrev_b32 v14, 7, v14
    v_add_u32 v14, s4, v14
    v_lshrrev_b32 v13, 1, v13
    v_and_b32 v12, 1, v12
    v_lshl_or_b32 v12, v12, 1, v13
    v_lshlrev_b32 v12, 5, v12
    v_and_b32 v13, 3, v1
    v_lshl_add_u32 v14, v13, 3, v14
    v_xor_b32 v13, 0, v12
    v_add_u32 v8, v14, v13
    v_xor_b32 v13, 32, v12
    v_add_u32 v9, v14, v13
    v_xor_b32 v13, 64, v12
    v_add_u32 v10, v14, v13
    v_xor_b32 v13, 96, v12
    v_add_u32 v11, v14, v13
    v_lshlrev_b32 v15, 4, v1
    s_cmp_eq_u32 s7, 16
    s_cbranch_scc1 prep_kv
    v_lshrrev_b32 v12, 3, v1
    v_mul_u32_u24 v12, 2048, v12
    v_lshrrev_b32 v13, 3, v1
    v_and_b32 v13, 2, v13
    v_xor_b32 v13, v13, v1
    v_and_b32 v13, 7, v13
    v_lshlrev_b32 v13, 4, v13
    v_add_u32 v4, v12, v13
    v_xor_b32 v13, 64, v13
    v_add_u32 v5, v12, v13
    v_add_u32 v5, 16384, v5
    v_add_u32 v6, 32768, v4
    v_add_u32 v7, 32768, v5
    s_lshl_b32 s9, s6, 17
    s_lshl_b32 s10, s7, 7
    s_add_u32 s9, s9, s10
    s_waitcnt lgkmcnt(0)
    s_add_u32 s44, s18, s9
    s_addc_u32 s45, s19, 0
    s_add_u32 s46, s44, 65536
    s_addc_u32 s47, s45, 0
    s_add_u32 m0, s4, 0
    s_nop 0
    global_load_lds_dwordx4 v4, s[44:45]
    s_add_u32 m0, s4, 1024
    s_nop 0
    global_load_lds_dwordx4 v5, s[44:45]
    s_add_u32 m0, s4, 2048
    s_nop 0
    global_load_lds_dwordx4 v6, s[44:45]
    s_add_u32 m0, s4, 3072
    s_nop 0
    global_load_lds_dwordx4 v7, s[44:45]
    s_add_u32 m0, s4, 4096
    s_nop 0
    global_load_lds_dwordx4 v4, s[46:47]
    s_add_u32 m0, s4, 5120
    s_nop 0
    global_load_lds_dwordx4 v5, s[46:47]
    s_add_u32 m0, s4, 6144
    s_nop 0
    global_load_lds_dwordx4 v6, s[46:47]
    s_add_u32 m0, s4, 7168
    s_nop 0
    global_load_lds_dwordx4 v7, s[46:47]
    s_branch prep_rp2
prep_kv:
    v_lshrrev_b32 v12, 3, v1
    v_mul_u32_u24 v12, 64, v12
    v_lshrrev_b32 v13, 3, v1
    v_and_b32 v13, 2, v13
    v_xor_b32 v13, v13, v1
    v_and_b32 v13, 7, v13
    v_lshlrev_b32 v13, 4, v13
    v_add_u32 v4, v12, v13
    v_xor_b32 v13, 64, v13
    v_add_u32 v5, v12, v13
    v_add_u32 v5, 512, v5
    v_add_u32 v6, 1024, v4
    v_add_u32 v7, 1024, v5
    s_lshl_b32 s9, s6, 12
    s_waitcnt lgkmcnt(0)
    s_add_u32 s44, s20, s9
    s_addc_u32 s45, s21, 0
    s_add_u32 s46, s22, s9
    s_addc_u32 s47, s23, 0
    s_sub_u32 s46, s46, 64
    s_subb_u32 s47, s47, 0
    v_and_b32 v12, 4, v1
    v_cmp_ne_u32 vcc, 0, v12
    v_mov_b32 v16, s44
    v_mov_b32 v17, s45
    v_mov_b32 v18, s46
    v_mov_b32 v19, s47
    v_cndmask_b32 v20, v16, v18, vcc
    v_cndmask_b32 v21, v17, v19, vcc
    v_cndmask_b32 v22, v18, v16, vcc
    v_cndmask_b32 v23, v19, v17, vcc
    v_add_u32 v12, 0, v4
    v_add_co_u32 v24, vcc, v20, v12
    s_nop 1
    v_addc_co_u32 v25, vcc, 0, v21, vcc
    s_add_u32 m0, s4, 0
    s_nop 0
    global_load_lds_dwordx4 v[24:25], off
    v_add_u32 v12, 0, v5
    v_add_co_u32 v24, vcc, v22, v12
    s_nop 1
    v_addc_co_u32 v25, vcc, 0, v23, vcc
    s_add_u32 m0, s4, 1024
    s_nop 0
    global_load_lds_dwordx4 v[24:25], off
    v_add_u32 v12, 0, v6
    v_add_co_u32 v24, vcc, v20, v12
    s_nop 1
    v_addc_co_u32 v25, vcc, 0, v21, vcc
    s_add_u32 m0, s4, 2048
    s_nop 0
    global_load_lds_dwordx4 v[24:25], off
    v_add_u32 v12, 0, v7
    v_add_co_u32 v24, vcc, v22, v12
    s_nop 1
    v_addc_co_u32 v25, vcc, 0, v23, vcc
    s_add_u32 m0, s4, 3072
    s_nop 0
    global_load_lds_dwordx4 v[24:25], off
    v_add_u32 v12, 2048, v4
    v_add_co_u32 v24, vcc, v20, v12
    s_nop 1
    v_addc_co_u32 v25, vcc, 0, v21, vcc
    s_add_u32 m0, s4, 4096
    s_nop 0
    global_load_lds_dwordx4 v[24:25], off
    v_add_u32 v12, 2048, v5
    v_add_co_u32 v24, vcc, v22, v12
    s_nop 1
    v_addc_co_u32 v25, vcc, 0, v23, vcc
    s_add_u32 m0, s4, 5120
    s_nop 0
    global_load_lds_dwordx4 v[24:25], off
    v_add_u32 v12, 2048, v6
    v_add_co_u32 v24, vcc, v20, v12
    s_nop 1
    v_addc_co_u32 v25, vcc, 0, v21, vcc
    s_add_u32 m0, s4, 6144
    s_nop 0
    global_load_lds_dwordx4 v[24:25], off
    v_add_u32 v12, 2048, v7
    v_add_co_u32 v24, vcc, v22, v12
    s_nop 1
    v_addc_co_u32 v25, vcc, 0, v23, vcc
    s_add_u32 m0, s4, 7168
    s_nop 0
    global_load_lds_dwordx4 v[24:25], off
prep_rp2:
    s_add_u32 s48, s42, s8
    s_addc_u32 s49, s43, 0
    s_add_u32 s50, s48, 69632
    s_addc_u32 s51, s49, 0
    s_waitcnt vmcnt(0)
    ds_read_b64_tr_b16 v[32:33], v8 offset:0
    ds_read_b64_tr_b16 v[34:35], v8 offset:512
    ds_read_b64_tr_b16 v[36:37], v9 offset:0
    ds_read_b64_tr_b16 v[38:39], v9 offset:512
    ds_read_b64_tr_b16 v[40:41], v10 offset:0
    ds_read_b64_tr_b16 v[42:43], v10 offset:512
    ds_read_b64_tr_b16 v[44:45], v11 offset:0
    ds_read_b64_tr_b16 v[46:47], v11 offset:512
    ds_read_b64_tr_b16 v[48:49], v8 offset:4096
    ds_read_b64_tr_b16 v[50:51], v8 offset:4608
    ds_read_b64_tr_b16 v[52:53], v9 offset:4096
    ds_read_b64_tr_b16 v[54:55], v9 offset:4608
    ds_read_b64_tr_b16 v[56:57], v10 offset:4096
    ds_read_b64_tr_b16 v[58:59], v10 offset:4608
    ds_read_b64_tr_b16 v[60:61], v11 offset:4096
    ds_read_b64_tr_b16 v[62:63], v11 offset:4608
    s_waitcnt lgkmcnt(14)
    global_store_dwordx4 v15, v[32:35], s[48:49] offset:0 sc1
    s_waitcnt lgkmcnt(12)
    global_store_dwordx4 v15, v[36:39], s[48:49] offset:1024 sc1
    s_waitcnt lgkmcnt(10)
    global_store_dwordx4 v15, v[40:43], s[48:49] offset:2048 sc1
    s_waitcnt lgkmcnt(8)
    global_store_dwordx4 v15, v[44:47], s[48:49] offset:3072 sc1
    s_waitcnt lgkmcnt(6)
    global_store_dwordx4 v15, v[48:51], s[50:51] offset:0 sc1
    s_waitcnt lgkmcnt(4)
    global_store_dwordx4 v15, v[52:55], s[50:51] offset:1024 sc1
    s_waitcnt lgkmcnt(2)
    global_store_dwordx4 v15, v[56:59], s[50:51] offset:2048 sc1
    s_waitcnt lgkmcnt(0)
    global_store_dwordx4 v15, v[60:63], s[50:51] offset:3072 sc1
prep_end:
    s_endpgm
.globl qkv_kernel
.p2align 8
.type qkv_kernel,@function
qkv_kernel:
    s_load_dwordx16 s[16:31], s[0:1], 0
    s_load_dwordx8 s[32:39], s[0:1], 64
    s_load_dwordx4 s[40:43], s[0:1], 96
    v_and_b32 v1, 63, v0
    v_lshrrev_b32 v2, 6, v0
    s_nop 0
    v_readfirstlane_b32 s3, v2
    s_cmp_ge_u32 s2, 256
    s_cbranch_scc1 qkv_end
    s_and_b32 s4, s2, 7
    s_lshr_b32 s5, s2, 3
    s_lshl_b32 s4, s4, 2
    s_lshr_b32 s6, s5, 3
    s_add_u32 s4, s4, s6
    s_and_b32 s5, s5, 7
    v_lshrrev_b32 v2, 3, v1
    v_and_b32 v3, 7, v1
    v_lshrrev_b32 v4, 5, v1
    v_lshlrev_b32 v4, 12, v4
    v_and_b32 v5, 31, v1
    v_lshl_add_u32 v4, v5, 5, v4
    s_lshl_b32 s6, s3, 10
    v_add_u32 v4, s6, v4
    v_lshlrev_b32 v5, 3, v2
    v_lshlrev_b32 v6, 11, v2
    v_lshl_add_u32 v6, v3, 4, v6
    s_lshl_b32 s6, s3, 9
    v_add_u32 v6, s6, v6
    v_lshlrev_b32 v7, 4, v1
    v_add_u32 v13, 69632, v7
    s_lshl_b32 s6, s5, 3
    s_lshl_b32 s7, s3, 1
    s_add_u32 s6, s6, s7
    s_and_b32 s7, s5, 3
    s_add_u32 s7, s7, 64
    s_sub_u32 s7, s7, s6
    s_lshl_b32 s7, s7, 10
    v_add_u32 v8, s7, v7
    v_add_u32 v14, 69632, v8
    s_lshl_b32 s6, s6, 10
    s_add_u32 s6, s6, 1048576
    s_lshl_b32 s7, s4, 17
    s_lshl_b32 s8, s4, 9
    s_add_u32 s8, s8, 131072
    s_waitcnt lgkmcnt(0)
    s_add_u32 s44, s42, 0
    s_addc_u32 s45, s43, 0
    s_add_u32 s46, s42, s8
    s_addc_u32 s47, s43, 0
    s_add_u32 s48, s16, s7
    s_addc_u32 s49, s17, 0
    global_load_dwordx4 v[16:19], v4, s[44:45]
    global_load_dwordx4 v[20:23], v4, s[44:45] offset:16
    s_add_u32 s44, s44, 24576
    s_addc_u32 s45, s45, 0
    global_load_dwordx4 v[24:27], v4, s[44:45]
    global_load_dwordx4 v[28:31], v4, s[44:45] offset:16
    s_add_u32 s44, s44, 24576
    s_addc_u32 s45, s45, 0
    global_load_dwordx4 v[32:35], v4, s[44:45]
    global_load_dwordx4 v[36:39], v4, s[44:45] offset:16
    s_add_u32 s44, s44, 24576
    s_addc_u32 s45, s45, 0
    global_load_dwordx4 v[40:43], v4, s[44:45]
    global_load_dwordx4 v[44:47], v4, s[44:45] offset:16
    global_load_dwordx2 v[112:113], v5, s[46:47] offset:0
    global_load_dwordx2 v[114:115], v5, s[46:47] offset:64
    global_load_dwordx2 v[116:117], v5, s[46:47] offset:128
    global_load_dwordx2 v[118:119], v5, s[46:47] offset:192
    global_load_dwordx2 v[120:121], v5, s[46:47] offset:256
    global_load_dwordx2 v[122:123], v5, s[46:47] offset:320
    global_load_dwordx2 v[124:125], v5, s[46:47] offset:384
    global_load_dwordx2 v[126:127], v5, s[46:47] offset:448
    global_load_dwordx4 v[128:131], v6, s[48:49] offset:0
    global_load_dwordx4 v[132:135], v6, s[48:49] offset:128
    global_load_dwordx4 v[136:139], v6, s[48:49] offset:256
    global_load_dwordx4 v[140:143], v6, s[48:49] offset:384
    s_add_u32 s48, s48, 16384
    s_addc_u32 s49, s49, 0
    global_load_dwordx4 v[144:147], v6, s[48:49] offset:0
    global_load_dwordx4 v[148:151], v6, s[48:49] offset:128
    global_load_dwordx4 v[152:155], v6, s[48:49] offset:256
    global_load_dwordx4 v[156:159], v6, s[48:49] offset:384
    s_add_u32 s48, s48, 16384
    s_addc_u32 s49, s49, 0
    global_load_dwordx4 v[160:163], v6, s[48:49] offset:0
    global_load_dwordx4 v[164:167], v6, s[48:49] offset:128
    global_load_dwordx4 v[168:171], v6, s[48:49] offset:256
    global_load_dwordx4 v[172:175], v6, s[48:49] offset:384
    s_add_u32 s48, s48, 16384
    s_addc_u32 s49, s49, 0
    global_load_dwordx4 v[176:179], v6, s[48:49] offset:0
    global_load_dwordx4 v[180:183], v6, s[48:49] offset:128
    global_load_dwordx4 v[184:187], v6, s[48:49] offset:256
    global_load_dwordx4 v[188:191], v6, s[48:49] offset:384
    s_add_u32 s48, s48, 16384
    s_addc_u32 s49, s49, 0
    s_add_u32 s9, s3, 0
    s_and_b32 s9, s9, 3
    s_lshl_b32 s12, s9, 13
    s_mul_i32 s9, s9, 139264
    s_add_u32 s9, s9, s6
    s_add_u32 s50, s42, s9
    s_addc_u32 s51, s43, 0
    s_add_u32 s9, s3, 1
    s_and_b32 s9, s9, 3
    s_lshl_b32 s13, s9, 13
    s_mul_i32 s9, s9, 139264
    s_add_u32 s9, s9, s6
    s_add_u32 s52, s42, s9
    s_addc_u32 s53, s43, 0
    s_add_u32 s9, s3, 2
    s_and_b32 s9, s9, 3
    s_lshl_b32 s14, s9, 13
    s_mul_i32 s9, s9, 139264
    s_add_u32 s9, s9, s6
    s_add_u32 s54, s42, s9
    s_addc_u32 s55, s43, 0
    s_add_u32 s9, s3, 3
    s_and_b32 s9, s9, 3
    s_lshl_b32 s15, s9, 13
    s_mul_i32 s9, s9, 139264
    s_add_u32 s9, s9, s6
    s_add_u32 s56, s42, s9
    s_addc_u32 s57, s43, 0
    v_lshrrev_b32 v9, 2, v3
    v_lshlrev_b32 v9, 12, v9
    v_and_b32 v10, 3, v3
    v_lshl_add_u32 v9, v10, 8, v9
    v_xor_b32 v10, v2, v3
    v_lshl_add_u32 v9, v10, 4, v9
    s_lshl_b32 s6, s3, 15
    v_add_u32 v9, s6, v9
    s_lshl_b32 s6, s3, 11
    s_add_u32 s6, s6, 131072
    v_lshlrev_b32 v10, 5, v1
    v_add_u32 v10, s6, v10
    v_lshlrev_b32 v11, 5, v3
    v_add_u32 v11, s6, v11
    s_waitcnt vmcnt(24)
    v_add_f32 v16, v16, v24
    v_add_f32 v32, v32, v40
    v_add_f32 v17, v17, v25
    v_add_f32 v33, v33, v41
    v_add_f32 v18, v18, v26
    v_add_f32 v34, v34, v42
    v_add_f32 v19, v19, v27
    v_add_f32 v35, v35, v43
    v_add_f32 v20, v20, v28
    v_add_f32 v36, v36, v44
    v_add_f32 v21, v21, v29
    v_add_f32 v37, v37, v45
    v_add_f32 v22, v22, v30
    v_add_f32 v38, v38, v46
    v_add_f32 v23, v23, v31
    v_add_f32 v39, v39, v47
    v_add_f32 v16, v16, v32
    v_add_f32 v17, v17, v33
    v_add_f32 v18, v18, v34
    v_add_f32 v19, v19, v35
    v_add_f32 v20, v20, v36
    v_add_f32 v21, v21, v37
    v_add_f32 v22, v22, v38
    v_add_f32 v23, v23, v39
    v_cvt_pk_bf16_f32 v16, v16, v16
    v_lshlrev_b32 v16, 16, v16
    v_cvt_pk_bf16_f32 v17, v17, v17
    v_lshlrev_b32 v17, 16, v17
    v_cvt_pk_bf16_f32 v18, v18, v18
    v_lshlrev_b32 v18, 16, v18
    v_cvt_pk_bf16_f32 v19, v19, v19
    v_lshlrev_b32 v19, 16, v19
    v_cvt_pk_bf16_f32 v20, v20, v20
    v_lshlrev_b32 v20, 16, v20
    v_cvt_pk_bf16_f32 v21, v21, v21
    v_lshlrev_b32 v21, 16, v21
    v_cvt_pk_bf16_f32 v22, v22, v22
    v_lshlrev_b32 v22, 16, v22
    v_cvt_pk_bf16_f32 v23, v23, v23
    v_lshlrev_b32 v23, 16, v23
    v_lshrrev_b32 v24, 5, v1
    v_cvt_f32_u32 v24, v24
    v_add_f32 v16, v16, v24
    v_add_f32 v17, v17, v24
    v_add_f32 v18, v18, v24
    v_add_f32 v19, v19, v24
    v_add_f32 v20, v20, v24
    v_add_f32 v21, v21, v24
    v_add_f32 v22, v22, v24
    v_add_f32 v23, v23, v24
    v_cvt_pk_bf16_f32 v16, v16, v16
    v_lshlrev_b32 v16, 16, v16
    v_cvt_pk_bf16_f32 v17, v17, v17
    v_lshlrev_b32 v17, 16, v17
    v_cvt_pk_bf16_f32 v18, v18, v18
    v_lshlrev_b32 v18, 16, v18
    v_cvt_pk_bf16_f32 v19, v19, v19
    v_lshlrev_b32 v19, 16, v19
    v_cvt_pk_bf16_f32 v20, v20, v20
    v_lshlrev_b32 v20, 16, v20
    v_cvt_pk_bf16_f32 v21, v21, v21
    v_lshlrev_b32 v21, 16, v21
    v_cvt_pk_bf16_f32 v22, v22, v22
    v_lshlrev_b32 v22, 16, v22
    v_cvt_pk_bf16_f32 v23, v23, v23
    v_lshlrev_b32 v23, 16, v23
    ds_write_b128 v10, v[16:19]
    ds_write_b128 v10, v[20:23] offset:16
    s_waitcnt lgkmcnt(0)
    ds_read_b128 v[48:51], v11 offset:1024
    ds_read_b128 v[52:55], v11 offset:1040
    ds_read_b128 v[56:59], v11 offset:0
    ds_read_b128 v[60:63], v11 offset:16
    ds_read_b128 v[64:67], v11 offset:1280
    ds_read_b128 v[68:71], v11 offset:1296
    ds_read_b128 v[72:75], v11 offset:256
    ds_read_b128 v[76:79], v11 offset:272
    ds_read_b128 v[80:83], v11 offset:1536
    ds_read_b128 v[84:87], v11 offset:1552
    ds_read_b128 v[88:91], v11 offset:512
    ds_read_b128 v[92:95], v11 offset:528
    ds_read_b128 v[96:99], v11 offset:1792
    ds_read_b128 v[100:103], v11 offset:1808
    ds_read_b128 v[104:107], v11 offset:768
    ds_read_b128 v[108:111], v11 offset:784
    s_waitcnt vmcnt(16)
    v_mul_f32 v12, v112, v113
    v_mov_b32 v112, v113
    v_sub_f32 v113, 0, v12
    v_mul_f32 v12, v114, v115
    v_mov_b32 v114, v115
    v_sub_f32 v115, 0, v12
    v_mul_f32 v12, v116, v117
    v_mov_b32 v116, v117
    v_sub_f32 v117, 0, v12
    v_mul_f32 v12, v118, v119
    v_mov_b32 v118, v119
    v_sub_f32 v119, 0, v12
    v_mul_f32 v12, v120, v121
    v_mov_b32 v120, v121
    v_sub_f32 v121, 0, v12
    v_mul_f32 v12, v122, v123
    v_mov_b32 v122, v123
    v_sub_f32 v123, 0, v12
    v_mul_f32 v12, v124, v125
    v_mov_b32 v124, v125
    v_sub_f32 v125, 0, v12
    v_mul_f32 v12, v126, v127
    v_mov_b32 v126, v127
    v_sub_f32 v127, 0, v12
    s_waitcnt lgkmcnt(0)
    s_waitcnt vmcnt(15)
    v_lshlrev_b32 v16, 16, v128
    v_and_b32 v17, 0xffff0000, v128
    v_lshlrev_b32 v18, 16, v129
    v_and_b32 v19, 0xffff0000, v129
    v_lshlrev_b32 v20, 16, v130
    v_and_b32 v21, 0xffff0000, v130
    v_lshlrev_b32 v22, 16, v131
    v_and_b32 v23, 0xffff0000, v131
    v_pk_fma_f32 v[16:17], v[16:17], v[112:113], v[112:113] op_sel:[0,0,1] op_sel_hi:[1,0,1]
    v_pk_fma_f32 v[18:19], v[18:19], v[112:113], v[112:113] op_sel:[0,0,1] op_sel_hi:[1,0,1]
    v_pk_fma_f32 v[20:21], v[20:21], v[112:113], v[112:113] op_sel:[0,0,1] op_sel_hi:[1,0,1]
    v_pk_fma_f32 v[22:23], v[22:23], v[112:113], v[112:113] op_sel:[0,0,1] op_sel_hi:[1,0,1]
    v_pk_fma_f32 v[16:17], v[16:17], v[48:49], v[56:57]
    v_pk_fma_f32 v[18:19], v[18:19], v[50:51], v[58:59]
    v_pk_fma_f32 v[20:21], v[20:21], v[52:53], v[60:61]
    v_pk_fma_f32 v[22:23], v[22:23], v[54:55], v[62:63]
    v_cvt_pk_bf16_f32 v24, v16, v17
    v_cvt_pk_bf16_f32 v25, v18, v19
    v_cvt_pk_bf16_f32 v26, v20, v21
    v_cvt_pk_bf16_f32 v27, v22, v23
    ds_write_b128 v9, v[24:27] offset:0
    global_load_dwordx4 v[192:195], v6, s[48:49] offset:0
    s_waitcnt vmcnt(15)
    v_lshlrev_b32 v28, 16, v132
    v_and_b32 v29, 0xffff0000, v132
    v_lshlrev_b32 v30, 16, v133
    v_and_b32 v31, 0xffff0000, v133
    v_lshlrev_b32 v32, 16, v134
    v_and_b32 v33, 0xffff0000, v134
    v_lshlrev_b32 v34, 16, v135
    v_and_b32 v35, 0xffff0000, v135
    v_pk_fma_f32 v[28:29], v[28:29], v[112:113], v[112:113] op_sel:[0,0,1] op_sel_hi:[1,0,1]
    v_pk_fma_f32 v[30:31], v[30:31], v[112:113], v[112:113] op_sel:[0,0,1] op_sel_hi:[1,0,1]
    v_pk_fma_f32 v[32:33], v[32:33], v[112:113], v[112:113] op_sel:[0,0,1] op_sel_hi:[1,0,1]
    v_pk_fma_f32 v[34:35], v[34:35], v[112:113], v[112:113] op_sel:[0,0,1] op_sel_hi:[1,0,1]
    v_pk_fma_f32 v[28:29], v[28:29], v[64:65], v[72:73]
    v_pk_fma_f32 v[30:31], v[30:31], v[66:67], v[74:75]
    v_pk_fma_f32 v[32:33], v[32:33], v[68:69], v[76:77]
    v_pk_fma_f32 v[34:35], v[34:35], v[70:71], v[78:79]
    v_cvt_pk_bf16_f32 v36, v28, v29
    v_cvt_pk_bf16_f32 v37, v30, v31
    v_cvt_pk_bf16_f32 v38, v32, v33
    v_cvt_pk_bf16_f32 v39, v34, v35
    ds_write_b128 v9, v[36:39] offset:8192
    global_load_dwordx4 v[196:199], v6, s[48:49] offset:128
    s_waitcnt vmcnt(15)
    v_lshlrev_b32 v16, 16, v136
    v_and_b32 v17, 0xffff0000, v136
    v_lshlrev_b32 v18, 16, v137
    v_and_b32 v19, 0xffff0000, v137
    v_lshlrev_b32 v20, 16, v138
    v_and_b32 v21, 0xffff0000, v138
    v_lshlrev_b32 v22, 16, v139
    v_and_b32 v23, 0xffff0000, v139
    v_pk_fma_f32 v[16:17], v[16:17], v[112:113], v[112:113] op_sel:[0,0,1] op_sel_hi:[1,0,1]
    v_pk_fma_f32 v[18:19], v[18:19], v[112:113], v[112:113] op_sel:[0,0,1] op_sel_hi:[1,0,1]
    v_pk_fma_f32 v[20:21], v[20:21], v[112:113], v[112:113] op_sel:[0,0,1] op_sel_hi:[1,0,1]
    v_pk_fma_f32 v[22:23], v[22:23], v[112:113], v[112:113] op_sel:[0,0,1] op_sel_hi:[1,0,1]
    v_pk_fma_f32 v[16:17], v[16:17], v[80:81], v[88:89]
    v_pk_fma_f32 v[18:19], v[18:19], v[82:83], v[90:91]
    v_pk_fma_f32 v[20:21], v[20:21], v[84:85], v[92:93]
    v_pk_fma_f32 v[22:23], v[22:23], v[86:87], v[94:95]
    v_cvt_pk_bf16_f32 v24, v16, v17
    v_cvt_pk_bf16_f32 v25, v18, v19
    v_cvt_pk_bf16_f32 v26, v20, v21
    v_cvt_pk_bf16_f32 v27, v22, v23
    ds_write_b128 v9, v[24:27] offset:16384
    global_load_dwordx4 v[200:203], v6, s[48:49] offset:256
    s_waitcnt vmcnt(15)
    v_lshlrev_b32 v28, 16, v140
    v_and_b32 v29, 0xffff0000, v140
    v_lshlrev_b32 v30, 16, v141
    v_and_b32 v31, 0xffff0000, v141
    v_lshlrev_b32 v32, 16, v142
    v_and_b32 v33, 0xffff0000, v142
    v_lshlrev_b32 v34, 16, v143
    v_and_b32 v35, 0xffff0000, v143
    v_pk_fma_f32 v[28:29], v[28:29], v[112:113], v[112:113] op_sel:[0,0,1] op_sel_hi:[1,0,1]
    v_pk_fma_f32 v[30:31], v[30:31], v[112:113], v[112:113] op_sel:[0,0,1] op_sel_hi:[1,0,1]
    v_pk_fma_f32 v[32:33], v[32:33], v[112:113], v[112:113] op_sel:[0,0,1] op_sel_hi:[1,0,1]
    v_pk_fma_f32 v[34:35], v[34:35], v[112:113], v[112:113] op_sel:[0,0,1] op_sel_hi:[1,0,1]
    v_pk_fma_f32 v[28:29], v[28:29], v[96:97], v[104:105]
    v_pk_fma_f32 v[30:31], v[30:31], v[98:99], v[106:107]
    v_pk_fma_f32 v[32:33], v[32:33], v[100:101], v[108:109]
    v_pk_fma_f32 v[34:35], v[34:35], v[102:103], v[110:111]
    v_cvt_pk_bf16_f32 v36, v28, v29
    v_cvt_pk_bf16_f32 v37, v30, v31
    v_cvt_pk_bf16_f32 v38, v32, v33
    v_cvt_pk_bf16_f32 v39, v34, v35
    ds_write_b128 v9, v[36:39] offset:24576
    global_load_dwordx4 v[204:207], v6, s[48:49] offset:384
    s_add_u32 s48, s48, 16384
    s_addc_u32 s49, s49, 0
    s_waitcnt vmcnt(15)
    v_lshlrev_b32 v16, 16, v144
    v_and_b32 v17, 0xffff0000, v144
    v_lshlrev_b32 v18, 16, v145
    v_and_b32 v19, 0xffff0000, v145
    v_lshlrev_b32 v20, 16, v146
    v_and_b32 v21, 0xffff0000, v146
    v_lshlrev_b32 v22, 16, v147
    v_and_b32 v23, 0xffff0000, v147
    v_pk_fma_f32 v[16:17], v[16:17], v[114:115], v[114:115] op_sel:[0,0,1] op_sel_hi:[1,0,1]
    v_pk_fma_f32 v[18:19], v[18:19], v[114:115], v[114:115] op_sel:[0,0,1] op_sel_hi:[1,0,1]
    v_pk_fma_f32 v[20:21], v[20:21], v[114:115], v[114:115] op_sel:[0,0,1] op_sel_hi:[1,0,1]
    v_pk_fma_f32 v[22:23], v[22:23], v[114:115], v[114:115] op_sel:[0,0,1] op_sel_hi:[1,0,1]
    v_pk_fma_f32 v[16:17], v[16:17], v[48:49], v[56:57]
    v_pk_fma_f32 v[18:19], v[18:19], v[50:51], v[58:59]
    v_pk_fma_f32 v[20:21], v[20:21], v[52:53], v[60:61]
    v_pk_fma_f32 v[22:23], v[22:23], v[54:55], v[62:63]
    v_cvt_pk_bf16_f32 v24, v16, v17
    v_cvt_pk_bf16_f32 v25, v18, v19
    v_cvt_pk_bf16_f32 v26, v20, v21
    v_cvt_pk_bf16_f32 v27, v22, v23
    ds_write_b128 v9, v[24:27] offset:128
    global_load_dwordx4 v[208:211], v6, s[48:49] offset:0
    s_waitcnt vmcnt(15)
    v_lshlrev_b32 v28, 16, v148
    v_and_b32 v29, 0xffff0000, v148
    v_lshlrev_b32 v30, 16, v149
    v_and_b32 v31, 0xffff0000, v149
    v_lshlrev_b32 v32, 16, v150
    v_and_b32 v33, 0xffff0000, v150
    v_lshlrev_b32 v34, 16, v151
    v_and_b32 v35, 0xffff0000, v151
    v_pk_fma_f32 v[28:29], v[28:29], v[114:115], v[114:115] op_sel:[0,0,1] op_sel_hi:[1,0,1]
    v_pk_fma_f32 v[30:31], v[30:31], v[114:115], v[114:115] op_sel:[0,0,1] op_sel_hi:[1,0,1]
    v_pk_fma_f32 v[32:33], v[32:33], v[114:115], v[114:115] op_sel:[0,0,1] op_sel_hi:[1,0,1]
    v_pk_fma_f32 v[34:35], v[34:35], v[114:115], v[114:115] op_sel:[0,0,1] op_sel_hi:[1,0,1]
    v_pk_fma_f32 v[28:29], v[28:29], v[64:65], v[72:73]
    v_pk_fma_f32 v[30:31], v[30:31], v[66:67], v[74:75]
    v_pk_fma_f32 v[32:33], v[32:33], v[68:69], v[76:77]
    v_pk_fma_f32 v[34:35], v[34:35], v[70:71], v[78:79]
    v_cvt_pk_bf16_f32 v36, v28, v29
    v_cvt_pk_bf16_f32 v37, v30, v31
    v_cvt_pk_bf16_f32 v38, v32, v33
    v_cvt_pk_bf16_f32 v39, v34, v35
    ds_write_b128 v9, v[36:39] offset:8320
    global_load_dwordx4 v[212:215], v6, s[48:49] offset:128
    s_waitcnt vmcnt(15)
    v_lshlrev_b32 v16, 16, v152
    v_and_b32 v17, 0xffff0000, v152
    v_lshlrev_b32 v18, 16, v153
    v_and_b32 v19, 0xffff0000, v153
    v_lshlrev_b32 v20, 16, v154
    v_and_b32 v21, 0xffff0000, v154
    v_lshlrev_b32 v22, 16, v155
    v_and_b32 v23, 0xffff0000, v155
    v_pk_fma_f32 v[16:17], v[16:17], v[114:115], v[114:115] op_sel:[0,0,1] op_sel_hi:[1,0,1]
    v_pk_fma_f32 v[18:19], v[18:19], v[114:115], v[114:115] op_sel:[0,0,1] op_sel_hi:[1,0,1]
    v_pk_fma_f32 v[20:21], v[20:21], v[114:115], v[114:115] op_sel:[0,0,1] op_sel_hi:[1,0,1]
    v_pk_fma_f32 v[22:23], v[22:23], v[114:115], v[114:115] op_sel:[0,0,1] op_sel_hi:[1,0,1]
    v_pk_fma_f32 v[16:17], v[16:17], v[80:81], v[88:89]
    v_pk_fma_f32 v[18:19], v[18:19], v[82:83], v[90:91]
    v_pk_fma_f32 v[20:21], v[20:21], v[84:85], v[92:93]
    v_pk_fma_f32 v[22:23], v[22:23], v[86:87], v[94:95]
    v_cvt_pk_bf16_f32 v24, v16, v17
    v_cvt_pk_bf16_f32 v25, v18, v19
    v_cvt_pk_bf16_f32 v26, v20, v21
    v_cvt_pk_bf16_f32 v27, v22, v23
    ds_write_b128 v9, v[24:27] offset:16512
    global_load_dwordx4 v[216:219], v6, s[48:49] offset:256
    s_waitcnt vmcnt(15)
    v_lshlrev_b32 v28, 16, v156
    v_and_b32 v29, 0xffff0000, v156
    v_lshlrev_b32 v30, 16, v157
    v_and_b32 v31, 0xffff0000, v157
    v_lshlrev_b32 v32, 16, v158
    v_and_b32 v33, 0xffff0000, v158
    v_lshlrev_b32 v34, 16, v159
    v_and_b32 v35, 0xffff0000, v159
    v_pk_fma_f32 v[28:29], v[28:29], v[114:115], v[114:115] op_sel:[0,0,1] op_sel_hi:[1,0,1]
    v_pk_fma_f32 v[30:31], v[30:31], v[114:115], v[114:115] op_sel:[0,0,1] op_sel_hi:[1,0,1]
    v_pk_fma_f32 v[32:33], v[32:33], v[114:115], v[114:115] op_sel:[0,0,1] op_sel_hi:[1,0,1]
    v_pk_fma_f32 v[34:35], v[34:35], v[114:115], v[114:115] op_sel:[0,0,1] op_sel_hi:[1,0,1]
    v_pk_fma_f32 v[28:29], v[28:29], v[96:97], v[104:105]
    v_pk_fma_f32 v[30:31], v[30:31], v[98:99], v[106:107]
    v_pk_fma_f32 v[32:33], v[32:33], v[100:101], v[108:109]
    v_pk_fma_f32 v[34:35], v[34:35], v[102:103], v[110:111]
    v_cvt_pk_bf16_f32 v36, v28, v29
    v_cvt_pk_bf16_f32 v37, v30, v31
    v_cvt_pk_bf16_f32 v38, v32, v33
    v_cvt_pk_bf16_f32 v39, v34, v35
    ds_write_b128 v9, v[36:39] offset:24704
    global_load_dwordx4 v[220:223], v6, s[48:49] offset:384
    s_add_u32 s48, s48, 16384
    s_addc_u32 s49, s49, 0
    s_waitcnt vmcnt(15)
    v_lshlrev_b32 v16, 16, v160
    v_and_b32 v17, 0xffff0000, v160
    v_lshlrev_b32 v18, 16, v161
    v_and_b32 v19, 0xffff0000, v161
    v_lshlrev_b32 v20, 16, v162
    v_and_b32 v21, 0xffff0000, v162
    v_lshlrev_b32 v22, 16, v163
    v_and_b32 v23, 0xffff0000, v163
    v_pk_fma_f32 v[16:17], v[16:17], v[116:117], v[116:117] op_sel:[0,0,1] op_sel_hi:[1,0,1]
    v_pk_fma_f32 v[18:19], v[18:19], v[116:117], v[116:117] op_sel:[0,0,1] op_sel_hi:[1,0,1]
    v_pk_fma_f32 v[20:21], v[20:21], v[116:117], v[116:117] op_sel:[0,0,1] op_sel_hi:[1,0,1]
    v_pk_fma_f32 v[22:23], v[22:23], v[116:117], v[116:117] op_sel:[0,0,1] op_sel_hi:[1,0,1]
    v_pk_fma_f32 v[16:17], v[16:17], v[48:49], v[56:57]
    v_pk_fma_f32 v[18:19], v[18:19], v[50:51], v[58:59]
    v_pk_fma_f32 v[20:21], v[20:21], v[52:53], v[60:61]
    v_pk_fma_f32 v[22:23], v[22:23], v[54:55], v[62:63]
    v_cvt_pk_bf16_f32 v24, v16, v17
    v_cvt_pk_bf16_f32 v25, v18, v19
    v_cvt_pk_bf16_f32 v26, v20, v21
    v_cvt_pk_bf16_f32 v27, v22, v23
    ds_write_b128 v9, v[24:27] offset:1024
    global_load_dwordx4 v[224:227], v6, s[48:49] offset:0
    s_waitcnt vmcnt(15)
    v_lshlrev_b32 v28, 16, v164
    v_and_b32 v29, 0xffff0000, v164
    v_lshlrev_b32 v30, 16, v165
    v_and_b32 v31, 0xffff0000, v165
    v_lshlrev_b32 v32, 16, v166
    v_and_b32 v33, 0xffff0000, v166
    v_lshlrev_b32 v34, 16, v167
    v_and_b32 v35, 0xffff0000, v167
    v_pk_fma_f32 v[28:29], v[28:29], v[116:117], v[116:117] op_sel:[0,0,1] op_sel_hi:[1,0,1]
    v_pk_fma_f32 v[30:31], v[30:31], v[116:117], v[116:117] op_sel:[0,0,1] op_sel_hi:[1,0,1]
    v_pk_fma_f32 v[32:33], v[32:33], v[116:117], v[116:117] op_sel:[0,0,1] op_sel_hi:[1,0,1]
    v_pk_fma_f32 v[34:35], v[34:35], v[116:117], v[116:117] op_sel:[0,0,1] op_sel_hi:[1,0,1]
    v_pk_fma_f32 v[28:29], v[28:29], v[64:65], v[72:73]
    v_pk_fma_f32 v[30:31], v[30:31], v[66:67], v[74:75]
    v_pk_fma_f32 v[32:33], v[32:33], v[68:69], v[76:77]
    v_pk_fma_f32 v[34:35], v[34:35], v[70:71], v[78:79]
    v_cvt_pk_bf16_f32 v36, v28, v29
    v_cvt_pk_bf16_f32 v37, v30, v31
    v_cvt_pk_bf16_f32 v38, v32, v33
    v_cvt_pk_bf16_f32 v39, v34, v35
    ds_write_b128 v9, v[36:39] offset:9216
    global_load_dwordx4 v[228:231], v6, s[48:49] offset:128
    s_waitcnt vmcnt(15)
    v_lshlrev_b32 v16, 16, v168
    v_and_b32 v17, 0xffff0000, v168
    v_lshlrev_b32 v18, 16, v169
    v_and_b32 v19, 0xffff0000, v169
    v_lshlrev_b32 v20, 16, v170
    v_and_b32 v21, 0xffff0000, v170
    v_lshlrev_b32 v22, 16, v171
    v_and_b32 v23, 0xffff0000, v171
    v_pk_fma_f32 v[16:17], v[16:17], v[116:117], v[116:117] op_sel:[0,0,1] op_sel_hi:[1,0,1]
    v_pk_fma_f32 v[18:19], v[18:19], v[116:117], v[116:117] op_sel:[0,0,1] op_sel_hi:[1,0,1]
    v_pk_fma_f32 v[20:21], v[20:21], v[116:117], v[116:117] op_sel:[0,0,1] op_sel_hi:[1,0,1]
    v_pk_fma_f32 v[22:23], v[22:23], v[116:117], v[116:117] op_sel:[0,0,1] op_sel_hi:[1,0,1]
    v_pk_fma_f32 v[16:17], v[16:17], v[80:81], v[88:89]
    v_pk_fma_f32 v[18:19], v[18:19], v[82:83], v[90:91]
    v_pk_fma_f32 v[20:21], v[20:21], v[84:85], v[92:93]
    v_pk_fma_f32 v[22:23], v[22:23], v[86:87], v[94:95]
    v_cvt_pk_bf16_f32 v24, v16, v17
    v_cvt_pk_bf16_f32 v25, v18, v19
    v_cvt_pk_bf16_f32 v26, v20, v21
    v_cvt_pk_bf16_f32 v27, v22, v23
    ds_write_b128 v9, v[24:27] offset:17408
    global_load_dwordx4 v[232:235], v6, s[48:49] offset:256
    s_waitcnt vmcnt(15)
    v_lshlrev_b32 v28, 16, v172
    v_and_b32 v29, 0xffff0000, v172
    v_lshlrev_b32 v30, 16, v173
    v_and_b32 v31, 0xffff0000, v173
    v_lshlrev_b32 v32, 16, v174
    v_and_b32 v33, 0xffff0000, v174
    v_lshlrev_b32 v34, 16, v175
    v_and_b32 v35, 0xffff0000, v175
    v_pk_fma_f32 v[28:29], v[28:29], v[116:117], v[116:117] op_sel:[0,0,1] op_sel_hi:[1,0,1]
    v_pk_fma_f32 v[30:31], v[30:31], v[116:117], v[116:117] op_sel:[0,0,1] op_sel_hi:[1,0,1]
    v_pk_fma_f32 v[32:33], v[32:33], v[116:117], v[116:117] op_sel:[0,0,1] op_sel_hi:[1,0,1]
    v_pk_fma_f32 v[34:35], v[34:35], v[116:117], v[116:117] op_sel:[0,0,1] op_sel_hi:[1,0,1]
    v_pk_fma_f32 v[28:29], v[28:29], v[96:97], v[104:105]
    v_pk_fma_f32 v[30:31], v[30:31], v[98:99], v[106:107]
    v_pk_fma_f32 v[32:33], v[32:33], v[100:101], v[108:109]
    v_pk_fma_f32 v[34:35], v[34:35], v[102:103], v[110:111]
    v_cvt_pk_bf16_f32 v36, v28, v29
    v_cvt_pk_bf16_f32 v37, v30, v31
    v_cvt_pk_bf16_f32 v38, v32, v33
    v_cvt_pk_bf16_f32 v39, v34, v35
    ds_write_b128 v9, v[36:39] offset:25600
    global_load_dwordx4 v[236:239], v6, s[48:49] offset:384
    s_add_u32 s48, s48, 16384
    s_addc_u32 s49, s49, 0
    s_waitcnt vmcnt(15)
    v_lshlrev_b32 v16, 16, v176
    v_and_b32 v17, 0xffff0000, v176
    v_lshlrev_b32 v18, 16, v177
    v_and_b32 v19, 0xffff0000, v177
    v_lshlrev_b32 v20, 16, v178
    v_and_b32 v21, 0xffff0000, v178
    v_lshlrev_b32 v22, 16, v179
    v_and_b32 v23, 0xffff0000, v179
    v_pk_fma_f32 v[16:17], v[16:17], v[118:119], v[118:119] op_sel:[0,0,1] op_sel_hi:[1,0,1]
    v_pk_fma_f32 v[18:19], v[18:19], v[118:119], v[118:119] op_sel:[0,0,1] op_sel_hi:[1,0,1]
    v_pk_fma_f32 v[20:21], v[20:21], v[118:119], v[118:119] op_sel:[0,0,1] op_sel_hi:[1,0,1]
    v_pk_fma_f32 v[22:23], v[22:23], v[118:119], v[118:119] op_sel:[0,0,1] op_sel_hi:[1,0,1]
    v_pk_fma_f32 v[16:17], v[16:17], v[48:49], v[56:57]
    v_pk_fma_f32 v[18:19], v[18:19], v[50:51], v[58:59]
    v_pk_fma_f32 v[20:21], v[20:21], v[52:53], v[60:61]
    v_pk_fma_f32 v[22:23], v[22:23], v[54:55], v[62:63]
    v_cvt_pk_bf16_f32 v24, v16, v17
    v_cvt_pk_bf16_f32 v25, v18, v19
    v_cvt_pk_bf16_f32 v26, v20, v21
    v_cvt_pk_bf16_f32 v27, v22, v23
    ds_write_b128 v9, v[24:27] offset:1152
    global_load_dwordx4 v[240:243], v6, s[48:49] offset:0
    s_waitcnt vmcnt(15)
    v_lshlrev_b32 v28, 16, v180
    v_and_b32 v29, 0xffff0000, v180
    v_lshlrev_b32 v30, 16, v181
    v_and_b32 v31, 0xffff0000, v181
    v_lshlrev_b32 v32, 16, v182
    v_and_b32 v33, 0xffff0000, v182
    v_lshlrev_b32 v34, 16, v183
    v_and_b32 v35, 0xffff0000, v183
    v_pk_fma_f32 v[28:29], v[28:29], v[118:119], v[118:119] op_sel:[0,0,1] op_sel_hi:[1,0,1]
    v_pk_fma_f32 v[30:31], v[30:31], v[118:119], v[118:119] op_sel:[0,0,1] op_sel_hi:[1,0,1]
    v_pk_fma_f32 v[32:33], v[32:33], v[118:119], v[118:119] op_sel:[0,0,1] op_sel_hi:[1,0,1]
    v_pk_fma_f32 v[34:35], v[34:35], v[118:119], v[118:119] op_sel:[0,0,1] op_sel_hi:[1,0,1]
    v_pk_fma_f32 v[28:29], v[28:29], v[64:65], v[72:73]
    v_pk_fma_f32 v[30:31], v[30:31], v[66:67], v[74:75]
    v_pk_fma_f32 v[32:33], v[32:33], v[68:69], v[76:77]
    v_pk_fma_f32 v[34:35], v[34:35], v[70:71], v[78:79]
    v_cvt_pk_bf16_f32 v36, v28, v29
    v_cvt_pk_bf16_f32 v37, v30, v31
    v_cvt_pk_bf16_f32 v38, v32, v33
    v_cvt_pk_bf16_f32 v39, v34, v35
    ds_write_b128 v9, v[36:39] offset:9344
    global_load_dwordx4 v[244:247], v6, s[48:49] offset:128
    s_waitcnt vmcnt(15)
    v_lshlrev_b32 v16, 16, v184
    v_and_b32 v17, 0xffff0000, v184
    v_lshlrev_b32 v18, 16, v185
    v_and_b32 v19, 0xffff0000, v185
    v_lshlrev_b32 v20, 16, v186
    v_and_b32 v21, 0xffff0000, v186
    v_lshlrev_b32 v22, 16, v187
    v_and_b32 v23, 0xffff0000, v187
    v_pk_fma_f32 v[16:17], v[16:17], v[118:119], v[118:119] op_sel:[0,0,1] op_sel_hi:[1,0,1]
    v_pk_fma_f32 v[18:19], v[18:19], v[118:119], v[118:119] op_sel:[0,0,1] op_sel_hi:[1,0,1]
    v_pk_fma_f32 v[20:21], v[20:21], v[118:119], v[118:119] op_sel:[0,0,1] op_sel_hi:[1,0,1]
    v_pk_fma_f32 v[22:23], v[22:23], v[118:119], v[118:119] op_sel:[0,0,1] op_sel_hi:[1,0,1]
    v_pk_fma_f32 v[16:17], v[16:17], v[80:81], v[88:89]
    v_pk_fma_f32 v[18:19], v[18:19], v[82:83], v[90:91]
    v_pk_fma_f32 v[20:21], v[20:21], v[84:85], v[92:93]
    v_pk_fma_f32 v[22:23], v[22:23], v[86:87], v[94:95]
    v_cvt_pk_bf16_f32 v24, v16, v17
    v_cvt_pk_bf16_f32 v25, v18, v19
    v_cvt_pk_bf16_f32 v26, v20, v21
    v_cvt_pk_bf16_f32 v27, v22, v23
    ds_write_b128 v9, v[24:27] offset:17536
    global_load_dwordx4 v[248:251], v6, s[48:49] offset:256
    s_waitcnt vmcnt(15)
    v_lshlrev_b32 v28, 16, v188
    v_and_b32 v29, 0xffff0000, v188
    v_lshlrev_b32 v30, 16, v189
    v_and_b32 v31, 0xffff0000, v189
    v_lshlrev_b32 v32, 16, v190
    v_and_b32 v33, 0xffff0000, v190
    v_lshlrev_b32 v34, 16, v191
    v_and_b32 v35, 0xffff0000, v191
    v_pk_fma_f32 v[28:29], v[28:29], v[118:119], v[118:119] op_sel:[0,0,1] op_sel_hi:[1,0,1]
    v_pk_fma_f32 v[30:31], v[30:31], v[118:119], v[118:119] op_sel:[0,0,1] op_sel_hi:[1,0,1]
    v_pk_fma_f32 v[32:33], v[32:33], v[118:119], v[118:119] op_sel:[0,0,1] op_sel_hi:[1,0,1]
    v_pk_fma_f32 v[34:35], v[34:35], v[118:119], v[118:119] op_sel:[0,0,1] op_sel_hi:[1,0,1]
    v_pk_fma_f32 v[28:29], v[28:29], v[96:97], v[104:105]
    v_pk_fma_f32 v[30:31], v[30:31], v[98:99], v[106:107]
    v_pk_fma_f32 v[32:33], v[32:33], v[100:101], v[108:109]
    v_pk_fma_f32 v[34:35], v[34:35], v[102:103], v[110:111]
    v_cvt_pk_bf16_f32 v36, v28, v29
    v_cvt_pk_bf16_f32 v37, v30, v31
    v_cvt_pk_bf16_f32 v38, v32, v33
    v_cvt_pk_bf16_f32 v39, v34, v35
    ds_write_b128 v9, v[36:39] offset:25728
    global_load_dwordx4 v[252:255], v6, s[48:49] offset:384
    s_add_u32 s48, s48, 16384
    s_addc_u32 s49, s49, 0
    s_waitcnt vmcnt(15)
    v_lshlrev_b32 v16, 16, v192
    v_and_b32 v17, 0xffff0000, v192
    v_lshlrev_b32 v18, 16, v193
    v_and_b32 v19, 0xffff0000, v193
    v_lshlrev_b32 v20, 16, v194
    v_and_b32 v21, 0xffff0000, v194
    v_lshlrev_b32 v22, 16, v195
    v_and_b32 v23, 0xffff0000, v195
    v_pk_fma_f32 v[16:17], v[16:17], v[120:121], v[120:121] op_sel:[0,0,1] op_sel_hi:[1,0,1]
    v_pk_fma_f32 v[18:19], v[18:19], v[120:121], v[120:121] op_sel:[0,0,1] op_sel_hi:[1,0,1]
    v_pk_fma_f32 v[20:21], v[20:21], v[120:121], v[120:121] op_sel:[0,0,1] op_sel_hi:[1,0,1]
    v_pk_fma_f32 v[22:23], v[22:23], v[120:121], v[120:121] op_sel:[0,0,1] op_sel_hi:[1,0,1]
    v_pk_fma_f32 v[16:17], v[16:17], v[48:49], v[56:57]
    v_pk_fma_f32 v[18:19], v[18:19], v[50:51], v[58:59]
    v_pk_fma_f32 v[20:21], v[20:21], v[52:53], v[60:61]
    v_pk_fma_f32 v[22:23], v[22:23], v[54:55], v[62:63]
    v_cvt_pk_bf16_f32 v24, v16, v17
    v_cvt_pk_bf16_f32 v25, v18, v19
    v_cvt_pk_bf16_f32 v26, v20, v21
    v_cvt_pk_bf16_f32 v27, v22, v23
    ds_write_b128 v9, v[24:27] offset:2048
    global_load_dwordx4 a[0:3], v7, s[50:51] offset:0
    s_waitcnt vmcnt(15)
    v_lshlrev_b32 v28, 16, v196
    v_and_b32 v29, 0xffff0000, v196
    v_lshlrev_b32 v30, 16, v197
    v_and_b32 v31, 0xffff0000, v197
    v_lshlrev_b32 v32, 16, v198
    v_and_b32 v33, 0xffff0000, v198
    v_lshlrev_b32 v34, 16, v199
    v_and_b32 v35, 0xffff0000, v199
    v_pk_fma_f32 v[28:29], v[28:29], v[120:121], v[120:121] op_sel:[0,0,1] op_sel_hi:[1,0,1]
    v_pk_fma_f32 v[30:31], v[30:31], v[120:121], v[120:121] op_sel:[0,0,1] op_sel_hi:[1,0,1]
    v_pk_fma_f32 v[32:33], v[32:33], v[120:121], v[120:121] op_sel:[0,0,1] op_sel_hi:[1,0,1]
    v_pk_fma_f32 v[34:35], v[34:35], v[120:121], v[120:121] op_sel:[0,0,1] op_sel_hi:[1,0,1]
    v_pk_fma_f32 v[28:29], v[28:29], v[64:65], v[72:73]
    v_pk_fma_f32 v[30:31], v[30:31], v[66:67], v[74:75]
    v_pk_fma_f32 v[32:33], v[32:33], v[68:69], v[76:77]
    v_pk_fma_f32 v[34:35], v[34:35], v[70:71], v[78:79]
    v_cvt_pk_bf16_f32 v36, v28, v29
    v_cvt_pk_bf16_f32 v37, v30, v31
    v_cvt_pk_bf16_f32 v38, v32, v33
    v_cvt_pk_bf16_f32 v39, v34, v35
    ds_write_b128 v9, v[36:39] offset:10240
    global_load_dwordx4 a[4:7], v7, s[50:51] offset:1024
    s_waitcnt vmcnt(15)
    v_lshlrev_b32 v16, 16, v200
    v_and_b32 v17, 0xffff0000, v200
    v_lshlrev_b32 v18, 16, v201
    v_and_b32 v19, 0xffff0000, v201
    v_lshlrev_b32 v20, 16, v202
    v_and_b32 v21, 0xffff0000, v202
    v_lshlrev_b32 v22, 16, v203
    v_and_b32 v23, 0xffff0000, v203
    v_pk_fma_f32 v[16:17], v[16:17], v[120:121], v[120:121] op_sel:[0,0,1] op_sel_hi:[1,0,1]
    v_pk_fma_f32 v[18:19], v[18:19], v[120:121], v[120:121] op_sel:[0,0,1] op_sel_hi:[1,0,1]
    v_pk_fma_f32 v[20:21], v[20:21], v[120:121], v[120:121] op_sel:[0,0,1] op_sel_hi:[1,0,1]
    v_pk_fma_f32 v[22:23], v[22:23], v[120:121], v[120:121] op_sel:[0,0,1] op_sel_hi:[1,0,1]
    v_pk_fma_f32 v[16:17], v[16:17], v[80:81], v[88:89]
    v_pk_fma_f32 v[18:19], v[18:19], v[82:83], v[90:91]
    v_pk_fma_f32 v[20:21], v[20:21], v[84:85], v[92:93]
    v_pk_fma_f32 v[22:23], v[22:23], v[86:87], v[94:95]
    v_cvt_pk_bf16_f32 v24, v16, v17
    v_cvt_pk_bf16_f32 v25, v18, v19
    v_cvt_pk_bf16_f32 v26, v20, v21
    v_cvt_pk_bf16_f32 v27, v22, v23
    ds_write_b128 v9, v[24:27] offset:18432
    global_load_dwordx4 v[128:131], v8, s[50:51]
    s_waitcnt vmcnt(15)
    v_lshlrev_b32 v28, 16, v204
    v_and_b32 v29, 0xffff0000, v204
    v_lshlrev_b32 v30, 16, v205
    v_and_b32 v31, 0xffff0000, v205
    v_lshlrev_b32 v32, 16, v206
    v_and_b32 v33, 0xffff0000, v206
    v_lshlrev_b32 v34, 16, v207
    v_and_b32 v35, 0xffff0000, v207
    v_pk_fma_f32 v[28:29], v[28:29], v[120:121], v[120:121] op_sel:[0,0,1] op_sel_hi:[1,0,1]
    v_pk_fma_f32 v[30:31], v[30:31], v[120:121], v[120:121] op_sel:[0,0,1] op_sel_hi:[1,0,1]
    v_pk_fma_f32 v[32:33], v[32:33], v[120:121], v[120:121] op_sel:[0,0,1] op_sel_hi:[1,0,1]
    v_pk_fma_f32 v[34:35], v[34:35], v[120:121], v[120:121] op_sel:[0,0,1] op_sel_hi:[1,0,1]
    v_pk_fma_f32 v[28:29], v[28:29], v[96:97], v[104:105]
    v_pk_fma_f32 v[30:31], v[30:31], v[98:99], v[106:107]
    v_pk_fma_f32 v[32:33], v[32:33], v[100:101], v[108:109]
    v_pk_fma_f32 v[34:35], v[34:35], v[102:103], v[110:111]
    v_cvt_pk_bf16_f32 v36, v28, v29
    v_cvt_pk_bf16_f32 v37, v30, v31
    v_cvt_pk_bf16_f32 v38, v32, v33
    v_cvt_pk_bf16_f32 v39, v34, v35
    ds_write_b128 v9, v[36:39] offset:26624
    global_load_dwordx4 a[8:11], v13, s[50:51] offset:0
    s_waitcnt vmcnt(15)
    v_lshlrev_b32 v16, 16, v208
    v_and_b32 v17, 0xffff0000, v208
    v_lshlrev_b32 v18, 16, v209
    v_and_b32 v19, 0xffff0000, v209
    v_lshlrev_b32 v20, 16, v210
    v_and_b32 v21, 0xffff0000, v210
    v_lshlrev_b32 v22, 16, v211
    v_and_b32 v23, 0xffff0000, v211
    v_pk_fma_f32 v[16:17], v[16:17], v[122:123], v[122:123] op_sel:[0,0,1] op_sel_hi:[1,0,1]
    v_pk_fma_f32 v[18:19], v[18:19], v[122:123], v[122:123] op_sel:[0,0,1] op_sel_hi:[1,0,1]
    v_pk_fma_f32 v[20:21], v[20:21], v[122:123], v[122:123] op_sel:[0,0,1] op_sel_hi:[1,0,1]
    v_pk_fma_f32 v[22:23], v[22:23], v[122:123], v[122:123] op_sel:[0,0,1] op_sel_hi:[1,0,1]
    v_pk_fma_f32 v[16:17], v[16:17], v[48:49], v[56:57]
    v_pk_fma_f32 v[18:19], v[18:19], v[50:51], v[58:59]
    v_pk_fma_f32 v[20:21], v[20:21], v[52:53], v[60:61]
    v_pk_fma_f32 v[22:23], v[22:23], v[54:55], v[62:63]
    v_cvt_pk_bf16_f32 v24, v16, v17
    v_cvt_pk_bf16_f32 v25, v18, v19
    v_cvt_pk_bf16_f32 v26, v20, v21
    v_cvt_pk_bf16_f32 v27, v22, v23
    ds_write_b128 v9, v[24:27] offset:2176
    global_load_dwordx4 a[12:15], v13, s[50:51] offset:1024
    s_waitcnt vmcnt(15)
    v_lshlrev_b32 v28, 16, v212
    v_and_b32 v29, 0xffff0000, v212
    v_lshlrev_b32 v30, 16, v213
    v_and_b32 v31, 0xffff0000, v213
    v_lshlrev_b32 v32, 16, v214
    v_and_b32 v33, 0xffff0000, v214
    v_lshlrev_b32 v34, 16, v215
    v_and_b32 v35, 0xffff0000, v215
    v_pk_fma_f32 v[28:29], v[28:29], v[122:123], v[122:123] op_sel:[0,0,1] op_sel_hi:[1,0,1]
    v_pk_fma_f32 v[30:31], v[30:31], v[122:123], v[122:123] op_sel:[0,0,1] op_sel_hi:[1,0,1]
    v_pk_fma_f32 v[32:33], v[32:33], v[122:123], v[122:123] op_sel:[0,0,1] op_sel_hi:[1,0,1]
    v_pk_fma_f32 v[34:35], v[34:35], v[122:123], v[122:123] op_sel:[0,0,1] op_sel_hi:[1,0,1]
    v_pk_fma_f32 v[28:29], v[28:29], v[64:65], v[72:73]
    v_pk_fma_f32 v[30:31], v[30:31], v[66:67], v[74:75]
    v_pk_fma_f32 v[32:33], v[32:33], v[68:69], v[76:77]
    v_pk_fma_f32 v[34:35], v[34:35], v[70:71], v[78:79]
    v_cvt_pk_bf16_f32 v36, v28, v29
    v_cvt_pk_bf16_f32 v37, v30, v31
    v_cvt_pk_bf16_f32 v38, v32, v33
    v_cvt_pk_bf16_f32 v39, v34, v35
    ds_write_b128 v9, v[36:39] offset:10368
    global_load_dwordx4 v[132:135], v14, s[50:51]
    s_add_u32 s50, s50, 557056
    s_addc_u32 s51, s51, 0
    s_waitcnt vmcnt(15)
    v_lshlrev_b32 v16, 16, v216
    v_and_b32 v17, 0xffff0000, v216
    v_lshlrev_b32 v18, 16, v217
    v_and_b32 v19, 0xffff0000, v217
    v_lshlrev_b32 v20, 16, v218
    v_and_b32 v21, 0xffff0000, v218
    v_lshlrev_b32 v22, 16, v219
    v_and_b32 v23, 0xffff0000, v219
    v_pk_fma_f32 v[16:17], v[16:17], v[122:123], v[122:123] op_sel:[0,0,1] op_sel_hi:[1,0,1]
    v_pk_fma_f32 v[18:19], v[18:19], v[122:123], v[122:123] op_sel:[0,0,1] op_sel_hi:[1,0,1]
    v_pk_fma_f32 v[20:21], v[20:21], v[122:123], v[122:123] op_sel:[0,0,1] op_sel_hi:[1,0,1]
    v_pk_fma_f32 v[22:23], v[22:23], v[122:123], v[122:123] op_sel:[0,0,1] op_sel_hi:[1,0,1]
    v_pk_fma_f32 v[16:17], v[16:17], v[80:81], v[88:89]
    v_pk_fma_f32 v[18:19], v[18:19], v[82:83], v[90:91]
    v_pk_fma_f32 v[20:21], v[20:21], v[84:85], v[92:93]
    v_pk_fma_f32 v[22:23], v[22:23], v[86:87], v[94:95]
    v_cvt_pk_bf16_f32 v24, v16, v17
    v_cvt_pk_bf16_f32 v25, v18, v19
    v_cvt_pk_bf16_f32 v26, v20, v21
    v_cvt_pk_bf16_f32 v27, v22, v23
    ds_write_b128 v9, v[24:27] offset:18560
    global_load_dwordx4 a[16:19], v7, s[52:53] offset:0
    s_waitcnt vmcnt(15)
    v_lshlrev_b32 v28, 16, v220
    v_and_b32 v29, 0xffff0000, v220
    v_lshlrev_b32 v30, 16, v221
    v_and_b32 v31, 0xffff0000, v221
    v_lshlrev_b32 v32, 16, v222
    v_and_b32 v33, 0xffff0000, v222
    v_lshlrev_b32 v34, 16, v223
    v_and_b32 v35, 0xffff0000, v223
    v_pk_fma_f32 v[28:29], v[28:29], v[122:123], v[122:123] op_sel:[0,0,1] op_sel_hi:[1,0,1]
    v_pk_fma_f32 v[30:31], v[30:31], v[122:123], v[122:123] op_sel:[0,0,1] op_sel_hi:[1,0,1]
    v_pk_fma_f32 v[32:33], v[32:33], v[122:123], v[122:123] op_sel:[0,0,1] op_sel_hi:[1,0,1]
    v_pk_fma_f32 v[34:35], v[34:35], v[122:123], v[122:123] op_sel:[0,0,1] op_sel_hi:[1,0,1]
    v_pk_fma_f32 v[28:29], v[28:29], v[96:97], v[104:105]
    v_pk_fma_f32 v[30:31], v[30:31], v[98:99], v[106:107]
    v_pk_fma_f32 v[32:33], v[32:33], v[100:101], v[108:109]
    v_pk_fma_f32 v[34:35], v[34:35], v[102:103], v[110:111]
    v_cvt_pk_bf16_f32 v36, v28, v29
    v_cvt_pk_bf16_f32 v37, v30, v31
    v_cvt_pk_bf16_f32 v38, v32, v33
    v_cvt_pk_bf16_f32 v39, v34, v35
    ds_write_b128 v9, v[36:39] offset:26752
    global_load_dwordx4 a[20:23], v7, s[52:53] offset:1024
    s_waitcnt vmcnt(15)
    v_lshlrev_b32 v16, 16, v224
    v_and_b32 v17, 0xffff0000, v224
    v_lshlrev_b32 v18, 16, v225
    v_and_b32 v19, 0xffff0000, v225
    v_lshlrev_b32 v20, 16, v226
    v_and_b32 v21, 0xffff0000, v226
    v_lshlrev_b32 v22, 16, v227
    v_and_b32 v23, 0xffff0000, v227
    v_pk_fma_f32 v[16:17], v[16:17], v[124:125], v[124:125] op_sel:[0,0,1] op_sel_hi:[1,0,1]
    v_pk_fma_f32 v[18:19], v[18:19], v[124:125], v[124:125] op_sel:[0,0,1] op_sel_hi:[1,0,1]
    v_pk_fma_f32 v[20:21], v[20:21], v[124:125], v[124:125] op_sel:[0,0,1] op_sel_hi:[1,0,1]
    v_pk_fma_f32 v[22:23], v[22:23], v[124:125], v[124:125] op_sel:[0,0,1] op_sel_hi:[1,0,1]
    v_pk_fma_f32 v[16:17], v[16:17], v[48:49], v[56:57]
    v_pk_fma_f32 v[18:19], v[18:19], v[50:51], v[58:59]
    v_pk_fma_f32 v[20:21], v[20:21], v[52:53], v[60:61]
    v_pk_fma_f32 v[22:23], v[22:23], v[54:55], v[62:63]
    v_cvt_pk_bf16_f32 v24, v16, v17
    v_cvt_pk_bf16_f32 v25, v18, v19
    v_cvt_pk_bf16_f32 v26, v20, v21
    v_cvt_pk_bf16_f32 v27, v22, v23
    ds_write_b128 v9, v[24:27] offset:3072
    global_load_dwordx4 a[24:27], v13, s[52:53] offset:0
    s_waitcnt vmcnt(15)
    v_lshlrev_b32 v28, 16, v228
    v_and_b32 v29, 0xffff0000, v228
    v_lshlrev_b32 v30, 16, v229
    v_and_b32 v31, 0xffff0000, v229
    v_lshlrev_b32 v32, 16, v230
    v_and_b32 v33, 0xffff0000, v230
    v_lshlrev_b32 v34, 16, v231
    v_and_b32 v35, 0xffff0000, v231
    v_pk_fma_f32 v[28:29], v[28:29], v[124:125], v[124:125] op_sel:[0,0,1] op_sel_hi:[1,0,1]
    v_pk_fma_f32 v[30:31], v[30:31], v[124:125], v[124:125] op_sel:[0,0,1] op_sel_hi:[1,0,1]
    v_pk_fma_f32 v[32:33], v[32:33], v[124:125], v[124:125] op_sel:[0,0,1] op_sel_hi:[1,0,1]
    v_pk_fma_f32 v[34:35], v[34:35], v[124:125], v[124:125] op_sel:[0,0,1] op_sel_hi:[1,0,1]
    v_pk_fma_f32 v[28:29], v[28:29], v[64:65], v[72:73]
    v_pk_fma_f32 v[30:31], v[30:31], v[66:67], v[74:75]
    v_pk_fma_f32 v[32:33], v[32:33], v[68:69], v[76:77]
    v_pk_fma_f32 v[34:35], v[34:35], v[70:71], v[78:79]
    v_cvt_pk_bf16_f32 v36, v28, v29
    v_cvt_pk_bf16_f32 v37, v30, v31
    v_cvt_pk_bf16_f32 v38, v32, v33
    v_cvt_pk_bf16_f32 v39, v34, v35
    ds_write_b128 v9, v[36:39] offset:11264
    global_load_dwordx4 a[28:31], v13, s[52:53] offset:1024
    s_add_u32 s52, s52, 557056
    s_addc_u32 s53, s53, 0
    s_waitcnt vmcnt(15)
    v_lshlrev_b32 v16, 16, v232
    v_and_b32 v17, 0xffff0000, v232
    v_lshlrev_b32 v18, 16, v233
    v_and_b32 v19, 0xffff0000, v233
    v_lshlrev_b32 v20, 16, v234
    v_and_b32 v21, 0xffff0000, v234
    v_lshlrev_b32 v22, 16, v235
    v_and_b32 v23, 0xffff0000, v235
    v_pk_fma_f32 v[16:17], v[16:17], v[124:125], v[124:125] op_sel:[0,0,1] op_sel_hi:[1,0,1]
    v_pk_fma_f32 v[18:19], v[18:19], v[124:125], v[124:125] op_sel:[0,0,1] op_sel_hi:[1,0,1]
    v_pk_fma_f32 v[20:21], v[20:21], v[124:125], v[124:125] op_sel:[0,0,1] op_sel_hi:[1,0,1]
    v_pk_fma_f32 v[22:23], v[22:23], v[124:125], v[124:125] op_sel:[0,0,1] op_sel_hi:[1,0,1]
    v_pk_fma_f32 v[16:17], v[16:17], v[80:81], v[88:89]
    v_pk_fma_f32 v[18:19], v[18:19], v[82:83], v[90:91]
    v_pk_fma_f32 v[20:21], v[20:21], v[84:85], v[92:93]
    v_pk_fma_f32 v[22:23], v[22:23], v[86:87], v[94:95]
    v_cvt_pk_bf16_f32 v24, v16, v17
    v_cvt_pk_bf16_f32 v25, v18, v19
    v_cvt_pk_bf16_f32 v26, v20, v21
    v_cvt_pk_bf16_f32 v27, v22, v23
    ds_write_b128 v9, v[24:27] offset:19456
    global_load_dwordx4 a[32:35], v7, s[54:55] offset:0
    s_waitcnt vmcnt(15)
    v_lshlrev_b32 v28, 16, v236
    v_and_b32 v29, 0xffff0000, v236
    v_lshlrev_b32 v30, 16, v237
    v_and_b32 v31, 0xffff0000, v237
    v_lshlrev_b32 v32, 16, v238
    v_and_b32 v33, 0xffff0000, v238
    v_lshlrev_b32 v34, 16, v239
    v_and_b32 v35, 0xffff0000, v239
    v_pk_fma_f32 v[28:29], v[28:29], v[124:125], v[124:125] op_sel:[0,0,1] op_sel_hi:[1,0,1]
    v_pk_fma_f32 v[30:31], v[30:31], v[124:125], v[124:125] op_sel:[0,0,1] op_sel_hi:[1,0,1]
    v_pk_fma_f32 v[32:33], v[32:33], v[124:125], v[124:125] op_sel:[0,0,1] op_sel_hi:[1,0,1]
    v_pk_fma_f32 v[34:35], v[34:35], v[124:125], v[124:125] op_sel:[0,0,1] op_sel_hi:[1,0,1]
    v_pk_fma_f32 v[28:29], v[28:29], v[96:97], v[104:105]
    v_pk_fma_f32 v[30:31], v[30:31], v[98:99], v[106:107]
    v_pk_fma_f32 v[32:33], v[32:33], v[100:101], v[108:109]
    v_pk_fma_f32 v[34:35], v[34:35], v[102:103], v[110:111]
    v_cvt_pk_bf16_f32 v36, v28, v29
    v_cvt_pk_bf16_f32 v37, v30, v31
    v_cvt_pk_bf16_f32 v38, v32, v33
    v_cvt_pk_bf16_f32 v39, v34, v35
    ds_write_b128 v9, v[36:39] offset:27648
    global_load_dwordx4 a[36:39], v7, s[54:55] offset:1024
    s_waitcnt vmcnt(15)
    v_lshlrev_b32 v16, 16, v240
    v_and_b32 v17, 0xffff0000, v240
    v_lshlrev_b32 v18, 16, v241
    v_and_b32 v19, 0xffff0000, v241
    v_lshlrev_b32 v20, 16, v242
    v_and_b32 v21, 0xffff0000, v242
    v_lshlrev_b32 v22, 16, v243
    v_and_b32 v23, 0xffff0000, v243
    v_pk_fma_f32 v[16:17], v[16:17], v[126:127], v[126:127] op_sel:[0,0,1] op_sel_hi:[1,0,1]
    v_pk_fma_f32 v[18:19], v[18:19], v[126:127], v[126:127] op_sel:[0,0,1] op_sel_hi:[1,0,1]
    v_pk_fma_f32 v[20:21], v[20:21], v[126:127], v[126:127] op_sel:[0,0,1] op_sel_hi:[1,0,1]
    v_pk_fma_f32 v[22:23], v[22:23], v[126:127], v[126:127] op_sel:[0,0,1] op_sel_hi:[1,0,1]
    v_pk_fma_f32 v[16:17], v[16:17], v[48:49], v[56:57]
    v_pk_fma_f32 v[18:19], v[18:19], v[50:51], v[58:59]
    v_pk_fma_f32 v[20:21], v[20:21], v[52:53], v[60:61]
    v_pk_fma_f32 v[22:23], v[22:23], v[54:55], v[62:63]
    v_cvt_pk_bf16_f32 v24, v16, v17
    v_cvt_pk_bf16_f32 v25, v18, v19
    v_cvt_pk_bf16_f32 v26, v20, v21
    v_cvt_pk_bf16_f32 v27, v22, v23
    ds_write_b128 v9, v[24:27] offset:3200
    global_load_dwordx4 a[40:43], v13, s[54:55] offset:0
    s_waitcnt vmcnt(15)
    v_lshlrev_b32 v28, 16, v244
    v_and_b32 v29, 0xffff0000, v244
    v_lshlrev_b32 v30, 16, v245
    v_and_b32 v31, 0xffff0000, v245
    v_lshlrev_b32 v32, 16, v246
    v_and_b32 v33, 0xffff0000, v246
    v_lshlrev_b32 v34, 16, v247
    v_and_b32 v35, 0xffff0000, v247
    v_pk_fma_f32 v[28:29], v[28:29], v[126:127], v[126:127] op_sel:[0,0,1] op_sel_hi:[1,0,1]
    v_pk_fma_f32 v[30:31], v[30:31], v[126:127], v[126:127] op_sel:[0,0,1] op_sel_hi:[1,0,1]
    v_pk_fma_f32 v[32:33], v[32:33], v[126:127], v[126:127] op_sel:[0,0,1] op_sel_hi:[1,0,1]
    v_pk_fma_f32 v[34:35], v[34:35], v[126:127], v[126:127] op_sel:[0,0,1] op_sel_hi:[1,0,1]
    v_pk_fma_f32 v[28:29], v[28:29], v[64:65], v[72:73]
    v_pk_fma_f32 v[30:31], v[30:31], v[66:67], v[74:75]
    v_pk_fma_f32 v[32:33], v[32:33], v[68:69], v[76:77]
    v_pk_fma_f32 v[34:35], v[34:35], v[70:71], v[78:79]
    v_cvt_pk_bf16_f32 v36, v28, v29
    v_cvt_pk_bf16_f32 v37, v30, v31
    v_cvt_pk_bf16_f32 v38, v32, v33
    v_cvt_pk_bf16_f32 v39, v34, v35
    ds_write_b128 v9, v[36:39] offset:11392
    global_load_dwordx4 a[44:47], v13, s[54:55] offset:1024
    s_add_u32 s54, s54, 557056
    s_addc_u32 s55, s55, 0
    s_waitcnt vmcnt(15)
    v_lshlrev_b32 v16, 16, v248
    v_and_b32 v17, 0xffff0000, v248
    v_lshlrev_b32 v18, 16, v249
    v_and_b32 v19, 0xffff0000, v249
    v_lshlrev_b32 v20, 16, v250
    v_and_b32 v21, 0xffff0000, v250
    v_lshlrev_b32 v22, 16, v251
    v_and_b32 v23, 0xffff0000, v251
    v_pk_fma_f32 v[16:17], v[16:17], v[126:127], v[126:127] op_sel:[0,0,1] op_sel_hi:[1,0,1]
    v_pk_fma_f32 v[18:19], v[18:19], v[126:127], v[126:127] op_sel:[0,0,1] op_sel_hi:[1,0,1]
    v_pk_fma_f32 v[20:21], v[20:21], v[126:127], v[126:127] op_sel:[0,0,1] op_sel_hi:[1,0,1]
    v_pk_fma_f32 v[22:23], v[22:23], v[126:127], v[126:127] op_sel:[0,0,1] op_sel_hi:[1,0,1]
    v_pk_fma_f32 v[16:17], v[16:17], v[80:81], v[88:89]
    v_pk_fma_f32 v[18:19], v[18:19], v[82:83], v[90:91]
    v_pk_fma_f32 v[20:21], v[20:21], v[84:85], v[92:93]
    v_pk_fma_f32 v[22:23], v[22:23], v[86:87], v[94:95]
    v_cvt_pk_bf16_f32 v24, v16, v17
    v_cvt_pk_bf16_f32 v25, v18, v19
    v_cvt_pk_bf16_f32 v26, v20, v21
    v_cvt_pk_bf16_f32 v27, v22, v23
    ds_write_b128 v9, v[24:27] offset:19584
    global_load_dwordx4 a[48:51], v7, s[56:57] offset:0
    s_waitcnt vmcnt(15)
    v_lshlrev_b32 v28, 16, v252
    v_and_b32 v29, 0xffff0000, v252
    v_lshlrev_b32 v30, 16, v253
    v_and_b32 v31, 0xffff0000, v253
    v_lshlrev_b32 v32, 16, v254
    v_and_b32 v33, 0xffff0000, v254
    v_lshlrev_b32 v34, 16, v255
    v_and_b32 v35, 0xffff0000, v255
    v_pk_fma_f32 v[28:29], v[28:29], v[126:127], v[126:127] op_sel:[0,0,1] op_sel_hi:[1,0,1]
    v_pk_fma_f32 v[30:31], v[30:31], v[126:127], v[126:127] op_sel:[0,0,1] op_sel_hi:[1,0,1]
    v_pk_fma_f32 v[32:33], v[32:33], v[126:127], v[126:127] op_sel:[0,0,1] op_sel_hi:[1,0,1]
    v_pk_fma_f32 v[34:35], v[34:35], v[126:127], v[126:127] op_sel:[0,0,1] op_sel_hi:[1,0,1]
    v_pk_fma_f32 v[28:29], v[28:29], v[96:97], v[104:105]
    v_pk_fma_f32 v[30:31], v[30:31], v[98:99], v[106:107]
    v_pk_fma_f32 v[32:33], v[32:33], v[100:101], v[108:109]
    v_pk_fma_f32 v[34:35], v[34:35], v[102:103], v[110:111]
    v_cvt_pk_bf16_f32 v36, v28, v29
    v_cvt_pk_bf16_f32 v37, v30, v31
    v_cvt_pk_bf16_f32 v38, v32, v33
    v_cvt_pk_bf16_f32 v39, v34, v35
    ds_write_b128 v9, v[36:39] offset:27776
    global_load_dwordx4 a[52:55], v7, s[56:57] offset:1024
    v_and_b32 v2, 15, v1
    v_lshrrev_b32 v3, 4, v1
    v_xor_b32 v4, v2, v3
    v_lshlrev_b32 v5, 8, v3
    v_lshl_add_u32 v4, v4, 4, v5
    v_xor_b32 v5, 64, v4
    v_add_u32 v5, 0x1000, v5
    v_mov_b32 v80, 0
    v_mov_b32 v81, 0
    v_mov_b32 v82, 0
    v_mov_b32 v83, 0
    v_mov_b32 v84, 0
    v_mov_b32 v85, 0
    v_mov_b32 v86, 0
    v_mov_b32 v87, 0
    v_mov_b32 v88, 0
    v_mov_b32 v89, 0
    v_mov_b32 v90, 0
    v_mov_b32 v91, 0
    v_mov_b32 v92, 0
    v_mov_b32 v93, 0
    v_mov_b32 v94, 0
    v_mov_b32 v95, 0
    v_mov_b32 v96, 0
    v_mov_b32 v97, 0
    v_mov_b32 v98, 0
    v_mov_b32 v99, 0
    v_mov_b32 v100, 0
    v_mov_b32 v101, 0
    v_mov_b32 v102, 0
    v_mov_b32 v103, 0
    v_mov_b32 v104, 0
    v_mov_b32 v105, 0
    v_mov_b32 v106, 0
    v_mov_b32 v107, 0
    v_mov_b32 v108, 0
    v_mov_b32 v109, 0
    v_mov_b32 v110, 0
    v_mov_b32 v111, 0
    v_mov_b32 v112, 0
    v_mov_b32 v113, 0
    v_mov_b32 v114, 0
    v_mov_b32 v115, 0
    v_mov_b32 v116, 0
    v_mov_b32 v117, 0
    v_mov_b32 v118, 0
    v_mov_b32 v119, 0
    v_mov_b32 v120, 0
    v_mov_b32 v121, 0
    v_mov_b32 v122, 0
    v_mov_b32 v123, 0
    v_mov_b32 v124, 0
    v_mov_b32 v125, 0
    v_mov_b32 v126, 0
    v_mov_b32 v127, 0
    s_waitcnt lgkmcnt(0)
    s_barrier
    v_add_u32 v40, s12, v4
    v_add_u32 v41, s12, v5
    ds_read_b128 v[48:51], v40 offset:0
    ds_read_b128 v[52:55], v40 offset:1024
    ds_read_b128 v[56:59], v40 offset:2048
    ds_read_b128 v[60:63], v40 offset:3072
    ds_read_b128 v[64:67], v41 offset:0
    ds_read_b128 v[68:71], v41 offset:1024
    ds_read_b128 v[72:75], v41 offset:2048
    ds_read_b128 v[76:79], v41 offset:3072
    global_load_dwordx4 a[56:59], v13, s[56:57] offset:0
    s_waitcnt lgkmcnt(4)
    s_waitcnt vmcnt(14)
    v_mfma_f32_16x16x32_bf16 v[80:83], a[0:3], v[48:51], v[80:83]
    v_mfma_f32_16x16x32_bf16 v[84:87], a[4:7], v[48:51], v[84:87]
    v_mfma_f32_16x16x32_bf16 v[112:115], v[128:131], v[48:51], v[112:115]
    v_mfma_f32_16x16x32_bf16 v[88:91], a[0:3], v[52:55], v[88:91]
    v_mfma_f32_16x16x32_bf16 v[92:95], a[4:7], v[52:55], v[92:95]
    v_mfma_f32_16x16x32_bf16 v[116:119], v[128:131], v[52:55], v[116:119]
    global_load_dwordx4 a[60:63], v13, s[56:57] offset:1024
    s_add_u32 s56, s56, 557056
    s_addc_u32 s57, s57, 0
    v_mfma_f32_16x16x32_bf16 v[96:99], a[0:3], v[56:59], v[96:99]
    v_mfma_f32_16x16x32_bf16 v[100:103], a[4:7], v[56:59], v[100:103]
    v_mfma_f32_16x16x32_bf16 v[120:123], v[128:131], v[56:59], v[120:123]
    v_mfma_f32_16x16x32_bf16 v[104:107], a[0:3], v[60:63], v[104:107]
    v_mfma_f32_16x16x32_bf16 v[108:111], a[4:7], v[60:63], v[108:111]
    v_mfma_f32_16x16x32_bf16 v[124:127], v[128:131], v[60:63], v[124:127]
    global_load_dwordx4 a[64:67], v7, s[50:51] offset:0
    v_add_u32 v40, s13, v4
    v_add_u32 v41, s13, v5
    ds_read_b128 v[48:51], v40 offset:0
    ds_read_b128 v[52:55], v40 offset:1024
    ds_read_b128 v[56:59], v40 offset:2048
    ds_read_b128 v[60:63], v40 offset:3072
    global_load_dwordx4 a[68:71], v7, s[50:51] offset:1024
    s_waitcnt lgkmcnt(4)
    s_waitcnt vmcnt(14)
    v_mfma_f32_16x16x32_bf16 v[80:83], a[8:11], v[64:67], v[80:83]
    v_mfma_f32_16x16x32_bf16 v[84:87], a[12:15], v[64:67], v[84:87]
    v_mfma_f32_16x16x32_bf16 v[112:115], v[132:135], v[64:67], v[112:115]
    v_mfma_f32_16x16x32_bf16 v[88:91], a[8:11], v[68:71], v[88:91]
    v_mfma_f32_16x16x32_bf16 v[92:95], a[12:15], v[68:71], v[92:95]
    v_mfma_f32_16x16x32_bf16 v[116:119], v[132:135], v[68:71], v[116:119]
    global_load_dwordx4 v[136:139], v8, s[50:51]
    v_mfma_f32_16x16x32_bf16 v[96:99], a[8:11], v[72:75], v[96:99]
    v_mfma_f32_16x16x32_bf16 v[100:103], a[12:15], v[72:75], v[100:103]
    v_mfma_f32_16x16x32_bf16 v[120:123], v[132:135], v[72:75], v[120:123]
    v_mfma_f32_16x16x32_bf16 v[104:107], a[8:11], v[76:79], v[104:107]
    v_mfma_f32_16x16x32_bf16 v[108:111], a[12:15], v[76:79], v[108:111]
    v_mfma_f32_16x16x32_bf16 v[124:127], v[132:135], v[76:79], v[124:127]
    global_load_dwordx4 a[72:75], v13, s[50:51] offset:0
    ds_read_b128 v[64:67], v41 offset:0
    ds_read_b128 v[68:71], v41 offset:1024
    ds_read_b128 v[72:75], v41 offset:2048
    ds_read_b128 v[76:79], v41 offset:3072
    global_load_dwordx4 a[76:79], v13, s[50:51] offset:1024
    s_waitcnt lgkmcnt(4)
    s_waitcnt vmcnt(15)
    v_mfma_f32_16x16x32_bf16 v[80:83], a[16:19], v[48:51], v[80:83]
    v_mfma_f32_16x16x32_bf16 v[84:87], a[20:23], v[48:51], v[84:87]
    v_mfma_f32_16x16x32_bf16 v[88:91], a[16:19], v[52:55], v[88:91]
    v_mfma_f32_16x16x32_bf16 v[92:95], a[20:23], v[52:55], v[92:95]
    global_load_dwordx4 v[140:143], v14, s[50:51]
    s_add_u32 s50, s50, 557056
    s_addc_u32 s51, s51, 0
    v_mfma_f32_16x16x32_bf16 v[96:99], a[16:19], v[56:59], v[96:99]
    v_mfma_f32_16x16x32_bf16 v[100:103], a[20:23], v[56:59], v[100:103]
    v_mfma_f32_16x16x32_bf16 v[104:107], a[16:19], v[60:63], v[104:107]
    v_mfma_f32_16x16x32_bf16 v[108:111], a[20:23], v[60:63], v[108:111]
    global_load_dwordx4 a[80:83], v7, s[52:53] offset:0
    v_add_u32 v40, s14, v4
    v_add_u32 v41, s14, v5
    ds_read_b128 v[48:51], v40 offset:0
    ds_read_b128 v[52:55], v40 offset:1024
    ds_read_b128 v[56:59], v40 offset:2048
    ds_read_b128 v[60:63], v40 offset:3072
    global_load_dwordx4 a[84:87], v7, s[52:53] offset:1024
    s_waitcnt lgkmcnt(4)
    s_waitcnt vmcnt(16)
    v_mfma_f32_16x16x32_bf16 v[80:83], a[24:27], v[64:67], v[80:83]
    v_mfma_f32_16x16x32_bf16 v[84:87], a[28:31], v[64:67], v[84:87]
    v_mfma_f32_16x16x32_bf16 v[88:91], a[24:27], v[68:71], v[88:91]
    v_mfma_f32_16x16x32_bf16 v[92:95], a[28:31], v[68:71], v[92:95]
    global_load_dwordx4 a[88:91], v13, s[52:53] offset:0
    v_mfma_f32_16x16x32_bf16 v[96:99], a[24:27], v[72:75], v[96:99]
    v_mfma_f32_16x16x32_bf16 v[100:103], a[28:31], v[72:75], v[100:103]
    v_mfma_f32_16x16x32_bf16 v[104:107], a[24:27], v[76:79], v[104:107]
    v_mfma_f32_16x16x32_bf16 v[108:111], a[28:31], v[76:79], v[108:111]
    global_load_dwordx4 a[92:95], v13, s[52:53] offset:1024
    s_add_u32 s52, s52, 557056
    s_addc_u32 s53, s53, 0
    ds_read_b128 v[64:67], v41 offset:0
    ds_read_b128 v[68:71], v41 offset:1024
    ds_read_b128 v[72:75], v41 offset:2048
    ds_read_b128 v[76:79], v41 offset:3072
    global_load_dwordx4 a[96:99], v7, s[54:55] offset:0
    s_waitcnt lgkmcnt(4)
    s_waitcnt vmcnt(17)
    v_mfma_f32_16x16x32_bf16 v[80:83], a[32:35], v[48:51], v[80:83]
    v_mfma_f32_16x16x32_bf16 v[84:87], a[36:39], v[48:51], v[84:87]
    v_mfma_f32_16x16x32_bf16 v[88:91], a[32:35], v[52:55], v[88:91]
    v_mfma_f32_16x16x32_bf16 v[92:95], a[36:39], v[52:55], v[92:95]
    global_load_dwordx4 a[100:103], v7, s[54:55] offset:1024
    v_mfma_f32_16x16x32_bf16 v[96:99], a[32:35], v[56:59], v[96:99]
    v_mfma_f32_16x16x32_bf16 v[100:103], a[36:39], v[56:59], v[100:103]
    v_mfma_f32_16x16x32_bf16 v[104:107], a[32:35], v[60:63], v[104:107]
    v_mfma_f32_16x16x32_bf16 v[108:111], a[36:39], v[60:63], v[108:111]
    global_load_dwordx4 a[104:107], v13, s[54:55] offset:0
    v_add_u32 v40, s15, v4
    v_add_u32 v41, s15, v5
    ds_read_b128 v[48:51], v40 offset:0
    ds_read_b128 v[52:55], v40 offset:1024
    ds_read_b128 v[56:59], v40 offset:2048
    ds_read_b128 v[60:63], v40 offset:3072
    global_load_dwordx4 a[108:111], v13, s[54:55] offset:1024
    s_add_u32 s54, s54, 557056
    s_addc_u32 s55, s55, 0
    s_waitcnt lgkmcnt(4)
    s_waitcnt vmcnt(18)
    v_mfma_f32_16x16x32_bf16 v[80:83], a[40:43], v[64:67], v[80:83]
    v_mfma_f32_16x16x32_bf16 v[84:87], a[44:47], v[64:67], v[84:87]
    v_mfma_f32_16x16x32_bf16 v[88:91], a[40:43], v[68:71], v[88:91]
    v_mfma_f32_16x16x32_bf16 v[92:95], a[44:47], v[68:71], v[92:95]
    global_load_dwordx4 a[112:115], v7, s[56:57] offset:0
    v_mfma_f32_16x16x32_bf16 v[96:99], a[40:43], v[72:75], v[96:99]
    v_mfma_f32_16x16x32_bf16 v[100:103], a[44:47], v[72:75], v[100:103]
    v_mfma_f32_16x16x32_bf16 v[104:107], a[40:43], v[76:79], v[104:107]
    v_mfma_f32_16x16x32_bf16 v[108:111], a[44:47], v[76:79], v[108:111]
    global_load_dwordx4 a[116:119], v7, s[56:57] offset:1024
    ds_read_b128 v[64:67], v41 offset:0
    ds_read_b128 v[68:71], v41 offset:1024
    ds_read_b128 v[72:75], v41 offset:2048
    ds_read_b128 v[76:79], v41 offset:3072
    global_load_dwordx4 a[120:123], v13, s[56:57] offset:0
    s_waitcnt lgkmcnt(4)
    s_waitcnt vmcnt(19)
    v_mfma_f32_16x16x32_bf16 v[80:83], a[48:51], v[48:51], v[80:83]
    v_mfma_f32_16x16x32_bf16 v[84:87], a[52:55], v[48:51], v[84:87]
    v_mfma_f32_16x16x32_bf16 v[88:91], a[48:51], v[52:55], v[88:91]
    v_mfma_f32_16x16x32_bf16 v[92:95], a[52:55], v[52:55], v[92:95]
    global_load_dwordx4 a[124:127], v13, s[56:57] offset:1024
    s_add_u32 s56, s56, 557056
    s_addc_u32 s57, s57, 0
    v_mfma_f32_16x16x32_bf16 v[96:99], a[48:51], v[56:59], v[96:99]
    v_mfma_f32_16x16x32_bf16 v[100:103], a[52:55], v[56:59], v[100:103]
    v_mfma_f32_16x16x32_bf16 v[104:107], a[48:51], v[60:63], v[104:107]
    v_mfma_f32_16x16x32_bf16 v[108:111], a[52:55], v[60:63], v[108:111]
    global_load_dwordx4 a[128:131], v7, s[50:51] offset:0
    v_add_u32 v40, s12, v4
    v_add_u32 v41, s12, v5
    ds_read_b128 v[48:51], v40 offset:32768
    ds_read_b128 v[52:55], v40 offset:33792
    ds_read_b128 v[56:59], v40 offset:34816
    ds_read_b128 v[60:63], v40 offset:35840
    global_load_dwordx4 a[132:135], v7, s[50:51] offset:1024
    s_waitcnt lgkmcnt(4)
    s_waitcnt vmcnt(20)
    v_mfma_f32_16x16x32_bf16 v[80:83], a[56:59], v[64:67], v[80:83]
    v_mfma_f32_16x16x32_bf16 v[84:87], a[60:63], v[64:67], v[84:87]
    v_mfma_f32_16x16x32_bf16 v[88:91], a[56:59], v[68:71], v[88:91]
    v_mfma_f32_16x16x32_bf16 v[92:95], a[60:63], v[68:71], v[92:95]
    global_load_dwordx4 v[144:147], v8, s[50:51]
    v_mfma_f32_16x16x32_bf16 v[96:99], a[56:59], v[72:75], v[96:99]
    v_mfma_f32_16x16x32_bf16 v[100:103], a[60:63], v[72:75], v[100:103]
    v_mfma_f32_16x16x32_bf16 v[104:107], a[56:59], v[76:79], v[104:107]
    v_mfma_f32_16x16x32_bf16 v[108:111], a[60:63], v[76:79], v[108:111]
    global_load_dwordx4 a[136:139], v13, s[50:51] offset:0
    ds_read_b128 v[64:67], v41 offset:32768
    ds_read_b128 v[68:71], v41 offset:33792
    ds_read_b128 v[72:75], v41 offset:34816
    ds_read_b128 v[76:79], v41 offset:35840
    global_load_dwordx4 a[140:143], v13, s[50:51] offset:1024
    s_waitcnt lgkmcnt(4)
    s_waitcnt vmcnt(20)
    v_mfma_f32_16x16x32_bf16 v[80:83], a[64:67], v[48:51], v[80:83]
    v_mfma_f32_16x16x32_bf16 v[84:87], a[68:71], v[48:51], v[84:87]
    v_mfma_f32_16x16x32_bf16 v[112:115], v[136:139], v[48:51], v[112:115]
    v_mfma_f32_16x16x32_bf16 v[88:91], a[64:67], v[52:55], v[88:91]
    v_mfma_f32_16x16x32_bf16 v[92:95], a[68:71], v[52:55], v[92:95]
    v_mfma_f32_16x16x32_bf16 v[116:119], v[136:139], v[52:55], v[116:119]
    global_load_dwordx4 v[148:151], v14, s[50:51]
    s_add_u32 s50, s50, 557056
    s_addc_u32 s51, s51, 0
    v_mfma_f32_16x16x32_bf16 v[96:99], a[64:67], v[56:59], v[96:99]
    v_mfma_f32_16x16x32_bf16 v[100:103], a[68:71], v[56:59], v[100:103]
    v_mfma_f32_16x16x32_bf16 v[120:123], v[136:139], v[56:59], v[120:123]
    v_mfma_f32_16x16x32_bf16 v[104:107], a[64:67], v[60:63], v[104:107]
    v_mfma_f32_16x16x32_bf16 v[108:111], a[68:71], v[60:63], v[108:111]
    v_mfma_f32_16x16x32_bf16 v[124:127], v[136:139], v[60:63], v[124:127]
    global_load_dwordx4 a[144:147], v7, s[52:53] offset:0
    v_add_u32 v40, s13, v4
    v_add_u32 v41, s13, v5
    ds_read_b128 v[48:51], v40 offset:32768
    ds_read_b128 v[52:55], v40 offset:33792
    ds_read_b128 v[56:59], v40 offset:34816
    ds_read_b128 v[60:63], v40 offset:35840
    global_load_dwordx4 a[148:151], v7, s[52:53] offset:1024
    s_waitcnt lgkmcnt(4)
    s_waitcnt vmcnt(20)
    v_mfma_f32_16x16x32_bf16 v[80:83], a[72:75], v[64:67], v[80:83]
    v_mfma_f32_16x16x32_bf16 v[84:87], a[76:79], v[64:67], v[84:87]
    v_mfma_f32_16x16x32_bf16 v[112:115], v[140:143], v[64:67], v[112:115]
    v_mfma_f32_16x16x32_bf16 v[88:91], a[72:75], v[68:71], v[88:91]
    v_mfma_f32_16x16x32_bf16 v[92:95], a[76:79], v[68:71], v[92:95]
    v_mfma_f32_16x16x32_bf16 v[116:119], v[140:143], v[68:71], v[116:119]
    global_load_dwordx4 a[152:155], v13, s[52:53] offset:0
    v_mfma_f32_16x16x32_bf16 v[96:99], a[72:75], v[72:75], v[96:99]
    v_mfma_f32_16x16x32_bf16 v[100:103], a[76:79], v[72:75], v[100:103]
    v_mfma_f32_16x16x32_bf16 v[120:123], v[140:143], v[72:75], v[120:123]
    v_mfma_f32_16x16x32_bf16 v[104:107], a[72:75], v[76:79], v[104:107]
    v_mfma_f32_16x16x32_bf16 v[108:111], a[76:79], v[76:79], v[108:111]
    v_mfma_f32_16x16x32_bf16 v[124:127], v[140:143], v[76:79], v[124:127]
    global_load_dwordx4 a[156:159], v13, s[52:53] offset:1024
    s_add_u32 s52, s52, 557056
    s_addc_u32 s53, s53, 0
    ds_read_b128 v[64:67], v41 offset:32768
    ds_read_b128 v[68:71], v41 offset:33792
    ds_read_b128 v[72:75], v41 offset:34816
    ds_read_b128 v[76:79], v41 offset:35840
    global_load_dwordx4 a[160:163], v7, s[54:55] offset:0
    s_waitcnt lgkmcnt(4)
    s_waitcnt vmcnt(21)
    v_mfma_f32_16x16x32_bf16 v[80:83], a[80:83], v[48:51], v[80:83]
    v_mfma_f32_16x16x32_bf16 v[84:87], a[84:87], v[48:51], v[84:87]
    v_mfma_f32_16x16x32_bf16 v[88:91], a[80:83], v[52:55], v[88:91]
    v_mfma_f32_16x16x32_bf16 v[92:95], a[84:87], v[52:55], v[92:95]
    global_load_dwordx4 a[164:167], v7, s[54:55] offset:1024
    v_mfma_f32_16x16x32_bf16 v[96:99], a[80:83], v[56:59], v[96:99]
    v_mfma_f32_16x16x32_bf16 v[100:103], a[84:87], v[56:59], v[100:103]
    v_mfma_f32_16x16x32_bf16 v[104:107], a[80:83], v[60:63], v[104:107]
    v_mfma_f32_16x16x32_bf16 v[108:111], a[84:87], v[60:63], v[108:111]
    global_load_dwordx4 a[168:171], v13, s[54:55] offset:0
    v_add_u32 v40, s14, v4
    v_add_u32 v41, s14, v5
    ds_read_b128 v[48:51], v40 offset:32768
    ds_read_b128 v[52:55], v40 offset:33792
    ds_read_b128 v[56:59], v40 offset:34816
    ds_read_b128 v[60:63], v40 offset:35840
    global_load_dwordx4 a[172:175], v13, s[54:55] offset:1024
    s_add_u32 s54, s54, 557056
    s_addc_u32 s55, s55, 0
    s_waitcnt lgkmcnt(4)
    s_waitcnt vmcnt(22)
    v_mfma_f32_16x16x32_bf16 v[80:83], a[88:91], v[64:67], v[80:83]
    v_mfma_f32_16x16x32_bf16 v[84:87], a[92:95], v[64:67], v[84:87]
    v_mfma_f32_16x16x32_bf16 v[88:91], a[88:91], v[68:71], v[88:91]
    v_mfma_f32_16x16x32_bf16 v[92:95], a[92:95], v[68:71], v[92:95]
    global_load_dwordx4 a[176:179], v7, s[56:57] offset:0
    v_mfma_f32_16x16x32_bf16 v[96:99], a[88:91], v[72:75], v[96:99]
    v_mfma_f32_16x16x32_bf16 v[100:103], a[92:95], v[72:75], v[100:103]
    v_mfma_f32_16x16x32_bf16 v[104:107], a[88:91], v[76:79], v[104:107]
    v_mfma_f32_16x16x32_bf16 v[108:111], a[92:95], v[76:79], v[108:111]
    global_load_dwordx4 a[180:183], v7, s[56:57] offset:1024
    ds_read_b128 v[64:67], v41 offset:32768
    ds_read_b128 v[68:71], v41 offset:33792
    ds_read_b128 v[72:75], v41 offset:34816
    ds_read_b128 v[76:79], v41 offset:35840
    global_load_dwordx4 a[184:187], v13, s[56:57] offset:0
    s_waitcnt lgkmcnt(4)
    s_waitcnt vmcnt(23)
    v_mfma_f32_16x16x32_bf16 v[80:83], a[96:99], v[48:51], v[80:83]
    v_mfma_f32_16x16x32_bf16 v[84:87], a[100:103], v[48:51], v[84:87]
    v_mfma_f32_16x16x32_bf16 v[88:91], a[96:99], v[52:55], v[88:91]
    v_mfma_f32_16x16x32_bf16 v[92:95], a[100:103], v[52:55], v[92:95]
    global_load_dwordx4 a[188:191], v13, s[56:57] offset:1024
    s_add_u32 s56, s56, 557056
    s_addc_u32 s57, s57, 0
    v_mfma_f32_16x16x32_bf16 v[96:99], a[96:99], v[56:59], v[96:99]
    v_mfma_f32_16x16x32_bf16 v[100:103], a[100:103], v[56:59], v[100:103]
    v_mfma_f32_16x16x32_bf16 v[104:107], a[96:99], v[60:63], v[104:107]
    v_mfma_f32_16x16x32_bf16 v[108:111], a[100:103], v[60:63], v[108:111]
    global_load_dwordx4 a[192:195], v7, s[50:51] offset:0
    v_add_u32 v40, s15, v4
    v_add_u32 v41, s15, v5
    ds_read_b128 v[48:51], v40 offset:32768
    ds_read_b128 v[52:55], v40 offset:33792
    ds_read_b128 v[56:59], v40 offset:34816
    ds_read_b128 v[60:63], v40 offset:35840
    global_load_dwordx4 a[196:199], v7, s[50:51] offset:1024
    s_waitcnt lgkmcnt(4)
    s_waitcnt vmcnt(24)
    v_mfma_f32_16x16x32_bf16 v[80:83], a[104:107], v[64:67], v[80:83]
    v_mfma_f32_16x16x32_bf16 v[84:87], a[108:111], v[64:67], v[84:87]
    v_mfma_f32_16x16x32_bf16 v[88:91], a[104:107], v[68:71], v[88:91]
    v_mfma_f32_16x16x32_bf16 v[92:95], a[108:111], v[68:71], v[92:95]
    global_load_dwordx4 v[152:155], v8, s[50:51]
    v_mfma_f32_16x16x32_bf16 v[96:99], a[104:107], v[72:75], v[96:99]
    v_mfma_f32_16x16x32_bf16 v[100:103], a[108:111], v[72:75], v[100:103]
    v_mfma_f32_16x16x32_bf16 v[104:107], a[104:107], v[76:79], v[104:107]
    v_mfma_f32_16x16x32_bf16 v[108:111], a[108:111], v[76:79], v[108:111]
    global_load_dwordx4 a[200:203], v13, s[50:51] offset:0
    ds_read_b128 v[64:67], v41 offset:32768
    ds_read_b128 v[68:71], v41 offset:33792
    ds_read_b128 v[72:75], v41 offset:34816
    ds_read_b128 v[76:79], v41 offset:35840
    global_load_dwordx4 a[204:207], v13, s[50:51] offset:1024
    s_waitcnt lgkmcnt(4)
    s_waitcnt vmcnt(25)
    v_mfma_f32_16x16x32_bf16 v[80:83], a[112:115], v[48:51], v[80:83]
    v_mfma_f32_16x16x32_bf16 v[84:87], a[116:119], v[48:51], v[84:87]
    v_mfma_f32_16x16x32_bf16 v[88:91], a[112:115], v[52:55], v[88:91]
    v_mfma_f32_16x16x32_bf16 v[92:95], a[116:119], v[52:55], v[92:95]
    global_load_dwordx4 v[156:159], v14, s[50:51]
    s_add_u32 s50, s50, 557056
    s_addc_u32 s51, s51, 0
    v_mfma_f32_16x16x32_bf16 v[96:99], a[112:115], v[56:59], v[96:99]
    v_mfma_f32_16x16x32_bf16 v[100:103], a[116:119], v[56:59], v[100:103]
    v_mfma_f32_16x16x32_bf16 v[104:107], a[112:115], v[60:63], v[104:107]
    v_mfma_f32_16x16x32_bf16 v[108:111], a[116:119], v[60:63], v[108:111]
    global_load_dwordx4 a[208:211], v7, s[52:53] offset:0
    v_add_u32 v4, 0x10000, v4
    v_add_u32 v5, 0x10000, v5
    v_add_u32 v40, s12, v4
    v_add_u32 v41, s12, v5
    ds_read_b128 v[48:51], v40 offset:0
    ds_read_b128 v[52:55], v40 offset:1024
    ds_read_b128 v[56:59], v40 offset:2048
    ds_read_b128 v[60:63], v40 offset:3072
    global_load_dwordx4 a[212:215], v7, s[52:53] offset:1024
    s_waitcnt lgkmcnt(4)
    s_waitcnt vmcnt(26)
    v_mfma_f32_16x16x32_bf16 v[80:83], a[120:123], v[64:67], v[80:83]
    v_mfma_f32_16x16x32_bf16 v[84:87], a[124:127], v[64:67], v[84:87]
    v_mfma_f32_16x16x32_bf16 v[88:91], a[120:123], v[68:71], v[88:91]
    v_mfma_f32_16x16x32_bf16 v[92:95], a[124:127], v[68:71], v[92:95]
    global_load_dwordx4 a[216:219], v13, s[52:53] offset:0
    v_mfma_f32_16x16x32_bf16 v[96:99], a[120:123], v[72:75], v[96:99]
    v_mfma_f32_16x16x32_bf16 v[100:103], a[124:127], v[72:75], v[100:103]
    v_mfma_f32_16x16x32_bf16 v[104:107], a[120:123], v[76:79], v[104:107]
    v_mfma_f32_16x16x32_bf16 v[108:111], a[124:127], v[76:79], v[108:111]
    global_load_dwordx4 a[220:223], v13, s[52:53] offset:1024
    s_add_u32 s52, s52, 557056
    s_addc_u32 s53, s53, 0
    ds_read_b128 v[64:67], v41 offset:0
    ds_read_b128 v[68:71], v41 offset:1024
    ds_read_b128 v[72:75], v41 offset:2048
    ds_read_b128 v[76:79], v41 offset:3072
    global_load_dwordx4 a[224:227], v7, s[54:55] offset:0
    s_waitcnt lgkmcnt(4)
    s_waitcnt vmcnt(26)
    v_mfma_f32_16x16x32_bf16 v[80:83], a[128:131], v[48:51], v[80:83]
    v_mfma_f32_16x16x32_bf16 v[84:87], a[132:135], v[48:51], v[84:87]
    v_mfma_f32_16x16x32_bf16 v[112:115], v[144:147], v[48:51], v[112:115]
    v_mfma_f32_16x16x32_bf16 v[88:91], a[128:131], v[52:55], v[88:91]
    v_mfma_f32_16x16x32_bf16 v[92:95], a[132:135], v[52:55], v[92:95]
    v_mfma_f32_16x16x32_bf16 v[116:119], v[144:147], v[52:55], v[116:119]
    global_load_dwordx4 a[228:231], v7, s[54:55] offset:1024
    v_mfma_f32_16x16x32_bf16 v[96:99], a[128:131], v[56:59], v[96:99]
    v_mfma_f32_16x16x32_bf16 v[100:103], a[132:135], v[56:59], v[100:103]
    v_mfma_f32_16x16x32_bf16 v[120:123], v[144:147], v[56:59], v[120:123]
    v_mfma_f32_16x16x32_bf16 v[104:107], a[128:131], v[60:63], v[104:107]
    v_mfma_f32_16x16x32_bf16 v[108:111], a[132:135], v[60:63], v[108:111]
    v_mfma_f32_16x16x32_bf16 v[124:127], v[144:147], v[60:63], v[124:127]
    global_load_dwordx4 a[232:235], v13, s[54:55] offset:0
    v_add_u32 v40, s13, v4
    v_add_u32 v41, s13, v5
    ds_read_b128 v[48:51], v40 offset:0
    ds_read_b128 v[52:55], v40 offset:1024
    ds_read_b128 v[56:59], v40 offset:2048
    ds_read_b128 v[60:63], v40 offset:3072
    global_load_dwordx4 a[236:239], v13, s[54:55] offset:1024
    s_add_u32 s54, s54, 557056
    s_addc_u32 s55, s55, 0
    s_waitcnt lgkmcnt(4)
    s_waitcnt vmcnt(26)
    v_mfma_f32_16x16x32_bf16 v[80:83], a[136:139], v[64:67], v[80:83]
    v_mfma_f32_16x16x32_bf16 v[84:87], a[140:143], v[64:67], v[84:87]
    v_mfma_f32_16x16x32_bf16 v[112:115], v[148:151], v[64:67], v[112:115]
    v_mfma_f32_16x16x32_bf16 v[88:91], a[136:139], v[68:71], v[88:91]
    v_mfma_f32_16x16x32_bf16 v[92:95], a[140:143], v[68:71], v[92:95]
    v_mfma_f32_16x16x32_bf16 v[116:119], v[148:151], v[68:71], v[116:119]
    global_load_dwordx4 a[240:243], v7, s[56:57] offset:0
    v_mfma_f32_16x16x32_bf16 v[96:99], a[136:139], v[72:75], v[96:99]
    v_mfma_f32_16x16x32_bf16 v[100:103], a[140:143], v[72:75], v[100:103]
    v_mfma_f32_16x16x32_bf16 v[120:123], v[148:151], v[72:75], v[120:123]
    v_mfma_f32_16x16x32_bf16 v[104:107], a[136:139], v[76:79], v[104:107]
    v_mfma_f32_16x16x32_bf16 v[108:111], a[140:143], v[76:79], v[108:111]
    v_mfma_f32_16x16x32_bf16 v[124:127], v[148:151], v[76:79], v[124:127]
    global_load_dwordx4 a[244:247], v7, s[56:57] offset:1024
    ds_read_b128 v[64:67], v41 offset:0
    ds_read_b128 v[68:71], v41 offset:1024
    ds_read_b128 v[72:75], v41 offset:2048
    ds_read_b128 v[76:79], v41 offset:3072
    global_load_dwordx4 a[248:251], v13, s[56:57] offset:0
    s_waitcnt lgkmcnt(4)
    s_waitcnt vmcnt(27)
    v_mfma_f32_16x16x32_bf16 v[80:83], a[144:147], v[48:51], v[80:83]
    v_mfma_f32_16x16x32_bf16 v[84:87], a[148:151], v[48:51], v[84:87]
    v_mfma_f32_16x16x32_bf16 v[88:91], a[144:147], v[52:55], v[88:91]
    v_mfma_f32_16x16x32_bf16 v[92:95], a[148:151], v[52:55], v[92:95]
    global_load_dwordx4 a[252:255], v13, s[56:57] offset:1024
    s_add_u32 s56, s56, 557056
    s_addc_u32 s57, s57, 0
    v_mfma_f32_16x16x32_bf16 v[96:99], a[144:147], v[56:59], v[96:99]
    v_mfma_f32_16x16x32_bf16 v[100:103], a[148:151], v[56:59], v[100:103]
    v_mfma_f32_16x16x32_bf16 v[104:107], a[144:147], v[60:63], v[104:107]
    v_mfma_f32_16x16x32_bf16 v[108:111], a[148:151], v[60:63], v[108:111]
    v_add_u32 v40, s14, v4
    v_add_u32 v41, s14, v5
    ds_read_b128 v[48:51], v40 offset:0
    ds_read_b128 v[52:55], v40 offset:1024
    ds_read_b128 v[56:59], v40 offset:2048
    ds_read_b128 v[60:63], v40 offset:3072
    s_waitcnt lgkmcnt(4)
    s_waitcnt vmcnt(26)
    v_mfma_f32_16x16x32_bf16 v[80:83], a[152:155], v[64:67], v[80:83]
    v_mfma_f32_16x16x32_bf16 v[84:87], a[156:159], v[64:67], v[84:87]
    v_mfma_f32_16x16x32_bf16 v[88:91], a[152:155], v[68:71], v[88:91]
    v_mfma_f32_16x16x32_bf16 v[92:95], a[156:159], v[68:71], v[92:95]
    v_mfma_f32_16x16x32_bf16 v[96:99], a[152:155], v[72:75], v[96:99]
    v_mfma_f32_16x16x32_bf16 v[100:103], a[156:159], v[72:75], v[100:103]
    v_mfma_f32_16x16x32_bf16 v[104:107], a[152:155], v[76:79], v[104:107]
    v_mfma_f32_16x16x32_bf16 v[108:111], a[156:159], v[76:79], v[108:111]
    ds_read_b128 v[64:67], v41 offset:0
    ds_read_b128 v[68:71], v41 offset:1024
    ds_read_b128 v[72:75], v41 offset:2048
    ds_read_b128 v[76:79], v41 offset:3072
    s_cmp_lg_u32 s2, 255
    s_cbranch_scc1 qkv_nofin
    s_lshl_b32 s6, s3, 11
    s_add_u32 s6, s6, 12288
    s_add_u32 s44, s42, s6
    s_addc_u32 s45, s43, 0
    v_lshlrev_b32 v42, 5, v1
    global_load_dwordx4 a[0:3], v42, s[44:45]
    global_load_dwordx4 a[4:7], v42, s[44:45] offset:16
    s_add_u32 s44, s44, 24576
    s_addc_u32 s45, s45, 0
    global_load_dwordx4 a[8:11], v42, s[44:45]
    global_load_dwordx4 a[12:15], v42, s[44:45] offset:16
    s_add_u32 s44, s44, 24576
    s_addc_u32 s45, s45, 0
    global_load_dwordx4 a[16:19], v42, s[44:45]
    global_load_dwordx4 a[20:23], v42, s[44:45] offset:16
    s_add_u32 s44, s44, 24576
    s_addc_u32 s45, s45, 0
    global_load_dwordx4 a[24:27], v42, s[44:45]
    global_load_dwordx4 a[28:31], v42, s[44:45] offset:16
qkv_nofin:
    s_waitcnt lgkmcnt(4)
    s_waitcnt vmcnt(24)
    v_mfma_f32_16x16x32_bf16 v[80:83], a[160:163], v[48:51], v[80:83]
    v_mfma_f32_16x16x32_bf16 v[84:87], a[164:167], v[48:51], v[84:87]
    v_mfma_f32_16x16x32_bf16 v[88:91], a[160:163], v[52:55], v[88:91]
    v_mfma_f32_16x16x32_bf16 v[92:95], a[164:167], v[52:55], v[92:95]
    v_mfma_f32_16x16x32_bf16 v[96:99], a[160:163], v[56:59], v[96:99]
    v_mfma_f32_16x16x32_bf16 v[100:103], a[164:167], v[56:59], v[100:103]
    v_mfma_f32_16x16x32_bf16 v[104:107], a[160:163], v[60:63], v[104:107]
    v_mfma_f32_16x16x32_bf16 v[108:111], a[164:167], v[60:63], v[108:111]
    v_add_u32 v40, s15, v4
    v_add_u32 v41, s15, v5
    ds_read_b128 v[48:51], v40 offset:0
    ds_read_b128 v[52:55], v40 offset:1024
    ds_read_b128 v[56:59], v40 offset:2048
    ds_read_b128 v[60:63], v40 offset:3072
    s_waitcnt lgkmcnt(4)
    s_waitcnt vmcnt(22)
    v_mfma_f32_16x16x32_bf16 v[80:83], a[168:171], v[64:67], v[80:83]
    v_mfma_f32_16x16x32_bf16 v[84:87], a[172:175], v[64:67], v[84:87]
    v_mfma_f32_16x16x32_bf16 v[88:91], a[168:171], v[68:71], v[88:91]
    v_mfma_f32_16x16x32_bf16 v[92:95], a[172:175], v[68:71], v[92:95]
    v_mfma_f32_16x16x32_bf16 v[96:99], a[168:171], v[72:75], v[96:99]
    v_mfma_f32_16x16x32_bf16 v[100:103], a[172:175], v[72:75], v[100:103]
    v_mfma_f32_16x16x32_bf16 v[104:107], a[168:171], v[76:79], v[104:107]
    v_mfma_f32_16x16x32_bf16 v[108:111], a[172:175], v[76:79], v[108:111]
    ds_read_b128 v[64:67], v41 offset:0
    ds_read_b128 v[68:71], v41 offset:1024
    ds_read_b128 v[72:75], v41 offset:2048
    ds_read_b128 v[76:79], v41 offset:3072
    s_waitcnt lgkmcnt(4)
    s_waitcnt vmcnt(20)
    v_mfma_f32_16x16x32_bf16 v[80:83], a[176:179], v[48:51], v[80:83]
    v_mfma_f32_16x16x32_bf16 v[84:87], a[180:183], v[48:51], v[84:87]
    v_mfma_f32_16x16x32_bf16 v[88:91], a[176:179], v[52:55], v[88:91]
    v_mfma_f32_16x16x32_bf16 v[92:95], a[180:183], v[52:55], v[92:95]
    v_mfma_f32_16x16x32_bf16 v[96:99], a[176:179], v[56:59], v[96:99]
    v_mfma_f32_16x16x32_bf16 v[100:103], a[180:183], v[56:59], v[100:103]
    v_mfma_f32_16x16x32_bf16 v[104:107], a[176:179], v[60:63], v[104:107]
    v_mfma_f32_16x16x32_bf16 v[108:111], a[180:183], v[60:63], v[108:111]
    v_add_u32 v40, s12, v4
    v_add_u32 v41, s12, v5
    ds_read_b128 v[48:51], v40 offset:32768
    ds_read_b128 v[52:55], v40 offset:33792
    ds_read_b128 v[56:59], v40 offset:34816
    ds_read_b128 v[60:63], v40 offset:35840
    s_waitcnt lgkmcnt(4)
    s_waitcnt vmcnt(18)
    v_mfma_f32_16x16x32_bf16 v[80:83], a[184:187], v[64:67], v[80:83]
    v_mfma_f32_16x16x32_bf16 v[84:87], a[188:191], v[64:67], v[84:87]
    v_mfma_f32_16x16x32_bf16 v[88:91], a[184:187], v[68:71], v[88:91]
    v_mfma_f32_16x16x32_bf16 v[92:95], a[188:191], v[68:71], v[92:95]
    v_mfma_f32_16x16x32_bf16 v[96:99], a[184:187], v[72:75], v[96:99]
    v_mfma_f32_16x16x32_bf16 v[100:103], a[188:191], v[72:75], v[100:103]
    v_mfma_f32_16x16x32_bf16 v[104:107], a[184:187], v[76:79], v[104:107]
    v_mfma_f32_16x16x32_bf16 v[108:111], a[188:191], v[76:79], v[108:111]
    ds_read_b128 v[64:67], v41 offset:32768
    ds_read_b128 v[68:71], v41 offset:33792
    ds_read_b128 v[72:75], v41 offset:34816
    ds_read_b128 v[76:79], v41 offset:35840
    s_waitcnt lgkmcnt(4)
    s_waitcnt vmcnt(15)
    v_mfma_f32_16x16x32_bf16 v[80:83], a[192:195], v[48:51], v[80:83]
    v_mfma_f32_16x16x32_bf16 v[84:87], a[196:199], v[48:51], v[84:87]
    v_mfma_f32_16x16x32_bf16 v[112:115], v[152:155], v[48:51], v[112:115]
    v_mfma_f32_16x16x32_bf16 v[88:91], a[192:195], v[52:55], v[88:91]
    v_mfma_f32_16x16x32_bf16 v[92:95], a[196:199], v[52:55], v[92:95]
    v_mfma_f32_16x16x32_bf16 v[116:119], v[152:155], v[52:55], v[116:119]
    v_mfma_f32_16x16x32_bf16 v[96:99], a[192:195], v[56:59], v[96:99]
    v_mfma_f32_16x16x32_bf16 v[100:103], a[196:199], v[56:59], v[100:103]
    v_mfma_f32_16x16x32_bf16 v[120:123], v[152:155], v[56:59], v[120:123]
    v_mfma_f32_16x16x32_bf16 v[104:107], a[192:195], v[60:63], v[104:107]
    v_mfma_f32_16x16x32_bf16 v[108:111], a[196:199], v[60:63], v[108:111]
    v_mfma_f32_16x16x32_bf16 v[124:127], v[152:155], v[60:63], v[124:127]
    v_add_u32 v40, s13, v4
    v_add_u32 v41, s13, v5
    ds_read_b128 v[48:51], v40 offset:32768
    ds_read_b128 v[52:55], v40 offset:33792
    ds_read_b128 v[56:59], v40 offset:34816
    ds_read_b128 v[60:63], v40 offset:35840
    s_waitcnt lgkmcnt(4)
    s_waitcnt vmcnt(12)
    v_mfma_f32_16x16x32_bf16 v[80:83], a[200:203], v[64:67], v[80:83]
    v_mfma_f32_16x16x32_bf16 v[84:87], a[204:207], v[64:67], v[84:87]
    v_mfma_f32_16x16x32_bf16 v[112:115], v[156:159], v[64:67], v[112:115]
    v_mfma_f32_16x16x32_bf16 v[88:91], a[200:203], v[68:71], v[88:91]
    v_mfma_f32_16x16x32_bf16 v[92:95], a[204:207], v[68:71], v[92:95]
    v_mfma_f32_16x16x32_bf16 v[116:119], v[156:159], v[68:71], v[116:119]
    v_mfma_f32_16x16x32_bf16 v[96:99], a[200:203], v[72:75], v[96:99]
    v_mfma_f32_16x16x32_bf16 v[100:103], a[204:207], v[72:75], v[100:103]
    v_mfma_f32_16x16x32_bf16 v[120:123], v[156:159], v[72:75], v[120:123]
    v_mfma_f32_16x16x32_bf16 v[104:107], a[200:203], v[76:79], v[104:107]
    v_mfma_f32_16x16x32_bf16 v[108:111], a[204:207], v[76:79], v[108:111]
    v_mfma_f32_16x16x32_bf16 v[124:127], v[156:159], v[76:79], v[124:127]
    ds_read_b128 v[64:67], v41 offset:32768
    ds_read_b128 v[68:71], v41 offset:33792
    ds_read_b128 v[72:75], v41 offset:34816
    ds_read_b128 v[76:79], v41 offset:35840
    s_waitcnt lgkmcnt(4)
    s_waitcnt vmcnt(10)
    v_mfma_f32_16x16x32_bf16 v[80:83], a[208:211], v[48:51], v[80:83]
    v_mfma_f32_16x16x32_bf16 v[84:87], a[212:215], v[48:51], v[84:87]
    v_mfma_f32_16x16x32_bf16 v[88:91], a[208:211], v[52:55], v[88:91]
    v_mfma_f32_16x16x32_bf16 v[92:95], a[212:215], v[52:55], v[92:95]
    v_mfma_f32_16x16x32_bf16 v[96:99], a[208:211], v[56:59], v[96:99]
    v_mfma_f32_16x16x32_bf16 v[100:103], a[212:215], v[56:59], v[100:103]
    v_mfma_f32_16x16x32_bf16 v[104:107], a[208:211], v[60:63], v[104:107]
    v_mfma_f32_16x16x32_bf16 v[108:111], a[212:215], v[60:63], v[108:111]
    v_add_u32 v40, s14, v4
    v_add_u32 v41, s14, v5
    ds_read_b128 v[48:51], v40 offset:32768
    ds_read_b128 v[52:55], v40 offset:33792
    ds_read_b128 v[56:59], v40 offset:34816
    ds_read_b128 v[60:63], v40 offset:35840
    s_waitcnt lgkmcnt(4)
    s_waitcnt vmcnt(8)
    v_mfma_f32_16x16x32_bf16 v[80:83], a[216:219], v[64:67], v[80:83]
    v_mfma_f32_16x16x32_bf16 v[84:87], a[220:223], v[64:67], v[84:87]
    v_mfma_f32_16x16x32_bf16 v[88:91], a[216:219], v[68:71], v[88:91]
    v_mfma_f32_16x16x32_bf16 v[92:95], a[220:223], v[68:71], v[92:95]
    v_mfma_f32_16x16x32_bf16 v[96:99], a[216:219], v[72:75], v[96:99]
    v_mfma_f32_16x16x32_bf16 v[100:103], a[220:223], v[72:75], v[100:103]
    v_mfma_f32_16x16x32_bf16 v[104:107], a[216:219], v[76:79], v[104:107]
    v_mfma_f32_16x16x32_bf16 v[108:111], a[220:223], v[76:79], v[108:111]
    ds_read_b128 v[64:67], v41 offset:32768
    ds_read_b128 v[68:71], v41 offset:33792
    ds_read_b128 v[72:75], v41 offset:34816
    ds_read_b128 v[76:79], v41 offset:35840
    s_waitcnt lgkmcnt(4)
    s_waitcnt vmcnt(6)
    v_mfma_f32_16x16x32_bf16 v[80:83], a[224:227], v[48:51], v[80:83]
    v_mfma_f32_16x16x32_bf16 v[84:87], a[228:231], v[48:51], v[84:87]
    v_mfma_f32_16x16x32_bf16 v[88:91], a[224:227], v[52:55], v[88:91]
    v_mfma_f32_16x16x32_bf16 v[92:95], a[228:231], v[52:55], v[92:95]
    v_mfma_f32_16x16x32_bf16 v[96:99], a[224:227], v[56:59], v[96:99]
    v_mfma_f32_16x16x32_bf16 v[100:103], a[228:231], v[56:59], v[100:103]
    v_mfma_f32_16x16x32_bf16 v[104:107], a[224:227], v[60:63], v[104:107]
    v_mfma_f32_16x16x32_bf16 v[108:111], a[228:231], v[60:63], v[108:111]
    v_add_u32 v40, s15, v4
    v_add_u32 v41, s15, v5
    ds_read_b128 v[48:51], v40 offset:32768
    ds_read_b128 v[52:55], v40 offset:33792
    ds_read_b128 v[56:59], v40 offset:34816
    ds_read_b128 v[60:63], v40 offset:35840
    s_waitcnt lgkmcnt(4)
    s_waitcnt vmcnt(4)
    v_mfma_f32_16x16x32_bf16 v[80:83], a[232:235], v[64:67], v[80:83]
    v_mfma_f32_16x16x32_bf16 v[84:87], a[236:239], v[64:67], v[84:87]
    v_mfma_f32_16x16x32_bf16 v[88:91], a[232:235], v[68:71], v[88:91]
    v_mfma_f32_16x16x32_bf16 v[92:95], a[236:239], v[68:71], v[92:95]
    v_mfma_f32_16x16x32_bf16 v[96:99], a[232:235], v[72:75], v[96:99]
    v_mfma_f32_16x16x32_bf16 v[100:103], a[236:239], v[72:75], v[100:103]
    v_mfma_f32_16x16x32_bf16 v[104:107], a[232:235], v[76:79], v[104:107]
    v_mfma_f32_16x16x32_bf16 v[108:111], a[236:239], v[76:79], v[108:111]
    ds_read_b128 v[64:67], v41 offset:32768
    ds_read_b128 v[68:71], v41 offset:33792
    ds_read_b128 v[72:75], v41 offset:34816
    ds_read_b128 v[76:79], v41 offset:35840
    s_waitcnt lgkmcnt(4)
    s_waitcnt vmcnt(2)
    v_mfma_f32_16x16x32_bf16 v[80:83], a[240:243], v[48:51], v[80:83]
    v_mfma_f32_16x16x32_bf16 v[84:87], a[244:247], v[48:51], v[84:87]
    v_mfma_f32_16x16x32_bf16 v[88:91], a[240:243], v[52:55], v[88:91]
    v_mfma_f32_16x16x32_bf16 v[92:95], a[244:247], v[52:55], v[92:95]
    v_mfma_f32_16x16x32_bf16 v[96:99], a[240:243], v[56:59], v[96:99]
    v_mfma_f32_16x16x32_bf16 v[100:103], a[244:247], v[56:59], v[100:103]
    v_mfma_f32_16x16x32_bf16 v[104:107], a[240:243], v[60:63], v[104:107]
    v_mfma_f32_16x16x32_bf16 v[108:111], a[244:247], v[60:63], v[108:111]
    s_waitcnt lgkmcnt(0)
    s_waitcnt vmcnt(0)
    v_mfma_f32_16x16x32_bf16 v[80:83], a[248:251], v[64:67], v[80:83]
    v_mfma_f32_16x16x32_bf16 v[84:87], a[252:255], v[64:67], v[84:87]
    v_mfma_f32_16x16x32_bf16 v[88:91], a[248:251], v[68:71], v[88:91]
    v_mfma_f32_16x16x32_bf16 v[92:95], a[252:255], v[68:71], v[92:95]
    v_mfma_f32_16x16x32_bf16 v[96:99], a[248:251], v[72:75], v[96:99]
    v_mfma_f32_16x16x32_bf16 v[100:103], a[252:255], v[72:75], v[100:103]
    v_mfma_f32_16x16x32_bf16 v[104:107], a[248:251], v[76:79], v[104:107]
    v_mfma_f32_16x16x32_bf16 v[108:111], a[252:255], v[76:79], v[108:111]
    s_cmp_ge_u32 s5, 4
    s_cbranch_scc1 qkv_q
    s_lshl_b32 s6, s3, 12
    s_add_u32 s6, s6, 131072
    v_add_u32 v40, s6, v7
    ds_write_b128 v40, v[112:115] offset:0
    ds_write_b128 v40, v[116:119] offset:1024
    ds_write_b128 v40, v[120:123] offset:2048
    ds_write_b128 v40, v[124:127] offset:3072
    s_lshl_b32 s6, s3, 10
    s_add_u32 s6, s6, 131072
    v_add_u32 v40, s6, v7
    v_lshrrev_b32 v41, 2, v2
    v_lshlrev_b32 v41, 8, v41
    v_lshl_add_u32 v41, v3, 6, v41
    v_and_b32 v6, 3, v2
    v_lshl_add_u32 v41, v6, 2, v41
    v_add_u32 v41, s6, v41
    s_waitcnt lgkmcnt(0)
    s_barrier
    s_cmp_ge_u32 s5, 2
    s_cbranch_scc1 qkv_vr
    ds_read_b128 v[112:115], v40 offset:0
    ds_read_b128 v[116:119], v40 offset:4096
    ds_read_b128 v[120:123], v40 offset:8192
    ds_read_b128 v[124:127], v40 offset:12288
    s_branch qkv_q
qkv_vr:
    ds_read2_b32 v[112:113], v41 offset0:0 offset1:4
    ds_read2_b32 v[114:115], v41 offset0:8 offset1:12
    v_add_u32 v41, 0x1000, v41
    ds_read2_b32 v[116:117], v41 offset0:0 offset1:4
    ds_read2_b32 v[118:119], v41 offset0:8 offset1:12
    v_add_u32 v41, 0x1000, v41
    ds_read2_b32 v[120:121], v41 offset0:0 offset1:4
    ds_read2_b32 v[122:123], v41 offset0:8 offset1:12
    v_add_u32 v41, 0x1000, v41
    ds_read2_b32 v[124:125], v41 offset0:0 offset1:4
    ds_read2_b32 v[126:127], v41 offset0:8 offset1:12
qkv_q:
    v_and_b32 v4, 1, v3
    v_lshlrev_b32 v4, 10, v4
    v_lshrrev_b32 v5, 1, v3
    v_lshl_add_u32 v5, v5, 5, v2
    v_lshl_add_u32 v4, v5, 4, v4
    s_lshl_b32 s6, s5, 2
    s_add_u32 s6, s6, s3
    s_lshl_b32 s6, s6, 6
    s_lshl_b32 s7, s4, 1
    s_add_u32 s6, s6, s7
    s_lshl_b32 s6, s6, 11
    s_add_u32 s6, s6, 6291456
    s_mov_b32 s9, 0x3e8293ee
    s_add_u32 s44, s42, s6
    s_addc_u32 s45, s43, 0
    v_mul_f32 v80, s9, v80
    v_mul_f32 v81, s9, v81
    v_mul_f32 v82, s9, v82
    v_mul_f32 v83, s9, v83
    v_mul_f32 v84, s9, v84
    v_mul_f32 v85, s9, v85
    v_mul_f32 v86, s9, v86
    v_mul_f32 v87, s9, v87
    v_cvt_pk_bf16_f32 v16, v80, v81
    v_cvt_pk_bf16_f32 v17, v82, v83
    v_cvt_pk_bf16_f32 v18, v84, v85
    v_cvt_pk_bf16_f32 v19, v86, v87
    s_nop 0
    v_permlane16_swap_b32 v16, v18
    v_permlane16_swap_b32 v17, v19
    global_store_dwordx4 v4, v[16:19], s[44:45] offset:0 sc1
    v_mul_f32 v88, s9, v88
    v_mul_f32 v89, s9, v89
    v_mul_f32 v90, s9, v90
    v_mul_f32 v91, s9, v91
    v_mul_f32 v92, s9, v92
    v_mul_f32 v93, s9, v93
    v_mul_f32 v94, s9, v94
    v_mul_f32 v95, s9, v95
    v_cvt_pk_bf16_f32 v20, v88, v89
    v_cvt_pk_bf16_f32 v21, v90, v91
    v_cvt_pk_bf16_f32 v22, v92, v93
    v_cvt_pk_bf16_f32 v23, v94, v95
    s_nop 0
    v_permlane16_swap_b32 v20, v22
    v_permlane16_swap_b32 v21, v23
    global_store_dwordx4 v4, v[20:23], s[44:45] offset:256 sc1
    v_mul_f32 v96, s9, v96
    v_mul_f32 v97, s9, v97
    v_mul_f32 v98, s9, v98
    v_mul_f32 v99, s9, v99
    v_mul_f32 v100, s9, v100
    v_mul_f32 v101, s9, v101
    v_mul_f32 v102, s9, v102
    v_mul_f32 v103, s9, v103
    v_cvt_pk_bf16_f32 v24, v96, v97
    v_cvt_pk_bf16_f32 v25, v98, v99
    v_cvt_pk_bf16_f32 v26, v100, v101
    v_cvt_pk_bf16_f32 v27, v102, v103
    s_nop 0
    v_permlane16_swap_b32 v24, v26
    v_permlane16_swap_b32 v25, v27
    global_store_dwordx4 v4, v[24:27], s[44:45] offset:2048 sc1
    v_mul_f32 v104, s9, v104
    v_mul_f32 v105, s9, v105
    v_mul_f32 v106, s9, v106
    v_mul_f32 v107, s9, v107
    v_mul_f32 v108, s9, v108
    v_mul_f32 v109, s9, v109
    v_mul_f32 v110, s9, v110
    v_mul_f32 v111, s9, v111
    v_cvt_pk_bf16_f32 v28, v104, v105
    v_cvt_pk_bf16_f32 v29, v106, v107
    v_cvt_pk_bf16_f32 v30, v108, v109
    v_cvt_pk_bf16_f32 v31, v110, v111
    s_nop 0
    v_permlane16_swap_b32 v28, v30
    v_permlane16_swap_b32 v29, v31
    global_store_dwordx4 v4, v[28:31], s[44:45] offset:2304 sc1
    s_cmp_ge_u32 s5, 4
    s_cbranch_scc1 qkv_fin
    s_waitcnt lgkmcnt(0)
    v_add_f32 v112, v112, v116
    v_add_f32 v120, v120, v124
    v_add_f32 v113, v113, v117
    v_add_f32 v121, v121, v125
    v_add_f32 v114, v114, v118
    v_add_f32 v122, v122, v126
    v_add_f32 v115, v115, v119
    v_add_f32 v123, v123, v127
    v_add_f32 v112, v112, v120
    v_add_f32 v113, v113, v121
    v_add_f32 v114, v114, v122
    v_add_f32 v115, v115, v123
    v_cvt_pk_bf16_f32 v32, v112, v113
    v_cvt_pk_bf16_f32 v33, v114, v115
    s_lshl_b32 s6, s4, 1
    s_lshr_b32 s7, s3, 1
    s_add_u32 s6, s6, s7
    s_lshl_b32 s6, s6, 12
    s_add_u32 s6, s6, 786432
    s_and_b32 s7, s3, 1
    s_and_b32 s8, s5, 1
    s_cmp_ge_u32 s5, 2
    s_cbranch_scc1 qkv_v
    s_lshl_b32 s9, s8, 10
    s_lshl_b32 s10, s7, 8
    s_add_u32 s6, s6, s9
    s_add_u32 s6, s6, s10
    s_add_u32 s44, s42, s6
    s_addc_u32 s45, s43, 0
    v_lshlrev_b32 v5, 4, v5
    v_and_b32 v6, 1, v3
    v_lshl_add_u32 v5, v6, 3, v5
    global_store_dwordx2 v5, v[32:33], s[44:45] sc1
    v_lshlrev_b32 v34, 16, v32
    v_and_b32 v35, 0xffff0000, v32
    v_lshlrev_b32 v36, 16, v33
    v_and_b32 v37, 0xffff0000, v33
    v_mul_f32 v34, v34, v34
    v_fmac_f32 v34, v35, v35
    v_fmac_f32 v34, v36, v36
    v_fmac_f32 v34, v37, v37
    v_mov_b32 v35, v34
    s_nop 1
    v_permlane16_swap_b32 v34, v35
    v_add_f32 v34, v34, v35
    v_mov_b32 v35, v34
    s_nop 1
    v_permlane32_swap_b32 v34, v35
    v_add_f32 v34, v34, v35
    s_nop 1
    v_max_f32 v34, v34, v34 quad_perm:[1,0,3,2] row_mask:0xf bank_mask:0xf
    s_nop 1
    v_max_f32 v34, v34, v34 quad_perm:[2,3,0,1] row_mask:0xf bank_mask:0xf
    s_nop 1
    v_max_f32 v34, v34, v34 row_half_mirror row_mask:0xf bank_mask:0xf
    s_nop 1
    v_max_f32 v34, v34, v34 row_mirror row_mask:0xf bank_mask:0xf
    s_lshl_b32 s6, s8, 9
    s_lshl_b32 s9, s4, 4
    s_lshl_b32 s10, s3, 2
    s_add_u32 s6, s6, s9
    s_add_u32 s6, s6, s10
    s_add_u32 s6, s6, 163840
    s_add_u32 s44, s42, s6
    s_addc_u32 s45, s43, 0
    v_mov_b32 v5, 0
    s_mov_b64 exec, 1
    global_store_dword v5, v34, s[44:45] sc1
    s_endpgm
qkv_v:
    s_lshl_b32 s9, s7, 10
    s_lshl_b32 s10, s8, 8
    s_add_u32 s6, s6, s9
    s_add_u32 s6, s6, s10
    s_add_u32 s6, s6, 2048
    s_add_u32 s44, s42, s6
    s_addc_u32 s45, s43, 0
    v_lshlrev_b32 v5, 4, v2
    v_and_b32 v6, 1, v3
    v_lshl_add_u32 v5, v6, 9, v5
    v_lshrrev_b32 v6, 1, v3
    v_lshl_add_u32 v5, v6, 3, v5
    global_store_dwordx2 v5, v[32:33], s[44:45] sc1
    s_endpgm
qkv_fin:
    s_cmp_lg_u32 s2, 255
    s_cbranch_scc1 qkv_end
    s_waitcnt vmcnt(0)
    v_accvgpr_read_b32 v48, a0
    v_accvgpr_read_b32 v49, a1
    v_accvgpr_read_b32 v50, a2
    v_accvgpr_read_b32 v51, a3
    v_accvgpr_read_b32 v52, a4
    v_accvgpr_read_b32 v53, a5
    v_accvgpr_read_b32 v54, a6
    v_accvgpr_read_b32 v55, a7
    v_accvgpr_read_b32 v56, a8
    v_accvgpr_read_b32 v57, a9
    v_accvgpr_read_b32 v58, a10
    v_accvgpr_read_b32 v59, a11
    v_accvgpr_read_b32 v60, a12
    v_accvgpr_read_b32 v61, a13
    v_accvgpr_read_b32 v62, a14
    v_accvgpr_read_b32 v63, a15
    v_accvgpr_read_b32 v64, a16
    v_accvgpr_read_b32 v65, a17
    v_accvgpr_read_b32 v66, a18
    v_accvgpr_read_b32 v67, a19
    v_accvgpr_read_b32 v68, a20
    v_accvgpr_read_b32 v69, a21
    v_accvgpr_read_b32 v70, a22
    v_accvgpr_read_b32 v71, a23
    v_accvgpr_read_b32 v72, a24
    v_accvgpr_read_b32 v73, a25
    v_accvgpr_read_b32 v74, a26
    v_accvgpr_read_b32 v75, a27
    v_accvgpr_read_b32 v76, a28
    v_accvgpr_read_b32 v77, a29
    v_accvgpr_read_b32 v78, a30
    v_accvgpr_read_b32 v79, a31
    v_add_f32 v48, v48, v56
    v_add_f32 v64, v64, v72
    v_add_f32 v49, v49, v57
    v_add_f32 v65, v65, v73
    v_add_f32 v50, v50, v58
    v_add_f32 v66, v66, v74
    v_add_f32 v51, v51, v59
    v_add_f32 v67, v67, v75
    v_add_f32 v52, v52, v60
    v_add_f32 v68, v68, v76
    v_add_f32 v53, v53, v61
    v_add_f32 v69, v69, v77
    v_add_f32 v54, v54, v62
    v_add_f32 v70, v70, v78
    v_add_f32 v55, v55, v63
    v_add_f32 v71, v71, v79
    v_add_f32 v48, v48, v64
    v_add_f32 v49, v49, v65
    v_add_f32 v50, v50, v66
    v_add_f32 v51, v51, v67
    v_add_f32 v52, v52, v68
    v_add_f32 v53, v53, v69
    v_add_f32 v54, v54, v70
    v_add_f32 v55, v55, v71
    s_cmp_ge_u32 s3, 2
    s_cselect_b32 s6, 1.0, 0
    s_cselect_b32 s7, 0, 2048
    v_cvt_pk_bf16_f32 v48, v48, v48
    v_lshlrev_b32 v48, 16, v48
    v_cvt_pk_bf16_f32 v49, v49, v49
    v_lshlrev_b32 v49, 16, v49
    v_cvt_pk_bf16_f32 v50, v50, v50
    v_lshlrev_b32 v50, 16, v50
    v_cvt_pk_bf16_f32 v51, v51, v51
    v_lshlrev_b32 v51, 16, v51
    v_cvt_pk_bf16_f32 v52, v52, v52
    v_lshlrev_b32 v52, 16, v52
    v_cvt_pk_bf16_f32 v53, v53, v53
    v_lshlrev_b32 v53, 16, v53
    v_cvt_pk_bf16_f32 v54, v54, v54
    v_lshlrev_b32 v54, 16, v54
    v_cvt_pk_bf16_f32 v55, v55, v55
    v_lshlrev_b32 v55, 16, v55
    v_add_f32 v48, s6, v48
    v_add_f32 v49, s6, v49
    v_add_f32 v50, s6, v50
    v_add_f32 v51, s6, v51
    v_add_f32 v52, s6, v52
    v_add_f32 v53, s6, v53
    v_add_f32 v54, s6, v54
    v_add_f32 v55, s6, v55
    v_cvt_pk_bf16_f32 v56, v48, v49
    v_cvt_pk_bf16_f32 v57, v50, v51
    v_cvt_pk_bf16_f32 v58, v52, v53
    v_cvt_pk_bf16_f32 v59, v54, v55
    v_lshlrev_b32 v48, 16, v56
    v_and_b32 v49, 0xffff0000, v56
    v_lshlrev_b32 v50, 16, v57
    v_and_b32 v51, 0xffff0000, v57
    v_lshlrev_b32 v52, 16, v58
    v_and_b32 v53, 0xffff0000, v58
    v_lshlrev_b32 v54, 16, v59
    v_and_b32 v55, 0xffff0000, v59
    s_and_b32 s8, s3, 1
    s_lshl_b32 s8, s8, 10
    s_add_u32 s7, s7, s8
    s_add_u32 s7, s7, 122880
    s_add_u32 s44, s42, s7
    s_addc_u32 s45, s43, 0
    global_store_dwordx4 v7, v[56:59], s[44:45] sc1
    s_lshl_b32 s6, s3, 11
    s_add_u32 s6, s6, 110592
    s_add_u32 s44, s42, s6
    s_addc_u32 s45, s43, 0
    global_store_dwordx4 v42, v[48:51], s[44:45] sc1
    global_store_dwordx4 v42, v[52:55], s[44:45] offset:16 sc1
qkv_end:
    s_endpgm
.globl attn_kernel
.p2align 8
.type attn_kernel,@function
attn_kernel:
    s_load_dwordx16 s[16:31], s[0:1], 0
    s_load_dwordx8 s[32:39], s[0:1], 64
    s_load_dwordx4 s[40:43], s[0:1], 96
    v_and_b32 v1, 63, v0
    v_lshrrev_b32 v2, 6, v0
    s_nop 0
    v_readfirstlane_b32 s3, v2
    s_cmp_ge_u32 s2, 256
    s_cbranch_scc1 attn_end
    s_cmp_ge_u32 s3, 8
    s_cbranch_scc1 attn_help
    s_lshr_b32 s4, s2, 3
    s_and_b32 s5, s2, 7
    s_lshl_b32 s5, s5, 3
    s_add_u32 s5, s5, s3
    v_lshlrev_b32 v2, 4, v1
    v_lshlrev_b32 v3, 3, v1
    s_lshl_b32 s6, s4, 6
    s_add_u32 s6, s6, s5
    s_lshl_b32 s6, s6, 11
    s_add_u32 s6, s6, 6291456
    s_lshl_b32 s12, s3, 11
    v_add_u32 v4, s12, v2
    s_waitcnt lgkmcnt(0)
    s_add_u32 s44, s42, s6
    s_addc_u32 s45, s43, 0
    s_add_u32 s46, s42, 163840
    s_addc_u32 s47, s43, 0
    s_add_u32 s50, s42, 786432
    s_addc_u32 s51, s43, 0
    global_load_dwordx2 v[128:129], v3, s[46:47]
    global_load_dwordx2 v[132:133], v3, s[46:47] offset:512
    global_load_dwordx4 v[8:11], v2, s[44:45]
    global_load_dwordx4 v[12:15], v2, s[44:45] offset:1024
    s_mov_b32 s14, 0
    s_add_u32 m0, s14, s12
    s_nop 0
    global_load_lds_dwordx4 v4, s[50:51] offset:0
    global_load_lds_dwordx4 v4, s[50:51] offset:1024
    s_add_u32 s50, s50, 16384
    s_addc_u32 s51, s51, 0
    s_add_u32 s14, s14, 16384
    s_cmp_eq_u32 s14, 114688
    s_cselect_b32 s14, 0, s14
    v_lshrrev_b32 v5, 4, v1
    v_xor_b32 v5, v5, v1
    v_and_b32 v5, 1, v5
    v_cmp_eq_u32 vcc, 0, v5
    v_mov_b32 v6, 0x3f803f80
    s_nop 0
    v_cndmask_b32 v92, 0, v6, vcc
    v_cndmask_b32 v93, 0, v6, vcc
    v_cndmask_b32 v94, 0, v6, vcc
    v_cndmask_b32 v95, 0, v6, vcc
    v_mov_b32 v72, 0
    v_mov_b32 v73, 0
    v_mov_b32 v74, 0
    v_mov_b32 v75, 0
    v_mov_b32 v76, 0
    v_mov_b32 v77, 0
    v_mov_b32 v78, 0
    v_mov_b32 v79, 0
    v_mov_b32 v80, 0
    v_mov_b32 v81, 0
    v_mov_b32 v82, 0
    v_mov_b32 v83, 0
    v_mov_b32 v84, 0
    v_mov_b32 v85, 0
    v_mov_b32 v86, 0
    v_mov_b32 v87, 0
    v_mov_b32 v88, 0
    v_mov_b32 v89, 0
    v_mov_b32 v90, 0
    v_mov_b32 v91, 0
    v_mov_b32 v68, 0
    v_mov_b32 v69, 0
    v_mov_b32 v70, 0
    v_mov_b32 v71, 0
    v_mov_b32 v124, 0
    v_mov_b32 v125, 0
    v_mov_b32 v126, 0
    v_mov_b32 v127, 0
    s_waitcnt vmcnt(4)
    v_add_f32 v128, v128, v132
    v_add_f32 v129, v129, v133
    v_max_f32 v128, v128, v129
    s_nop 1
    v_max_f32 v128, v128, v128 quad_perm:[1,0,3,2] row_mask:0xf bank_mask:0xf
    s_nop 1
    v_max_f32 v128, v128, v128 quad_perm:[2,3,0,1] row_mask:0xf bank_mask:0xf
    s_nop 1
    v_max_f32 v128, v128, v128 row_half_mirror row_mask:0xf bank_mask:0xf
    s_nop 1
    v_max_f32 v128, v128, v128 row_mirror row_mask:0xf bank_mask:0xf
    v_mov_b32 v129, v128
    s_nop 1
    v_permlane16_swap_b32 v128, v129
    v_max_f32 v128, v128, v129
    v_mov_b32 v129, v128
    s_nop 1
    v_permlane32_swap_b32 v128, v129
    v_max_f32 v128, v128, v129
    v_mov_b32 v3, 147456
    v_mov_b32 v157, 1
    s_mov_b32 s12, 8
    s_mov_b32 s13, 2
    s_waitcnt vmcnt(2)
    v_lshlrev_b32 v136, 16, v8
    v_and_b32 v137, 0xffff0000, v8
    v_lshlrev_b32 v138, 16, v9
    v_and_b32 v139, 0xffff0000, v9
    v_lshlrev_b32 v140, 16, v10
    v_and_b32 v141, 0xffff0000, v10
    v_lshlrev_b32 v142, 16, v11
    v_and_b32 v143, 0xffff0000, v11
    v_lshlrev_b32 v144, 16, v12
    v_and_b32 v145, 0xffff0000, v12
    v_lshlrev_b32 v146, 16, v13
    v_and_b32 v147, 0xffff0000, v13
    v_lshlrev_b32 v148, 16, v14
    v_and_b32 v149, 0xffff0000, v14
    v_lshlrev_b32 v150, 16, v15
    v_and_b32 v151, 0xffff0000, v15
    v_mul_f32 v130, v136, v136
    v_fmac_f32 v130, v137, v137
    v_fmac_f32 v130, v138, v138
    v_fmac_f32 v130, v139, v139
    v_fmac_f32 v130, v140, v140
    v_fmac_f32 v130, v141, v141
    v_fmac_f32 v130, v142, v142
    v_fmac_f32 v130, v143, v143
    v_fmac_f32 v130, v144, v144
    v_fmac_f32 v130, v145, v145
    v_fmac_f32 v130, v146, v146
    v_fmac_f32 v130, v147, v147
    v_fmac_f32 v130, v148, v148
    v_fmac_f32 v130, v149, v149
    v_fmac_f32 v130, v150, v150
    v_fmac_f32 v130, v151, v151
    v_mov_b32 v131, v130
    s_nop 1
    v_permlane32_swap_b32 v130, v131
    v_add_f32 v130, v130, v131
    v_mul_f32 v130, v130, v128
    v_sqrt_f32 v130, v130
    s_nop 0
    v_mul_f32 v130, 0xbf8020c5, v130
    v_mov_b32 v16, v130
    v_mov_b32 v17, v130
    v_mov_b32 v18, v130
    v_mov_b32 v19, v130
    v_mov_b32 v20, v130
    v_mov_b32 v21, v130
    v_mov_b32 v22, v130
    v_mov_b32 v23, v130
    v_mov_b32 v24, v130
    v_mov_b32 v25, v130
    v_mov_b32 v26, v130
    v_mov_b32 v27, v130
    v_mov_b32 v28, v130
    v_mov_b32 v29, v130
    v_mov_b32 v30, v130
    v_mov_b32 v31, v130
    v_mov_b32 v6, v2
    v_add_u32 v7, 16384, v2
    s_mov_b32 s15, 32768
    s_waitcnt vmcnt(0) lgkmcnt(0)
    s_barrier
    ds_read_b128 v[96:99], v6 offset:0
    ds_read_b128 v[100:103], v6 offset:1024
    ds_read_b128 v[104:107], v6 offset:4096
    ds_read_b128 v[108:111], v6 offset:5120
    ds_read_b128 v[112:115], v6 offset:2048
    ds_read_b128 v[116:119], v6 offset:3072
    s_waitcnt lgkmcnt(4)
    v_mfma_f32_32x32x16_bf16 v[32:47], v[96:99], v[8:11], v[16:31]
    v_mfma_f32_32x32x16_bf16 v[32:47], v[100:103], v[12:15], v[32:47]
    s_nop 7
    s_mov_b32 s11, 0
attn_loop:
    s_waitcnt lgkmcnt(0)
    s_mov_b64 exec, 1
    ds_add_u32 v3, v157 offset:4
    s_mov_b64 exec, -1
    s_setprio 1
    v_mfma_f32_32x32x16_bf16 v[48:63], v[104:107], v[8:11], v[16:31]
    ds_read_b128 v[96:99], v6 offset:8192
    ds_read_b128 v[100:103], v6 offset:9216
    v_exp_f32 v32, v32
    v_exp_f32 v33, v33
    v_exp_f32 v34, v34
    v_exp_f32 v35, v35
    v_mfma_f32_32x32x16_bf16 v[72:87], v[124:127], v[68:71], v[72:87]
    ds_read_b128 v[120:123], v6 offset:6144
    ds_read_b128 v[124:127], v6 offset:7168
    v_exp_f32 v36, v36
    v_exp_f32 v37, v37
    v_exp_f32 v38, v38
    v_exp_f32 v39, v39
    v_mfma_f32_32x32x16_bf16 v[48:63], v[108:111], v[12:15], v[48:63]
    v_cvt_pk_bf16_f32 v64, v32, v33
    v_cvt_pk_bf16_f32 v65, v34, v35
    v_cvt_pk_bf16_f32 v66, v36, v37
    v_cvt_pk_bf16_f32 v67, v38, v39
    v_exp_f32 v40, v40
    v_exp_f32 v41, v41
    v_mfma_f32_16x16x32_bf16 v[88:91], v[92:95], v[68:71], v[88:91]
    v_exp_f32 v42, v42
    v_exp_f32 v43, v43
    v_mfma_f32_32x32x16_bf16 v[72:87], v[112:115], v[64:67], v[72:87]
    v_exp_f32 v44, v44
    v_exp_f32 v45, v45
    v_exp_f32 v46, v46
    v_exp_f32 v47, v47
    v_mfma_f32_16x16x32_bf16 v[88:91], v[92:95], v[64:67], v[88:91]
    v_cvt_pk_bf16_f32 v68, v40, v41
    v_cvt_pk_bf16_f32 v69, v42, v43
    v_cvt_pk_bf16_f32 v70, v44, v45
    v_cvt_pk_bf16_f32 v71, v46, v47
    s_waitcnt lgkmcnt(0)
    s_setprio 0
    v_mfma_f32_32x32x16_bf16 v[32:47], v[96:99], v[8:11], v[16:31]
    ds_read_b128 v[104:107], v6 offset:12288
    ds_read_b128 v[108:111], v6 offset:13312
    v_exp_f32 v48, v48
    v_exp_f32 v49, v49
    v_exp_f32 v50, v50
    v_exp_f32 v51, v51
    v_mfma_f32_32x32x16_bf16 v[72:87], v[116:119], v[68:71], v[72:87]
    ds_read_b128 v[112:115], v6 offset:10240
    ds_read_b128 v[116:119], v6 offset:11264
    v_exp_f32 v52, v52
    v_exp_f32 v53, v53
    v_exp_f32 v54, v54
    v_exp_f32 v55, v55
    v_mfma_f32_32x32x16_bf16 v[32:47], v[100:103], v[12:15], v[32:47]
    v_cvt_pk_bf16_f32 v64, v48, v49
    v_cvt_pk_bf16_f32 v65, v50, v51
    v_cvt_pk_bf16_f32 v66, v52, v53
    v_cvt_pk_bf16_f32 v67, v54, v55
    v_exp_f32 v56, v56
    v_exp_f32 v57, v57
    v_mfma_f32_16x16x32_bf16 v[88:91], v[92:95], v[68:71], v[88:91]
    v_exp_f32 v58, v58
    v_exp_f32 v59, v59
    v_mfma_f32_32x32x16_bf16 v[72:87], v[120:123], v[64:67], v[72:87]
    ds_read_b64 v[158:159], v3
    v_exp_f32 v60, v60
    v_exp_f32 v61, v61
    v_exp_f32 v62, v62
    v_exp_f32 v63, v63
    v_mfma_f32_16x16x32_bf16 v[88:91], v[92:95], v[64:67], v[88:91]
    v_cvt_pk_bf16_f32 v68, v56, v57
    v_cvt_pk_bf16_f32 v69, v58, v59
    v_cvt_pk_bf16_f32 v70, v60, v61
    v_cvt_pk_bf16_f32 v71, v62, v63
attn_poll:
    s_waitcnt lgkmcnt(0)
    v_readfirstlane_b32 s6, v158
    v_readfirstlane_b32 s7, v159
    s_cmp_ge_u32 s6, s13
    s_cbranch_scc0 attn_repoll
    s_cmp_ge_u32 s7, s12
    s_cbranch_scc0 attn_repoll
    s_add_u32 s13, s13, 1
    s_add_u32 s12, s12, 8
    s_setprio 3
    v_mfma_f32_32x32x16_bf16 v[48:63], v[104:107], v[8:11], v[16:31]
    ds_read_b128 v[96:99], v7 offset:0
    ds_read_b128 v[100:103], v7 offset:1024
    v_exp_f32 v32, v32
    v_exp_f32 v33, v33
    v_exp_f32 v34, v34
    v_exp_f32 v35, v35
    v_mfma_f32_32x32x16_bf16 v[72:87], v[124:127], v[68:71], v[72:87]
    ds_read_b128 v[120:123], v6 offset:14336
    ds_read_b128 v[124:127], v6 offset:15360
    v_exp_f32 v36, v36
    v_exp_f32 v37, v37
    v_exp_f32 v38, v38
    v_exp_f32 v39, v39
    v_mfma_f32_32x32x16_bf16 v[48:63], v[108:111], v[12:15], v[48:63]
    v_cvt_pk_bf16_f32 v64, v32, v33
    v_cvt_pk_bf16_f32 v65, v34, v35
    v_cvt_pk_bf16_f32 v66, v36, v37
    v_cvt_pk_bf16_f32 v67, v38, v39
    v_exp_f32 v40, v40
    v_exp_f32 v41, v41
    v_mfma_f32_16x16x32_bf16 v[88:91], v[92:95], v[68:71], v[88:91]
    v_exp_f32 v42, v42
    v_exp_f32 v43, v43
    v_mfma_f32_32x32x16_bf16 v[72:87], v[112:115], v[64:67], v[72:87]
    v_exp_f32 v44, v44
    v_exp_f32 v45, v45
    v_exp_f32 v46, v46
    v_exp_f32 v47, v47
    v_mfma_f32_16x16x32_bf16 v[88:91], v[92:95], v[64:67], v[88:91]
    v_cvt_pk_bf16_f32 v68, v40, v41
    v_cvt_pk_bf16_f32 v69, v42, v43
    v_cvt_pk_bf16_f32 v70, v44, v45
    v_cvt_pk_bf16_f32 v71, v46, v47
    s_waitcnt lgkmcnt(0)
    s_setprio 2
    v_mfma_f32_32x32x16_bf16 v[32:47], v[96:99], v[8:11], v[16:31]
    ds_read_b128 v[104:107], v7 offset:4096
    ds_read_b128 v[108:111], v7 offset:5120
    v_exp_f32 v48, v48
    v_exp_f32 v49, v49
    v_exp_f32 v50, v50
    v_exp_f32 v51, v51
    v_mfma_f32_32x32x16_bf16 v[72:87], v[116:119], v[68:71], v[72:87]
    ds_read_b128 v[112:115], v7 offset:2048
    ds_read_b128 v[116:119], v7 offset:3072
    v_exp_f32 v52, v52
    v_exp_f32 v53, v53
    v_exp_f32 v54, v54
    v_exp_f32 v55, v55
    v_mfma_f32_32x32x16_bf16 v[32:47], v[100:103], v[12:15], v[32:47]
    v_cvt_pk_bf16_f32 v64, v48, v49
    v_cvt_pk_bf16_f32 v65, v50, v51
    v_cvt_pk_bf16_f32 v66, v52, v53
    v_cvt_pk_bf16_f32 v67, v54, v55
    v_exp_f32 v56, v56
    v_exp_f32 v57, v57
    v_mfma_f32_16x16x32_bf16 v[88:91], v[92:95], v[68:71], v[88:91]
    v_exp_f32 v58, v58
    v_exp_f32 v59, v59
    v_mfma_f32_32x32x16_bf16 v[72:87], v[120:123], v[64:67], v[72:87]
    v_mov_b32 v6, v7
    v_add_u32 v7, s15, v2
    s_add_u32 s15, s15, 16384
    s_cmp_eq_u32 s15, 114688
    s_cselect_b32 s15, 0, s15
    s_add_u32 s11, s11, 1
    s_cmp_lt_u32 s11, 16
    v_exp_f32 v60, v60
    v_exp_f32 v61, v61
    v_exp_f32 v62, v62
    v_exp_f32 v63, v63
    v_mfma_f32_16x16x32_bf16 v[88:91], v[92:95], v[64:67], v[88:91]
    v_cvt_pk_bf16_f32 v68, v56, v57
    v_cvt_pk_bf16_f32 v69, v58, v59
    v_cvt_pk_bf16_f32 v70, v60, v61
    v_cvt_pk_bf16_f32 v71, v62, v63
    s_cbranch_scc1 attn_loop
    s_nop 0
    v_mfma_f32_32x32x16_bf16 v[72:87], v[124:127], v[68:71], v[72:87]
    v_mfma_f32_16x16x32_bf16 v[88:91], v[92:95], v[68:71], v[88:91]
    s_lshl_b32 s6, s4, 7
    s_lshl_b32 s7, s5, 1
    s_add_u32 s6, s6, s7
    s_lshl_b32 s6, s6, 10
    s_add_u32 s6, s6, 10485760
    s_add_u32 s44, s42, s6
    s_addc_u32 s45, s43, 0
    v_bfe_u32 v5, v1, 4, 1
    v_cmp_eq_u32 vcc, 1, v5
    v_lshlrev_b32 v5, 10, v5
    v_lshrrev_b32 v6, 5, v1
    v_lshl_add_u32 v5, v6, 8, v5
    v_and_b32 v6, 15, v1
    v_lshl_add_u32 v5, v6, 4, v5
    s_nop 7
    v_cndmask_b32 v128, v88, v89, vcc
    s_mov_b32 s6, 0x1f800000
    v_cmp_nle_f32 vcc, s6, v128
    s_nop 4
    s_cbranch_vccnz attn_fallback
attn_out:
    v_rcp_f32 v128, v128
    s_nop 0
    v_mul_f32 v72, v72, v128
    v_mul_f32 v73, v73, v128
    v_mul_f32 v74, v74, v128
    v_mul_f32 v75, v75, v128
    v_mul_f32 v76, v76, v128
    v_mul_f32 v77, v77, v128
    v_mul_f32 v78, v78, v128
    v_mul_f32 v79, v79, v128
    v_mul_f32 v80, v80, v128
    v_mul_f32 v81, v81, v128
    v_mul_f32 v82, v82, v128
    v_mul_f32 v83, v83, v128
    v_mul_f32 v84, v84, v128
    v_mul_f32 v85, v85, v128
    v_mul_f32 v86, v86, v128
    v_mul_f32 v87, v87, v128
    v_cvt_pk_bf16_f32 v64, v72, v73
    v_cvt_pk_bf16_f32 v65, v74, v75
    v_cvt_pk_bf16_f32 v66, v76, v77
    v_cvt_pk_bf16_f32 v67, v78, v79
    v_cvt_pk_bf16_f32 v68, v80, v81
    v_cvt_pk_bf16_f32 v69, v82, v83
    v_cvt_pk_bf16_f32 v70, v84, v85
    v_cvt_pk_bf16_f32 v71, v86, v87
    v_permlane32_swap_b32 v64, v66
    v_permlane32_swap_b32 v65, v67
    global_store_dwordx4 v5, v[64:67], s[44:45] offset:0 sc1
    v_permlane32_swap_b32 v68, v70
    v_permlane32_swap_b32 v69, v71
    global_store_dwordx4 v5, v[68:71], s[44:45] offset:512 sc1
attn_end:
    s_endpgm
attn_repoll:
    s_sleep 1
    ds_read_b64 v[158:159], v3
    s_branch attn_poll
attn_fallback:
    s_add_u32 s50, s42, 786432
    s_addc_u32 s51, s43, 0
    v_mov_b32 v72, 0
    v_mov_b32 v73, 0
    v_mov_b32 v74, 0
    v_mov_b32 v75, 0
    v_mov_b32 v76, 0
    v_mov_b32 v77, 0
    v_mov_b32 v78, 0
    v_mov_b32 v79, 0
    v_mov_b32 v80, 0
    v_mov_b32 v81, 0
    v_mov_b32 v82, 0
    v_mov_b32 v83, 0
    v_mov_b32 v84, 0
    v_mov_b32 v85, 0
    v_mov_b32 v86, 0
    v_mov_b32 v87, 0
    v_mov_b32 v129, 0xff800000
    v_mov_b32 v128, 0
    s_mov_b32 s11, 0
attn_fb_loop:
    global_load_dwordx4 v[96:99], v2, s[50:51] offset:0
    global_load_dwordx4 v[100:103], v2, s[50:51] offset:1024
    global_load_dwordx4 v[112:115], v2, s[50:51] offset:2048
    global_load_dwordx4 v[116:119], v2, s[50:51] offset:3072
    s_add_u32 s50, s50, 4096
    s_addc_u32 s51, s51, 0
    s_waitcnt vmcnt(0)
    v_mfma_f32_32x32x16_bf16 v[32:47], v[96:99], v[8:11], 0
    v_mfma_f32_32x32x16_bf16 v[32:47], v[100:103], v[12:15], v[32:47]
    s_nop 11
    v_max3_f32 v130, v32, v33, v129
    v_max3_f32 v130, v34, v35, v130
    v_max3_f32 v130, v36, v37, v130
    v_max3_f32 v130, v38, v39, v130
    v_max3_f32 v130, v40, v41, v130
    v_max3_f32 v130, v42, v43, v130
    v_max3_f32 v130, v44, v45, v130
    v_max3_f32 v130, v46, v47, v130
    v_mov_b32 v131, v130
    s_nop 1
    v_permlane32_swap_b32 v130, v131
    v_max_f32 v130, v130, v131
    v_sub_f32 v131, v129, v130
    v_exp_f32 v131, v131
    v_mov_b32 v129, v130
    v_sub_f32 v32, v32, v130
    v_sub_f32 v33, v33, v130
    v_sub_f32 v34, v34, v130
    v_sub_f32 v35, v35, v130
    v_sub_f32 v36, v36, v130
    v_sub_f32 v37, v37, v130
    v_sub_f32 v38, v38, v130
    v_sub_f32 v39, v39, v130
    v_sub_f32 v40, v40, v130
    v_sub_f32 v41, v41, v130
    v_sub_f32 v42, v42, v130
    v_sub_f32 v43, v43, v130
    v_sub_f32 v44, v44, v130
    v_sub_f32 v45, v45, v130
    v_sub_f32 v46, v46, v130
    v_sub_f32 v47, v47, v130
    v_exp_f32 v32, v32
    v_exp_f32 v33, v33
    v_exp_f32 v34, v34
    v_exp_f32 v35, v35
    v_exp_f32 v36, v36
    v_exp_f32 v37, v37
    v_exp_f32 v38, v38
    v_exp_f32 v39, v39
    v_exp_f32 v40, v40
    v_exp_f32 v41, v41
    v_exp_f32 v42, v42
    v_exp_f32 v43, v43
    v_exp_f32 v44, v44
    v_exp_f32 v45, v45
    v_exp_f32 v46, v46
    v_exp_f32 v47, v47
    v_cvt_pk_bf16_f32 v64, v32, v33
    v_cvt_pk_bf16_f32 v65, v34, v35
    v_cvt_pk_bf16_f32 v66, v36, v37
    v_cvt_pk_bf16_f32 v67, v38, v39
    v_cvt_pk_bf16_f32 v68, v40, v41
    v_cvt_pk_bf16_f32 v69, v42, v43
    v_cvt_pk_bf16_f32 v70, v44, v45
    v_cvt_pk_bf16_f32 v71, v46, v47
    v_mul_f32 v128, v128, v131
    v_mul_f32 v72, v72, v131
    v_mul_f32 v73, v73, v131
    v_mul_f32 v74, v74, v131
    v_mul_f32 v75, v75, v131
    v_mul_f32 v76, v76, v131
    v_mul_f32 v77, v77, v131
    v_mul_f32 v78, v78, v131
    v_mul_f32 v79, v79, v131
    v_mul_f32 v80, v80, v131
    v_mul_f32 v81, v81, v131
    v_mul_f32 v82, v82, v131
    v_mul_f32 v83, v83, v131
    v_mul_f32 v84, v84, v131
    v_mul_f32 v85, v85, v131
    v_mul_f32 v86, v86, v131
    v_mul_f32 v87, v87, v131
    v_lshlrev_b32 v132, 16, v64
    v_and_b32 v133, 0xffff0000, v64
    v_add_f32 v128, v128, v132
    v_add_f32 v128, v128, v133
    v_lshlrev_b32 v132, 16, v65
    v_and_b32 v133, 0xffff0000, v65
    v_add_f32 v128, v128, v132
    v_add_f32 v128, v128, v133
    v_lshlrev_b32 v132, 16, v66
    v_and_b32 v133, 0xffff0000, v66
    v_add_f32 v128, v128, v132
    v_add_f32 v128, v128, v133
    v_lshlrev_b32 v132, 16, v67
    v_and_b32 v133, 0xffff0000, v67
    v_add_f32 v128, v128, v132
    v_add_f32 v128, v128, v133
    v_lshlrev_b32 v132, 16, v68
    v_and_b32 v133, 0xffff0000, v68
    v_add_f32 v128, v128, v132
    v_add_f32 v128, v128, v133
    v_lshlrev_b32 v132, 16, v69
    v_and_b32 v133, 0xffff0000, v69
    v_add_f32 v128, v128, v132
    v_add_f32 v128, v128, v133
    v_lshlrev_b32 v132, 16, v70
    v_and_b32 v133, 0xffff0000, v70
    v_add_f32 v128, v128, v132
    v_add_f32 v128, v128, v133
    v_lshlrev_b32 v132, 16, v71
    v_and_b32 v133, 0xffff0000, v71
    v_add_f32 v128, v128, v132
    v_add_f32 v128, v128, v133
    v_mfma_f32_32x32x16_bf16 v[72:87], v[112:115], v[64:67], v[72:87]
    v_mfma_f32_32x32x16_bf16 v[72:87], v[116:119], v[68:71], v[72:87]
    s_add_u32 s11, s11, 1
    s_cmp_lt_u32 s11, 64
    s_nop 7
    s_nop 3
    s_cbranch_scc1 attn_fb_loop
    v_mov_b32 v130, v128
    s_nop 1
    v_permlane32_swap_b32 v128, v130
    v_add_f32 v128, v128, v130
    s_nop 1
    s_branch attn_out
attn_help:
    s_cmp_lt_u32 s3, 10
    s_cbranch_scc1 attn_rp
    s_setprio 2
    v_lshlrev_b32 v2, 4, v1
    v_mov_b32 v3, 147456
    v_mov_b32 v4, 1
    v_mov_b32 v5, 0
    ds_write_b64 v3, v[4:5]
    s_waitcnt lgkmcnt(0)
    s_add_u32 s50, s42, 802816
    s_addc_u32 s51, s43, 0
    s_mov_b32 s14, 16384
    s_add_u32 m0, s14, 0
    s_nop 0
    global_load_lds_dwordx4 v2, s[50:51] offset:0
    global_load_lds_dwordx4 v2, s[50:51] offset:1024
    global_load_lds_dwordx4 v2, s[50:51] offset:2048
    global_load_lds_dwordx4 v2, s[50:51] offset:3072
    s_add_u32 s50, s50, 4096
    s_addc_u32 s51, s51, 0
    s_add_u32 m0, s14, 4096
    s_nop 0
    global_load_lds_dwordx4 v2, s[50:51] offset:0
    global_load_lds_dwordx4 v2, s[50:51] offset:1024
    global_load_lds_dwordx4 v2, s[50:51] offset:2048
    global_load_lds_dwordx4 v2, s[50:51] offset:3072
    s_add_u32 s50, s50, 4096
    s_addc_u32 s51, s51, 0
    s_add_u32 m0, s14, 8192
    s_nop 0
    global_load_lds_dwordx4 v2, s[50:51] offset:0
    global_load_lds_dwordx4 v2, s[50:51] offset:1024
    global_load_lds_dwordx4 v2, s[50:51] offset:2048
    global_load_lds_dwordx4 v2, s[50:51] offset:3072
    s_add_u32 s50, s50, 4096
    s_addc_u32 s51, s51, 0
    s_add_u32 m0, s14, 12288
    s_nop 0
    global_load_lds_dwordx4 v2, s[50:51] offset:0
    global_load_lds_dwordx4 v2, s[50:51] offset:1024
    global_load_lds_dwordx4 v2, s[50:51] offset:2048
    global_load_lds_dwordx4 v2, s[50:51] offset:3072
    s_add_u32 s50, s50, 4096
    s_addc_u32 s51, s51, 0
    s_add_u32 s14, s14, 16384
    s_cmp_eq_u32 s14, 114688
    s_cselect_b32 s14, 0, s14
    s_add_u32 m0, s14, 0
    s_nop 0
    global_load_lds_dwordx4 v2, s[50:51] offset:0
    global_load_lds_dwordx4 v2, s[50:51] offset:1024
    global_load_lds_dwordx4 v2, s[50:51] offset:2048
    global_load_lds_dwordx4 v2, s[50:51] offset:3072
    s_add_u32 s50, s50, 4096
    s_addc_u32 s51, s51, 0
    s_add_u32 m0, s14, 4096
    s_nop 0
    global_load_lds_dwordx4 v2, s[50:51] offset:0
    global_load_lds_dwordx4 v2, s[50:51] offset:1024
    global_load_lds_dwordx4 v2, s[50:51] offset:2048
    global_load_lds_dwordx4 v2, s[50:51] offset:3072
    s_add_u32 s50, s50, 4096
    s_addc_u32 s51, s51, 0
    s_add_u32 m0, s14, 8192
    s_nop 0
    global_load_lds_dwordx4 v2, s[50:51] offset:0
    global_load_lds_dwordx4 v2, s[50:51] offset:1024
    global_load_lds_dwordx4 v2, s[50:51] offset:2048
    global_load_lds_dwordx4 v2, s[50:51] offset:3072
    s_add_u32 s50, s50, 4096
    s_addc_u32 s51, s51, 0
    s_add_u32 m0, s14, 12288
    s_nop 0
    global_load_lds_dwordx4 v2, s[50:51] offset:0
    global_load_lds_dwordx4 v2, s[50:51] offset:1024
    global_load_lds_dwordx4 v2, s[50:51] offset:2048
    global_load_lds_dwordx4 v2, s[50:51] offset:3072
    s_add_u32 s50, s50, 4096
    s_addc_u32 s51, s51, 0
    s_add_u32 s14, s14, 16384
    s_cmp_eq_u32 s14, 114688
    s_cselect_b32 s14, 0, s14
    s_barrier
    s_mov_b32 s11, 3
attn_ld:
    s_cmp_lt_u32 s11, 7
    s_cbranch_scc1 attn_ld_go
    s_cmp_ge_u32 s11, 16
    s_cbranch_scc1 attn_ld_tail
    s_sub_u32 s6, s11, 5
    s_lshl_b32 s6, s6, 3
attn_ld_poll:
    ds_read_b32 v8, v3 offset:4
    s_waitcnt lgkmcnt(0)
    v_readfirstlane_b32 s7, v8
    s_nop 0
    s_cmp_ge_u32 s7, s6
    s_cbranch_scc1 attn_ld_go
    s_waitcnt vmcnt(0)
    v_mov_b32 v4, s11
    ds_write_b32 v3, v4
    s_sleep 4
    s_branch attn_ld_poll
attn_ld_go:
    s_add_u32 m0, s14, 0
    s_nop 0
    global_load_lds_dwordx4 v2, s[50:51] offset:0
    global_load_lds_dwordx4 v2, s[50:51] offset:1024
    global_load_lds_dwordx4 v2, s[50:51] offset:2048
    global_load_lds_dwordx4 v2, s[50:51] offset:3072
    s_add_u32 s50, s50, 4096
    s_addc_u32 s51, s51, 0
    s_add_u32 m0, s14, 4096
    s_nop 0
    global_load_lds_dwordx4 v2, s[50:51] offset:0
    global_load_lds_dwordx4 v2, s[50:51] offset:1024
    global_load_lds_dwordx4 v2, s[50:51] offset:2048
    global_load_lds_dwordx4 v2, s[50:51] offset:3072
    s_add_u32 s50, s50, 4096
    s_addc_u32 s51, s51, 0
    s_add_u32 m0, s14, 8192
    s_nop 0
    global_load_lds_dwordx4 v2, s[50:51] offset:0
    global_load_lds_dwordx4 v2, s[50:51] offset:1024
    global_load_lds_dwordx4 v2, s[50:51] offset:2048
    global_load_lds_dwordx4 v2, s[50:51] offset:3072
    s_add_u32 s50, s50, 4096
    s_addc_u32 s51, s51, 0
    s_add_u32 m0, s14, 12288
    s_nop 0
    global_load_lds_dwordx4 v2, s[50:51] offset:0
    global_load_lds_dwordx4 v2, s[50:51] offset:1024
    global_load_lds_dwordx4 v2, s[50:51] offset:2048
    global_load_lds_dwordx4 v2, s[50:51] offset:3072
    s_add_u32 s50, s50, 4096
    s_addc_u32 s51, s51, 0
    s_add_u32 s14, s14, 16384
    s_cmp_eq_u32 s14, 114688
    s_cselect_b32 s14, 0, s14
    s_waitcnt vmcnt(32)
    s_sub_u32 s6, s11, 1
    v_mov_b32 v4, s6
    ds_max_u32 v3, v4
    s_add_u32 s11, s11, 1
    s_branch attn_ld
attn_ld_tail:
    s_waitcnt vmcnt(0)
    v_mov_b32 v4, 32
    ds_write_b32 v3, v4
    s_waitcnt lgkmcnt(0)
    s_endpgm
attn_rp:
    s_barrier
    s_setprio 3
    s_sub_u32 s3, s3, 8
    v_lshlrev_b32 v2, 4, v1
    s_lshl_b32 s12, s3, 14
    s_add_u32 s12, s12, 114688
    s_waitcnt lgkmcnt(0)
    s_cmp_ge_u32 s2, 224
    s_cbranch_scc1 attn_rp_plain
    v_lshrrev_b32 v124, 3, v1
    v_mul_u32_u24 v124, 7168, v124
    v_lshrrev_b32 v125, 3, v1
    v_and_b32 v125, 2, v125
    v_xor_b32 v125, v125, v1
    v_and_b32 v125, 7, v125
    v_lshlrev_b32 v125, 4, v125
    v_add_u32 v4, v124, v125
    v_xor_b32 v125, 64, v125
    v_add_u32 v5, v124, v125
    v_add_u32 v5, 57344, v5
    v_add_u32 v6, 114688, v4
    v_add_u32 v7, 114688, v5
    v_xor_b32 v8, 16, v4
    v_xor_b32 v9, 16, v5
    v_xor_b32 v10, 16, v6
    v_xor_b32 v11, 16, v7
    v_lshrrev_b32 v124, 4, v1
    v_bfe_u32 v125, v1, 2, 2
    v_lshlrev_b32 v126, 3, v124
    v_add_u32 v126, v126, v125
    v_lshlrev_b32 v126, 7, v126
    v_add_u32 v126, s12, v126
    v_lshrrev_b32 v125, 1, v125
    v_and_b32 v124, 1, v124
    v_lshl_or_b32 v124, v124, 1, v125
    v_lshlrev_b32 v124, 5, v124
    v_and_b32 v125, 1, v1
    v_lshl_add_u32 v126, v125, 3, v126
    v_bfe_u32 v125, v1, 1, 1
    v_lshl_add_u32 v126, v125, 12, v126
    v_lshl_or_b32 v124, v125, 4, v124
    v_xor_b32 v125, 0, v124
    v_add_u32 v12, v126, v125
    v_xor_b32 v125, 16, v124
    v_add_u32 v13, v126, v125
    v_xor_b32 v125, 32, v124
    v_add_u32 v14, v126, v125
    v_xor_b32 v125, 48, v124
    v_add_u32 v15, v126, v125
    v_xor_b32 v125, 64, v124
    v_add_u32 v16, v126, v125
    v_xor_b32 v125, 80, v124
    v_add_u32 v17, v126, v125
    v_xor_b32 v125, 96, v124
    v_add_u32 v18, v126, v125
    v_xor_b32 v125, 112, v124
    v_add_u32 v19, v126, v125
    v_mov_b32 v60, 0
    v_mov_b32 v61, 0
    v_mov_b32 v62, 0
    v_mov_b32 v63, 0
    v_mov_b32 v64, 0
    v_mov_b32 v65, 0
    v_mov_b32 v66, 0
    v_mov_b32 v67, 0
    v_mov_b32 v68, 0
    v_mov_b32 v69, 0
    v_mov_b32 v70, 0
    v_mov_b32 v71, 0
    v_mov_b32 v72, 0
    v_mov_b32 v73, 0
    v_mov_b32 v74, 0
    v_mov_b32 v75, 0
    v_mov_b32 v76, 0
    v_mov_b32 v77, 0
    v_mov_b32 v78, 0
    v_mov_b32 v79, 0
    v_mov_b32 v80, 0
    v_mov_b32 v81, 0
    v_mov_b32 v82, 0
    v_mov_b32 v83, 0
    v_mov_b32 v84, 0
    v_mov_b32 v85, 0
    v_mov_b32 v86, 0
    v_mov_b32 v87, 0
    v_mov_b32 v88, 0
    v_mov_b32 v89, 0
    v_mov_b32 v90, 0
    v_mov_b32 v91, 0
    s_lshr_b32 s4, s2, 2
    s_and_b32 s5, s2, 3
    s_lshl_b32 s5, s5, 1
    s_add_u32 s5, s5, s3
    s_lshl_b32 s6, s5, 2
    s_mul_i32 s8, s6, 448
    s_lshl_b32 s9, s4, 3
    s_add_u32 s8, s8, s9
    s_lshl_b32 s8, s8, 10
    s_add_u32 s8, s8, 23068672
    s_add_u32 s56, s42, s8
    s_addc_u32 s57, s43, 0
    s_add_u32 s58, s56, 4096
    s_addc_u32 s59, s57, 0
    v_and_b32 v128, 1, v1
    v_lshlrev_b32 v128, 11, v128
    v_lshrrev_b32 v129, 4, v1
    v_lshl_add_u32 v128, v129, 4, v128
    s_lshl_b32 s8, s6, 6
    s_add_u32 s8, s8, 122880
    s_add_u32 s52, s42, s8
    s_addc_u32 s53, s43, 0
    global_load_dwordx4 v[92:95], v128, s[52:53]
    s_mul_i32 s8, s6, 229376
    s_lshl_b32 s9, s4, 7
    s_add_u32 s8, s8, s9
    s_add_u32 s52, s28, s8
    s_addc_u32 s53, s29, 0
    s_add_u32 s54, s30, s8
    s_addc_u32 s55, s31, 0
    s_add_u32 m0, s12, 0
    s_nop 0
    global_load_lds_dwordx4 v4, s[52:53]
    s_add_u32 m0, s12, 1024
    s_nop 0
    global_load_lds_dwordx4 v5, s[52:53]
    s_add_u32 m0, s12, 2048
    s_nop 0
    global_load_lds_dwordx4 v6, s[52:53]
    s_add_u32 m0, s12, 3072
    s_nop 0
    global_load_lds_dwordx4 v7, s[52:53]
    s_add_u32 m0, s12, 4096
    s_nop 0
    global_load_lds_dwordx4 v8, s[54:55]
    s_add_u32 m0, s12, 5120
    s_nop 0
    global_load_lds_dwordx4 v9, s[54:55]
    s_add_u32 m0, s12, 6144
    s_nop 0
    global_load_lds_dwordx4 v10, s[54:55]
    s_add_u32 m0, s12, 7168
    s_nop 0
    global_load_lds_dwordx4 v11, s[54:55]
    s_add_u32 s6, s6, 1
    s_xor_b32 s12, s12, 0x2000
    s_waitcnt vmcnt(0)
    s_mov_b32 s11, 4
attn_rp_gu:
    s_waitcnt vmcnt(8)
    v_mov_b32 v20, v92
    v_mov_b32 v21, v93
    v_mov_b32 v22, v94
    v_mov_b32 v23, v95
    s_cmp_eq_u32 s11, 1
    s_cbranch_scc1 attn_rp_gu_ni
    s_lshl_b32 s8, s6, 6
    s_add_u32 s8, s8, 122880
    s_add_u32 s52, s42, s8
    s_addc_u32 s53, s43, 0
    global_load_dwordx4 v[92:95], v128, s[52:53]
    s_mul_i32 s8, s6, 229376
    s_lshl_b32 s9, s4, 7
    s_add_u32 s8, s8, s9
    s_add_u32 s52, s28, s8
    s_addc_u32 s53, s29, 0
    s_add_u32 s54, s30, s8
    s_addc_u32 s55, s31, 0
    s_add_u32 m0, s12, 0
    s_nop 0
    global_load_lds_dwordx4 v4, s[52:53]
    s_add_u32 m0, s12, 1024
    s_nop 0
    global_load_lds_dwordx4 v5, s[52:53]
    s_add_u32 m0, s12, 2048
    s_nop 0
    global_load_lds_dwordx4 v6, s[52:53]
    s_add_u32 m0, s12, 3072
    s_nop 0
    global_load_lds_dwordx4 v7, s[52:53]
    s_add_u32 m0, s12, 4096
    s_nop 0
    global_load_lds_dwordx4 v8, s[54:55]
    s_add_u32 m0, s12, 5120
    s_nop 0
    global_load_lds_dwordx4 v9, s[54:55]
    s_add_u32 m0, s12, 6144
    s_nop 0
    global_load_lds_dwordx4 v10, s[54:55]
    s_add_u32 m0, s12, 7168
    s_nop 0
    global_load_lds_dwordx4 v11, s[54:55]
    s_add_u32 s6, s6, 1
    s_xor_b32 s12, s12, 0x2000
attn_rp_gu_ni:
    ds_read_b64_tr_b16 v[28:29], v12 offset:0
    ds_read_b64_tr_b16 v[30:31], v12 offset:512
    ds_read_b64_tr_b16 v[32:33], v13 offset:0
    ds_read_b64_tr_b16 v[34:35], v13 offset:512
    ds_read_b64_tr_b16 v[36:37], v14 offset:0
    ds_read_b64_tr_b16 v[38:39], v14 offset:512
    ds_read_b64_tr_b16 v[40:41], v15 offset:0
    ds_read_b64_tr_b16 v[42:43], v15 offset:512
    ds_read_b64_tr_b16 v[44:45], v16 offset:0
    ds_read_b64_tr_b16 v[46:47], v16 offset:512
    ds_read_b64_tr_b16 v[48:49], v17 offset:0
    ds_read_b64_tr_b16 v[50:51], v17 offset:512
    ds_read_b64_tr_b16 v[52:53], v18 offset:0
    ds_read_b64_tr_b16 v[54:55], v18 offset:512
    ds_read_b64_tr_b16 v[56:57], v19 offset:0
    ds_read_b64_tr_b16 v[58:59], v19 offset:512
    s_waitcnt lgkmcnt(14)
    global_store_dwordx4 v2, v[28:31], s[56:57] offset:0 sc1
    v_mfma_f32_16x16x32_bf16 v[60:63], v[28:31], v[20:23], v[60:63]
    s_waitcnt lgkmcnt(12)
    global_store_dwordx4 v2, v[32:35], s[56:57] offset:1024 sc1
    v_mfma_f32_16x16x32_bf16 v[64:67], v[32:35], v[20:23], v[64:67]
    s_waitcnt lgkmcnt(10)
    global_store_dwordx4 v2, v[36:39], s[56:57] offset:2048 sc1
    v_mfma_f32_16x16x32_bf16 v[68:71], v[36:39], v[20:23], v[68:71]
    s_waitcnt lgkmcnt(8)
    global_store_dwordx4 v2, v[40:43], s[56:57] offset:3072 sc1
    v_mfma_f32_16x16x32_bf16 v[72:75], v[40:43], v[20:23], v[72:75]
    s_waitcnt lgkmcnt(6)
    global_store_dwordx4 v2, v[44:47], s[58:59] offset:0 sc1
    v_mfma_f32_16x16x32_bf16 v[76:79], v[44:47], v[20:23], v[76:79]
    s_waitcnt lgkmcnt(4)
    global_store_dwordx4 v2, v[48:51], s[58:59] offset:1024 sc1
    v_mfma_f32_16x16x32_bf16 v[80:83], v[48:51], v[20:23], v[80:83]
    s_waitcnt lgkmcnt(2)
    global_store_dwordx4 v2, v[52:55], s[58:59] offset:2048 sc1
    v_mfma_f32_16x16x32_bf16 v[84:87], v[52:55], v[20:23], v[84:87]
    s_waitcnt lgkmcnt(0)
    global_store_dwordx4 v2, v[56:59], s[58:59] offset:3072 sc1
    v_mfma_f32_16x16x32_bf16 v[88:91], v[56:59], v[20:23], v[88:91]
    s_add_u32 s56, s56, 458752
    s_addc_u32 s57, s57, 0
    s_add_u32 s58, s58, 458752
    s_addc_u32 s59, s59, 0
    v_xor_b32 v12, 0x2000, v12
    v_xor_b32 v13, 0x2000, v13
    v_xor_b32 v14, 0x2000, v14
    v_xor_b32 v15, 0x2000, v15
    v_xor_b32 v16, 0x2000, v16
    v_xor_b32 v17, 0x2000, v17
    v_xor_b32 v18, 0x2000, v18
    v_xor_b32 v19, 0x2000, v19
    s_sub_u32 s11, s11, 1
    s_cmp_lg_u32 s11, 0
    s_nop 4
    s_cbranch_scc1 attn_rp_gu
    s_mul_i32 s8, s5, 57344
    s_lshl_b32 s9, s4, 10
    s_add_u32 s8, s8, s9
    s_add_u32 s8, s8, 196608
    s_add_u32 s56, s42, s8
    s_addc_u32 s57, s43, 0
    v_lshrrev_b32 v124, 4, v1
    v_lshlrev_b32 v124, 4, v124
    v_and_b32 v125, 1, v1
    v_lshl_add_u32 v124, v125, 6, v124
    v_and_b32 v125, 14, v1
    v_cmp_eq_u32 vcc, 0, v125
    s_nop 0
    s_and_saveexec_b64 s[60:61], vcc
    global_store_dwordx4 v124, v[60:63], s[56:57] offset:0 sc1
    global_store_dwordx4 v124, v[64:67], s[56:57] offset:128 sc1
    global_store_dwordx4 v124, v[68:71], s[56:57] offset:256 sc1
    global_store_dwordx4 v124, v[72:75], s[56:57] offset:384 sc1
    global_store_dwordx4 v124, v[76:79], s[56:57] offset:512 sc1
    global_store_dwordx4 v124, v[80:83], s[56:57] offset:640 sc1
    global_store_dwordx4 v124, v[84:87], s[56:57] offset:768 sc1
    global_store_dwordx4 v124, v[88:91], s[56:57] offset:896 sc1
    s_mov_b64 exec, s[60:61]
    s_cmp_ge_u32 s2, 160
    s_cbranch_scc1 attn_rp_mod
attn_rp_plain:
    s_lshl_b32 s7, s2, 2
    s_lshl_b32 s8, s3, 1
    s_add_u32 s7, s7, s8
    s_lshl_b32 s8, s2, 4
    s_lshl_b32 s9, s3, 3
    s_add_u32 s8, s8, s9
    s_sub_u32 s8, s8, 2944
    s_cmp_ge_u32 s2, 224
    s_cselect_b32 s7, s8, s7
    s_cselect_b32 s15, 8, 2
    s_mov_b32 s14, s7
    v_lshrrev_b32 v124, 3, v1
    v_mul_u32_u24 v124, 2048, v124
    v_lshrrev_b32 v125, 3, v1
    v_and_b32 v125, 2, v125
    v_xor_b32 v125, v125, v1
    v_and_b32 v125, 7, v125
    v_lshlrev_b32 v125, 4, v125
    v_add_u32 v4, v124, v125
    v_xor_b32 v125, 64, v125
    v_add_u32 v5, v124, v125
    v_add_u32 v5, 16384, v5
    v_add_u32 v6, 32768, v4
    v_add_u32 v7, 32768, v5
    v_lshrrev_b32 v124, 4, v1
    v_bfe_u32 v125, v1, 2, 2
    v_lshlrev_b32 v126, 3, v124
    v_add_u32 v126, v126, v125
    v_lshlrev_b32 v126, 7, v126
    v_add_u32 v126, s12, v126
    v_lshrrev_b32 v125, 1, v125
    v_and_b32 v124, 1, v124
    v_lshl_or_b32 v124, v124, 1, v125
    v_lshlrev_b32 v124, 5, v124
    v_and_b32 v125, 3, v1
    v_lshl_add_u32 v126, v125, 3, v126
    v_xor_b32 v125, 0, v124
    v_add_u32 v12, v126, v125
    v_xor_b32 v125, 32, v124
    v_add_u32 v13, v126, v125
    v_xor_b32 v125, 64, v124
    v_add_u32 v14, v126, v125
    v_xor_b32 v125, 96, v124
    v_add_u32 v15, v126, v125
    s_cmp_lt_u32 s7, 256
    s_cselect_b32 s52, s24, s32
    s_cselect_b32 s53, s25, s33
    s_mov_b32 s10, 38797312
    s_cselect_b32 s10, 4194304, s10
    s_cselect_b32 s8, 0, 256
    s_sub_u32 s9, s7, s8
    s_lshr_b32 s8, s9, 4
    s_lshl_b32 s8, s8, 17
    s_and_b32 s9, s9, 15
    s_add_u32 s7, s7, 1
    s_lshl_b32 s9, s9, 7
    s_add_u32 s9, s9, s8
    s_add_u32 s52, s52, s9
    s_addc_u32 s53, s53, 0
    s_add_u32 s54, s52, 65536
    s_addc_u32 s55, s53, 0
    s_add_u32 m0, s12, 0
    s_nop 0
    global_load_lds_dwordx4 v4, s[52:53]
    s_add_u32 m0, s12, 1024
    s_nop 0
    global_load_lds_dwordx4 v5, s[52:53]
    s_add_u32 m0, s12, 2048
    s_nop 0
    global_load_lds_dwordx4 v6, s[52:53]
    s_add_u32 m0, s12, 3072
    s_nop 0
    global_load_lds_dwordx4 v7, s[52:53]
    s_add_u32 m0, s12, 4096
    s_nop 0
    global_load_lds_dwordx4 v4, s[54:55]
    s_add_u32 m0, s12, 5120
    s_nop 0
    global_load_lds_dwordx4 v5, s[54:55]
    s_add_u32 m0, s12, 6144
    s_nop 0
    global_load_lds_dwordx4 v6, s[54:55]
    s_add_u32 m0, s12, 7168
    s_nop 0
    global_load_lds_dwordx4 v7, s[54:55]
    s_xor_b32 s12, s12, 0x2000
    s_waitcnt vmcnt(0)
    s_mov_b32 s11, s15
attn_rp_pl:
    s_waitcnt vmcnt(8)
    s_cmp_eq_u32 s11, 1
    s_cbranch_scc1 attn_rp_pl_ni
    s_cmp_lt_u32 s7, 256
    s_cselect_b32 s52, s24, s32
    s_cselect_b32 s53, s25, s33
    s_mov_b32 s10, 38797312
    s_cselect_b32 s10, 4194304, s10
    s_cselect_b32 s8, 0, 256
    s_sub_u32 s9, s7, s8
    s_lshr_b32 s8, s9, 4
    s_lshl_b32 s8, s8, 17
    s_and_b32 s9, s9, 15
    s_add_u32 s7, s7, 1
    s_lshl_b32 s9, s9, 7
    s_add_u32 s9, s9, s8
    s_add_u32 s52, s52, s9
    s_addc_u32 s53, s53, 0
    s_add_u32 s54, s52, 65536
    s_addc_u32 s55, s53, 0
    s_add_u32 m0, s12, 0
    s_nop 0
    global_load_lds_dwordx4 v4, s[52:53]
    s_add_u32 m0, s12, 1024
    s_nop 0
    global_load_lds_dwordx4 v5, s[52:53]
    s_add_u32 m0, s12, 2048
    s_nop 0
    global_load_lds_dwordx4 v6, s[52:53]
    s_add_u32 m0, s12, 3072
    s_nop 0
    global_load_lds_dwordx4 v7, s[52:53]
    s_add_u32 m0, s12, 4096
    s_nop 0
    global_load_lds_dwordx4 v4, s[54:55]
    s_add_u32 m0, s12, 5120
    s_nop 0
    global_load_lds_dwordx4 v5, s[54:55]
    s_add_u32 m0, s12, 6144
    s_nop 0
    global_load_lds_dwordx4 v6, s[54:55]
    s_add_u32 m0, s12, 7168
    s_nop 0
    global_load_lds_dwordx4 v7, s[54:55]
    s_xor_b32 s12, s12, 0x2000
attn_rp_pl_ni:
    s_cmp_lt_u32 s14, 256
    s_cselect_b32 s52, s24, s32
    s_cselect_b32 s53, s25, s33
    s_mov_b32 s10, 38797312
    s_cselect_b32 s10, 4194304, s10
    s_cselect_b32 s8, 0, 256
    s_sub_u32 s9, s14, s8
    s_lshr_b32 s8, s9, 4
    s_lshl_b32 s8, s8, 17
    s_and_b32 s9, s9, 15
    s_add_u32 s14, s14, 1
    s_lshl_b32 s9, s9, 12
    s_add_u32 s8, s8, s9
    s_add_u32 s8, s8, s10
    s_add_u32 s56, s42, s8
    s_addc_u32 s57, s43, 0
    s_add_u32 s58, s56, 65536
    s_addc_u32 s59, s57, 0
    ds_read_b64_tr_b16 v[28:29], v12 offset:0
    ds_read_b64_tr_b16 v[30:31], v12 offset:512
    ds_read_b64_tr_b16 v[32:33], v13 offset:0
    ds_read_b64_tr_b16 v[34:35], v13 offset:512
    ds_read_b64_tr_b16 v[36:37], v14 offset:0
    ds_read_b64_tr_b16 v[38:39], v14 offset:512
    ds_read_b64_tr_b16 v[40:41], v15 offset:0
    ds_read_b64_tr_b16 v[42:43], v15 offset:512
    ds_read_b64_tr_b16 v[44:45], v12 offset:4096
    ds_read_b64_tr_b16 v[46:47], v12 offset:4608
    ds_read_b64_tr_b16 v[48:49], v13 offset:4096
    ds_read_b64_tr_b16 v[50:51], v13 offset:4608
    ds_read_b64_tr_b16 v[52:53], v14 offset:4096
    ds_read_b64_tr_b16 v[54:55], v14 offset:4608
    ds_read_b64_tr_b16 v[56:57], v15 offset:4096
    ds_read_b64_tr_b16 v[58:59], v15 offset:4608
    s_waitcnt lgkmcnt(14)
    global_store_dwordx4 v2, v[28:31], s[56:57] offset:0 sc1
    s_waitcnt lgkmcnt(12)
    global_store_dwordx4 v2, v[32:35], s[56:57] offset:1024 sc1
    s_waitcnt lgkmcnt(10)
    global_store_dwordx4 v2, v[36:39], s[56:57] offset:2048 sc1
    s_waitcnt lgkmcnt(8)
    global_store_dwordx4 v2, v[40:43], s[56:57] offset:3072 sc1
    s_waitcnt lgkmcnt(6)
    global_store_dwordx4 v2, v[44:47], s[58:59] offset:0 sc1
    s_waitcnt lgkmcnt(4)
    global_store_dwordx4 v2, v[48:51], s[58:59] offset:1024 sc1
    s_waitcnt lgkmcnt(2)
    global_store_dwordx4 v2, v[52:55], s[58:59] offset:2048 sc1
    s_waitcnt lgkmcnt(0)
    global_store_dwordx4 v2, v[56:59], s[58:59] offset:3072 sc1
    v_xor_b32 v12, 0x2000, v12
    v_xor_b32 v13, 0x2000, v13
    v_xor_b32 v14, 0x2000, v14
    v_xor_b32 v15, 0x2000, v15
    s_sub_u32 s11, s11, 1
    s_cmp_lg_u32 s11, 0
    s_nop 4
    s_cbranch_scc1 attn_rp_pl
    s_cmp_ge_u32 s2, 8
    s_cbranch_scc1 attn_rp_end
    s_lshl_b32 s8, s3, 6
    v_add_u32 v127, s8, v1
    s_getpc_b64 s[52:53]
attn_kernel_pc1:
    s_add_u32 s52, s52, attn_code_end-attn_kernel_pc1
    s_addc_u32 s53, s53, (attn_code_end-attn_kernel_pc1)>>32
    v_lshlrev_b32 v124, 7, v127
    v_min_u32 v125, code_end-attn_code_end-4, v124
    global_load_dword v126, v125, s[52:53]
    v_add_u32 v124, 16384, v124
    v_min_u32 v125, code_end-attn_code_end-4, v124
    global_load_dword v126, v125, s[52:53]
    v_add_u32 v124, 16384, v124
attn_rp_end:
    s_endpgm
attn_rp_mod:
    s_sub_u32 s4, s2, 160
    s_lshl_b32 s4, s4, 1
    s_add_u32 s4, s4, s3
    s_and_b32 s5, s4, 3
    s_lshr_b32 s4, s4, 2
    s_cmp_ge_u32 s4, 16
    s_cselect_b32 s8, 64, 32
    s_add_u32 s4, s4, s8
    s_lshl_b32 s6, s5, 8
    v_lshrrev_b32 v124, 3, v1
    v_mul_u32_u24 v124, 12288, v124
    v_lshrrev_b32 v125, 3, v1
    v_and_b32 v125, 2, v125
    v_xor_b32 v125, v125, v1
    v_and_b32 v125, 7, v125
    v_lshlrev_b32 v125, 4, v125
    v_add_u32 v4, v124, v125
    v_xor_b32 v125, 64, v125
    v_add_u32 v5, v124, v125
    v_add_u32 v5, 98304, v5
    v_add_u32 v6, 196608, v4
    v_add_u32 v7, 196608, v5
    v_lshrrev_b32 v124, 4, v1
    v_bfe_u32 v125, v1, 2, 2
    v_lshlrev_b32 v126, 3, v124
    v_add_u32 v126, v126, v125
    v_lshlrev_b32 v126, 7, v126
    v_add_u32 v126, s12, v126
    v_lshrrev_b32 v125, 1, v125
    v_and_b32 v124, 1, v124
    v_lshl_or_b32 v124, v124, 1, v125
    v_lshlrev_b32 v124, 5, v124
    v_and_b32 v125, 3, v1
    v_lshl_add_u32 v126, v125, 3, v126
    v_xor_b32 v125, 0, v124
    v_add_u32 v12, v126, v125
    v_xor_b32 v125, 32, v124
    v_add_u32 v13, v126, v125
    v_xor_b32 v125, 64, v124
    v_add_u32 v14, v126, v125
    v_xor_b32 v125, 96, v124
    v_add_u32 v15, v126, v125
    v_mov_b32 v60, 0
    v_mov_b32 v61, 0
    v_mov_b32 v62, 0
    v_mov_b32 v63, 0
    v_mov_b32 v64, 0
    v_mov_b32 v65, 0
    v_mov_b32 v66, 0
    v_mov_b32 v67, 0
    v_mov_b32 v68, 0
    v_mov_b32 v69, 0
    v_mov_b32 v70, 0
    v_mov_b32 v71, 0
    v_mov_b32 v72, 0
    v_mov_b32 v73, 0
    v_mov_b32 v74, 0
    v_mov_b32 v75, 0
    v_lshrrev_b32 v128, 4, v1
    v_lshlrev_b32 v128, 4, v128
    s_lshl_b32 s8, s6, 1
    s_add_u32 s8, s8, 126976
    s_add_u32 s52, s42, s8
    s_addc_u32 s53, s43, 0
    global_load_dwordx4 v[92:95], v128, s[52:53]
    global_load_dwordx4 v[96:99], v128, s[52:53] offset:64
    s_mul_i32 s8, s6, 12288
    s_lshl_b32 s9, s4, 7
    s_add_u32 s8, s8, s9
    s_add_u32 s52, s36, s8
    s_addc_u32 s53, s37, 0
    s_add_u32 s54, s52, 393216
    s_addc_u32 s55, s53, 0
    s_add_u32 m0, s12, 0
    s_nop 0
    global_load_lds_dwordx4 v4, s[52:53]
    s_add_u32 m0, s12, 1024
    s_nop 0
    global_load_lds_dwordx4 v5, s[52:53]
    s_add_u32 m0, s12, 2048
    s_nop 0
    global_load_lds_dwordx4 v6, s[52:53]
    s_add_u32 m0, s12, 3072
    s_nop 0
    global_load_lds_dwordx4 v7, s[52:53]
    s_add_u32 m0, s12, 4096
    s_nop 0
    global_load_lds_dwordx4 v4, s[54:55]
    s_add_u32 m0, s12, 5120
    s_nop 0
    global_load_lds_dwordx4 v5, s[54:55]
    s_add_u32 m0, s12, 6144
    s_nop 0
    global_load_lds_dwordx4 v6, s[54:55]
    s_add_u32 m0, s12, 7168
    s_nop 0
    global_load_lds_dwordx4 v7, s[54:55]
    s_add_u32 s6, s6, 64
    s_xor_b32 s12, s12, 0x2000
    s_waitcnt vmcnt(0)
    s_mov_b32 s11, 4
attn_rp_md:
    s_waitcnt vmcnt(0)
    v_mov_b32 v20, v92
    v_mov_b32 v21, v93
    v_mov_b32 v22, v94
    v_mov_b32 v23, v95
    v_mov_b32 v24, v96
    v_mov_b32 v25, v97
    v_mov_b32 v26, v98
    v_mov_b32 v27, v99
    s_cmp_eq_u32 s11, 1
    s_cbranch_scc1 attn_rp_md_ni
    s_lshl_b32 s8, s6, 1
    s_add_u32 s8, s8, 126976
    s_add_u32 s52, s42, s8
    s_addc_u32 s53, s43, 0
    global_load_dwordx4 v[92:95], v128, s[52:53]
    global_load_dwordx4 v[96:99], v128, s[52:53] offset:64
    s_mul_i32 s8, s6, 12288
    s_lshl_b32 s9, s4, 7
    s_add_u32 s8, s8, s9
    s_add_u32 s52, s36, s8
    s_addc_u32 s53, s37, 0
    s_add_u32 s54, s52, 393216
    s_addc_u32 s55, s53, 0
    s_add_u32 m0, s12, 0
    s_nop 0
    global_load_lds_dwordx4 v4, s[52:53]
    s_add_u32 m0, s12, 1024
    s_nop 0
    global_load_lds_dwordx4 v5, s[52:53]
    s_add_u32 m0, s12, 2048
    s_nop 0
    global_load_lds_dwordx4 v6, s[52:53]
    s_add_u32 m0, s12, 3072
    s_nop 0
    global_load_lds_dwordx4 v7, s[52:53]
    s_add_u32 m0, s12, 4096
    s_nop 0
    global_load_lds_dwordx4 v4, s[54:55]
    s_add_u32 m0, s12, 5120
    s_nop 0
    global_load_lds_dwordx4 v5, s[54:55]
    s_add_u32 m0, s12, 6144
    s_nop 0
    global_load_lds_dwordx4 v6, s[54:55]
    s_add_u32 m0, s12, 7168
    s_nop 0
    global_load_lds_dwordx4 v7, s[54:55]
    s_add_u32 s6, s6, 64
    s_xor_b32 s12, s12, 0x2000
attn_rp_md_ni:
    ds_read_b64_tr_b16 v[28:29], v12 offset:0
    ds_read_b64_tr_b16 v[30:31], v12 offset:512
    ds_read_b64_tr_b16 v[32:33], v13 offset:0
    ds_read_b64_tr_b16 v[34:35], v13 offset:512
    ds_read_b64_tr_b16 v[36:37], v14 offset:0
    ds_read_b64_tr_b16 v[38:39], v14 offset:512
    ds_read_b64_tr_b16 v[40:41], v15 offset:0
    ds_read_b64_tr_b16 v[42:43], v15 offset:512
    ds_read_b64_tr_b16 v[44:45], v12 offset:4096
    ds_read_b64_tr_b16 v[46:47], v12 offset:4608
    ds_read_b64_tr_b16 v[48:49], v13 offset:4096
    ds_read_b64_tr_b16 v[50:51], v13 offset:4608
    ds_read_b64_tr_b16 v[52:53], v14 offset:4096
    ds_read_b64_tr_b16 v[54:55], v14 offset:4608
    ds_read_b64_tr_b16 v[56:57], v15 offset:4096
    ds_read_b64_tr_b16 v[58:59], v15 offset:4608
    s_waitcnt lgkmcnt(0)
    v_mfma_f32_16x16x32_bf16 v[60:63], v[28:31], v[20:23], v[60:63]
    v_mfma_f32_16x16x32_bf16 v[64:67], v[32:35], v[20:23], v[64:67]
    v_mfma_f32_16x16x32_bf16 v[68:71], v[36:39], v[20:23], v[68:71]
    v_mfma_f32_16x16x32_bf16 v[72:75], v[40:43], v[20:23], v[72:75]
    v_mfma_f32_16x16x32_bf16 v[60:63], v[44:47], v[24:27], v[60:63]
    v_mfma_f32_16x16x32_bf16 v[64:67], v[48:51], v[24:27], v[64:67]
    v_mfma_f32_16x16x32_bf16 v[68:71], v[52:55], v[24:27], v[68:71]
    v_mfma_f32_16x16x32_bf16 v[72:75], v[56:59], v[24:27], v[72:75]
    v_xor_b32 v12, 0x2000, v12
    v_xor_b32 v13, 0x2000, v13
    v_xor_b32 v14, 0x2000, v14
    v_xor_b32 v15, 0x2000, v15
    s_sub_u32 s11, s11, 1
    s_cmp_lg_u32 s11, 0
    s_nop 4
    s_cbranch_scc1 attn_rp_md
    s_mul_i32 s5, s5, 24576
    s_lshl_b32 s4, s4, 8
    s_add_u32 s4, s4, s5
    s_add_u32 s4, s4, 0
    s_add_u32 s56, s42, s4
    s_addc_u32 s57, s43, 0
    v_and_b32 v125, 15, v1
    v_cmp_eq_u32 vcc, 0, v125
    s_nop 0
    s_and_saveexec_b64 s[60:61], vcc
    global_store_dwordx4 v128, v[60:63], s[56:57] offset:0 sc1
    global_store_dwordx4 v128, v[64:67], s[56:57] offset:64 sc1
    global_store_dwordx4 v128, v[68:71], s[56:57] offset:128 sc1
    global_store_dwordx4 v128, v[72:75], s[56:57] offset:192 sc1
    s_endpgm
attn_code_end:
.globl ffn_kernel
.p2align 8
.type ffn_kernel,@function
ffn_kernel:
    s_load_dwordx2 s[42:43], s[0:1], 104
    s_load_dwordx16 s[16:31], s[0:1], 0
    s_load_dwordx8 s[32:39], s[0:1], 64
    v_and_b32 v1, 63, v0
    v_lshrrev_b32 v2, 6, v0
    s_nop 0
    v_readfirstlane_b32 s3, v2
    s_cmp_ge_u32 s2, 256
    s_cbranch_scc1 ffn_kernel_end
    s_cmp_ge_u32 s3, 4
    s_cbranch_scc1 oproj_kernel_idle
    s_and_b32 s4, s2, 7
    s_lshr_b32 s5, s2, 3
    s_lshr_b32 s6, s4, 1
    s_and_b32 s7, s4, 1
    s_mul_i32 s6, s6, 4
    s_mul_i32 s7, s7, 8
    s_lshr_b32 s56, s5, 3
    s_and_b32 s57, s5, 7
    s_add_u32 s4, s56, s6
    s_add_u32 s5, s57, s7
    v_lshlrev_b32 v2, 4, v1
    s_mul_i32 s8, s3, 4
    s_lshl_b32 s12, s8, 10
    s_lshr_b32 s9, s8, 3
    s_and_b32 s8, s8, 7
    s_lshl_b32 s9, s9, 7
    s_add_u32 s8, s8, s9
    s_lshl_b32 s8, s8, 10
    v_add_u32 v5, s8, v2
    s_mul_i32 s8, s3, 2
    s_min_u32 s8, s8, 6
    s_lshl_b32 s13, s8, 10
    s_add_u32 s13, s13, 16384
    s_lshr_b32 s9, s8, 2
    s_and_b32 s8, s8, 3
    s_mul_i32 s9, s9, 64
    s_add_u32 s8, s8, s9
    s_lshl_b32 s8, s8, 10
    v_add_u32 v6, s8, v2
    s_mul_i32 s8, s4, 8192
    s_add_u32 s8, s8, 10485760
    s_mul_i32 s9, s5, 4096
    s_add_u32 s9, s9, 4194304
    s_mov_b32 s14, 0
    s_waitcnt lgkmcnt(0)
    s_add_u32 s44, s42, s8
    s_addc_u32 s45, s43, 0
    s_add_u32 s46, s42, s9
    s_addc_u32 s47, s43, 0
    s_add_u32 m0, s14, s12
    s_nop 0
    global_load_lds_dwordx4 v5, s[44:45]
    global_load_lds_dwordx4 v5, s[44:45] offset:1024
    global_load_lds_dwordx4 v5, s[44:45] offset:2048
    global_load_lds_dwordx4 v5, s[44:45] offset:3072
    s_add_u32 m0, s14, s13
    s_nop 0
    global_load_lds_dwordx4 v6, s[46:47]
    global_load_lds_dwordx4 v6, s[46:47] offset:1024
    s_add_u32 s44, s44, 262144
    s_addc_u32 s45, s45, 0
    s_add_u32 s46, s46, 131072
    s_addc_u32 s47, s47, 0
    s_add_u32 s14, s14, 24576
    s_cmp_eq_u32 s14, 147456
    s_cselect_b32 s14, 0, s14
    s_add_u32 m0, s14, s12
    s_nop 0
    global_load_lds_dwordx4 v5, s[44:45]
    global_load_lds_dwordx4 v5, s[44:45] offset:1024
    global_load_lds_dwordx4 v5, s[44:45] offset:2048
    global_load_lds_dwordx4 v5, s[44:45] offset:3072
    s_add_u32 m0, s14, s13
    s_nop 0
    global_load_lds_dwordx4 v6, s[46:47]
    global_load_lds_dwordx4 v6, s[46:47] offset:1024
    s_add_u32 s44, s44, 262144
    s_addc_u32 s45, s45, 0
    s_add_u32 s46, s46, 131072
    s_addc_u32 s47, s47, 0
    s_add_u32 s14, s14, 24576
    s_cmp_eq_u32 s14, 147456
    s_cselect_b32 s14, 0, s14
    s_add_u32 m0, s14, s12
    s_nop 0
    global_load_lds_dwordx4 v5, s[44:45]
    global_load_lds_dwordx4 v5, s[44:45] offset:1024
    global_load_lds_dwordx4 v5, s[44:45] offset:2048
    global_load_lds_dwordx4 v5, s[44:45] offset:3072
    s_add_u32 m0, s14, s13
    s_nop 0
    global_load_lds_dwordx4 v6, s[46:47]
    global_load_lds_dwordx4 v6, s[46:47] offset:1024
    s_add_u32 s44, s44, 262144
    s_addc_u32 s45, s45, 0
    s_add_u32 s46, s46, 131072
    s_addc_u32 s47, s47, 0
    s_add_u32 s14, s14, 24576
    s_cmp_eq_u32 s14, 147456
    s_cselect_b32 s14, 0, s14
    s_lshr_b32 s6, s3, 0
    s_and_b32 s7, s3, 0
    v_and_b32 v3, 15, v1
    v_lshrrev_b32 v4, 4, v1
    s_mul_i32 s8, s6, 2048
    v_add_u32 v7, s8, v2
    s_mul_i32 s8, s7, 4096
    s_add_u32 s8, s8, 16384
    v_add_u32 v8, s8, v2
    s_mov_b32 s15, 0
    s_waitcnt vmcnt(12) lgkmcnt(0)
    s_barrier
    v_add_u32 v9, s15, v7
    v_add_u32 v10, s15, v8
    s_add_u32 s15, s15, 24576
    s_cmp_eq_u32 s15, 147456
    s_cselect_b32 s15, 0, s15
    ds_read_b128 v[48:51], v9 offset:0
    ds_read_b128 v[52:55], v9 offset:1024
    ds_read_b128 v[56:59], v10 offset:0
    ds_read_b128 v[60:63], v10 offset:1024
    ds_read_b128 v[64:67], v10 offset:2048
    ds_read_b128 v[68:71], v10 offset:3072
    ds_read_b128 v[72:75], v9 offset:8192
    ds_read_b128 v[76:79], v9 offset:9216
    ds_read_b128 v[80:83], v10 offset:4096
    ds_read_b128 v[84:87], v10 offset:5120
    ds_read_b128 v[88:91], v10 offset:6144
    ds_read_b128 v[92:95], v10 offset:7168
    v_add_u32 v9, s15, v7
    v_add_u32 v10, s15, v8
    s_add_u32 s15, s15, 24576
    s_cmp_eq_u32 s15, 147456
    s_cselect_b32 s15, 0, s15
    s_waitcnt vmcnt(6) lgkmcnt(0)
    s_barrier
    v_mfma_f32_16x16x32_bf16 v[16:19], v[56:59], v[48:51], 0
    ds_read_b128 v[96:99], v9 offset:0
    ds_read_b128 v[100:103], v9 offset:1024
    v_mfma_f32_16x16x32_bf16 v[32:35], v[56:59], v[52:55], 0
    s_add_u32 m0, s14, s12
    s_nop 0
    global_load_lds_dwordx4 v5, s[44:45]
    ds_read_b128 v[104:107], v10 offset:0
    v_mfma_f32_16x16x32_bf16 v[20:23], v[60:63], v[48:51], 0
    ds_read_b128 v[108:111], v10 offset:1024
    global_load_lds_dwordx4 v5, s[44:45] offset:1024
    v_mfma_f32_16x16x32_bf16 v[36:39], v[60:63], v[52:55], 0
    ds_read_b128 v[112:115], v10 offset:2048
    v_mfma_f32_16x16x32_bf16 v[24:27], v[64:67], v[48:51], 0
    ds_read_b128 v[116:119], v10 offset:3072
    global_load_lds_dwordx4 v5, s[44:45] offset:2048
    v_mfma_f32_16x16x32_bf16 v[40:43], v[64:67], v[52:55], 0
    ds_read_b128 v[120:123], v9 offset:8192
    ds_read_b128 v[124:127], v9 offset:9216
    v_mfma_f32_16x16x32_bf16 v[28:31], v[68:71], v[48:51], 0
    global_load_lds_dwordx4 v5, s[44:45] offset:3072
    v_mfma_f32_16x16x32_bf16 v[44:47], v[68:71], v[52:55], 0
    ds_read_b128 v[128:131], v10 offset:4096
    ds_read_b128 v[132:135], v10 offset:5120
    v_mfma_f32_16x16x32_bf16 v[16:19], v[80:83], v[72:75], v[16:19]
    s_add_u32 m0, s14, s13
    s_nop 0
    global_load_lds_dwordx4 v6, s[46:47]
    ds_read_b128 v[136:139], v10 offset:6144
    v_mfma_f32_16x16x32_bf16 v[32:35], v[80:83], v[76:79], v[32:35]
    ds_read_b128 v[140:143], v10 offset:7168
    global_load_lds_dwordx4 v6, s[46:47] offset:1024
    s_add_u32 s44, s44, 262144
    s_addc_u32 s45, s45, 0
    s_add_u32 s46, s46, 131072
    s_addc_u32 s47, s47, 0
    s_add_u32 s14, s14, 24576
    s_cmp_eq_u32 s14, 147456
    s_cselect_b32 s14, 0, s14
    v_mfma_f32_16x16x32_bf16 v[20:23], v[84:87], v[72:75], v[20:23]
    s_add_u32 m0, s14, s12
    s_nop 0
    global_load_lds_dwordx4 v5, s[44:45]
    v_mfma_f32_16x16x32_bf16 v[36:39], v[84:87], v[76:79], v[36:39]
    global_load_lds_dwordx4 v5, s[44:45] offset:1024
    global_load_lds_dwordx4 v5, s[44:45] offset:2048
    v_mfma_f32_16x16x32_bf16 v[24:27], v[88:91], v[72:75], v[24:27]
    global_load_lds_dwordx4 v5, s[44:45] offset:3072
    s_add_u32 m0, s14, s13
    s_nop 0
    global_load_lds_dwordx4 v6, s[46:47]
    v_mfma_f32_16x16x32_bf16 v[40:43], v[88:91], v[76:79], v[40:43]
    global_load_lds_dwordx4 v6, s[46:47] offset:1024
    s_add_u32 s44, s44, 262144
    s_addc_u32 s45, s45, 0
    s_add_u32 s46, s46, 131072
    s_addc_u32 s47, s47, 0
    s_add_u32 s14, s14, 24576
    s_cmp_eq_u32 s14, 147456
    s_cselect_b32 s14, 0, s14
    v_mfma_f32_16x16x32_bf16 v[28:31], v[92:95], v[72:75], v[28:31]
    v_mfma_f32_16x16x32_bf16 v[44:47], v[92:95], v[76:79], v[44:47]
    v_add_u32 v9, s15, v7
    v_add_u32 v10, s15, v8
    s_add_u32 s15, s15, 24576
    s_cmp_eq_u32 s15, 147456
    s_cselect_b32 s15, 0, s15
    s_waitcnt vmcnt(12) lgkmcnt(0)
    s_barrier
    v_mfma_f32_16x16x32_bf16 v[16:19], v[104:107], v[96:99], v[16:19]
    ds_read_b128 v[48:51], v9 offset:0
    ds_read_b128 v[52:55], v9 offset:1024
    v_mfma_f32_16x16x32_bf16 v[32:35], v[104:107], v[100:103], v[32:35]
    s_add_u32 m0, s14, s12
    s_nop 0
    global_load_lds_dwordx4 v5, s[44:45]
    ds_read_b128 v[56:59], v10 offset:0
    v_mfma_f32_16x16x32_bf16 v[20:23], v[108:111], v[96:99], v[20:23]
    ds_read_b128 v[60:63], v10 offset:1024
    global_load_lds_dwordx4 v5, s[44:45] offset:1024
    v_mfma_f32_16x16x32_bf16 v[36:39], v[108:111], v[100:103], v[36:39]
    ds_read_b128 v[64:67], v10 offset:2048
    v_mfma_f32_16x16x32_bf16 v[24:27], v[112:115], v[96:99], v[24:27]
    ds_read_b128 v[68:71], v10 offset:3072
    global_load_lds_dwordx4 v5, s[44:45] offset:2048
    v_mfma_f32_16x16x32_bf16 v[40:43], v[112:115], v[100:103], v[40:43]
    ds_read_b128 v[72:75], v9 offset:8192
    ds_read_b128 v[76:79], v9 offset:9216
    v_mfma_f32_16x16x32_bf16 v[28:31], v[116:119], v[96:99], v[28:31]
    global_load_lds_dwordx4 v5, s[44:45] offset:3072
    v_mfma_f32_16x16x32_bf16 v[44:47], v[116:119], v[100:103], v[44:47]
    ds_read_b128 v[80:83], v10 offset:4096
    ds_read_b128 v[84:87], v10 offset:5120
    v_mfma_f32_16x16x32_bf16 v[16:19], v[128:131], v[120:123], v[16:19]
    s_add_u32 m0, s14, s13
    s_nop 0
    global_load_lds_dwordx4 v6, s[46:47]
    ds_read_b128 v[88:91], v10 offset:6144
    v_mfma_f32_16x16x32_bf16 v[32:35], v[128:131], v[124:127], v[32:35]
    ds_read_b128 v[92:95], v10 offset:7168
    global_load_lds_dwordx4 v6, s[46:47] offset:1024
    s_add_u32 s44, s44, 262144
    s_addc_u32 s45, s45, 0
    s_add_u32 s46, s46, 131072
    s_addc_u32 s47, s47, 0
    s_add_u32 s14, s14, 24576
    s_cmp_eq_u32 s14, 147456
    s_cselect_b32 s14, 0, s14
    v_mfma_f32_16x16x32_bf16 v[20:23], v[132:135], v[120:123], v[20:23]
    s_add_u32 m0, s14, s12
    s_nop 0
    global_load_lds_dwordx4 v5, s[44:45]
    v_mfma_f32_16x16x32_bf16 v[36:39], v[132:135], v[124:127], v[36:39]
    global_load_lds_dwordx4 v5, s[44:45] offset:1024
    global_load_lds_dwordx4 v5, s[44:45] offset:2048
    v_mfma_f32_16x16x32_bf16 v[24:27], v[136:139], v[120:123], v[24:27]
    global_load_lds_dwordx4 v5, s[44:45] offset:3072
    s_add_u32 m0, s14, s13
    s_nop 0
    global_load_lds_dwordx4 v6, s[46:47]
    v_mfma_f32_16x16x32_bf16 v[40:43], v[136:139], v[124:127], v[40:43]
    global_load_lds_dwordx4 v6, s[46:47] offset:1024
    s_add_u32 s44, s44, 262144
    s_addc_u32 s45, s45, 0
    s_add_u32 s46, s46, 131072
    s_addc_u32 s47, s47, 0
    s_add_u32 s14, s14, 24576
    s_cmp_eq_u32 s14, 147456
    s_cselect_b32 s14, 0, s14
    v_mfma_f32_16x16x32_bf16 v[28:31], v[140:143], v[120:123], v[28:31]
    v_mfma_f32_16x16x32_bf16 v[44:47], v[140:143], v[124:127], v[44:47]
    v_add_u32 v9, s15, v7
    v_add_u32 v10, s15, v8
    s_add_u32 s15, s15, 24576
    s_cmp_eq_u32 s15, 147456
    s_cselect_b32 s15, 0, s15
    s_waitcnt vmcnt(18) lgkmcnt(0)
    s_barrier
    v_mfma_f32_16x16x32_bf16 v[16:19], v[56:59], v[48:51], v[16:19]
    ds_read_b128 v[96:99], v9 offset:0
    ds_read_b128 v[100:103], v9 offset:1024
    v_mfma_f32_16x16x32_bf16 v[32:35], v[56:59], v[52:55], v[32:35]
    s_add_u32 m0, s14, s12
    s_nop 0
    global_load_lds_dwordx4 v5, s[44:45]
    ds_read_b128 v[104:107], v10 offset:0
    v_mfma_f32_16x16x32_bf16 v[20:23], v[60:63], v[48:51], v[20:23]
    ds_read_b128 v[108:111], v10 offset:1024
    global_load_lds_dwordx4 v5, s[44:45] offset:1024
    v_mfma_f32_16x16x32_bf16 v[36:39], v[60:63], v[52:55], v[36:39]
    ds_read_b128 v[112:115], v10 offset:2048
    v_mfma_f32_16x16x32_bf16 v[24:27], v[64:67], v[48:51], v[24:27]
    ds_read_b128 v[116:119], v10 offset:3072
    global_load_lds_dwordx4 v5, s[44:45] offset:2048
    v_mfma_f32_16x16x32_bf16 v[40:43], v[64:67], v[52:55], v[40:43]
    ds_read_b128 v[120:123], v9 offset:8192
    ds_read_b128 v[124:127], v9 offset:9216
    v_mfma_f32_16x16x32_bf16 v[28:31], v[68:71], v[48:51], v[28:31]
    global_load_lds_dwordx4 v5, s[44:45] offset:3072
    v_mfma_f32_16x16x32_bf16 v[44:47], v[68:71], v[52:55], v[44:47]
    ds_read_b128 v[128:131], v10 offset:4096
    ds_read_b128 v[132:135], v10 offset:5120
    v_mfma_f32_16x16x32_bf16 v[16:19], v[80:83], v[72:75], v[16:19]
    s_add_u32 m0, s14, s13
    s_nop 0
    global_load_lds_dwordx4 v6, s[46:47]
    ds_read_b128 v[136:139], v10 offset:6144
    v_mfma_f32_16x16x32_bf16 v[32:35], v[80:83], v[76:79], v[32:35]
    ds_read_b128 v[140:143], v10 offset:7168
    global_load_lds_dwordx4 v6, s[46:47] offset:1024
    s_add_u32 s44, s44, 262144
    s_addc_u32 s45, s45, 0
    s_add_u32 s46, s46, 131072
    s_addc_u32 s47, s47, 0
    s_add_u32 s14, s14, 24576
    s_cmp_eq_u32 s14, 147456
    s_cselect_b32 s14, 0, s14
    v_mfma_f32_16x16x32_bf16 v[20:23], v[84:87], v[72:75], v[20:23]
    s_add_u32 m0, s14, s12
    s_nop 0
    global_load_lds_dwordx4 v5, s[44:45]
    v_mfma_f32_16x16x32_bf16 v[36:39], v[84:87], v[76:79], v[36:39]
    global_load_lds_dwordx4 v5, s[44:45] offset:1024
    global_load_lds_dwordx4 v5, s[44:45] offset:2048
    v_mfma_f32_16x16x32_bf16 v[24:27], v[88:91], v[72:75], v[24:27]
    global_load_lds_dwordx4 v5, s[44:45] offset:3072
    s_add_u32 m0, s14, s13
    s_nop 0
    global_load_lds_dwordx4 v6, s[46:47]
    v_mfma_f32_16x16x32_bf16 v[40:43], v[88:91], v[76:79], v[40:43]
    global_load_lds_dwordx4 v6, s[46:47] offset:1024
    s_add_u32 s44, s44, 262144
    s_addc_u32 s45, s45, 0
    s_add_u32 s46, s46, 131072
    s_addc_u32 s47, s47, 0
    s_add_u32 s14, s14, 24576
    s_cmp_eq_u32 s14, 147456
    s_cselect_b32 s14, 0, s14
    v_mfma_f32_16x16x32_bf16 v[28:31], v[92:95], v[72:75], v[28:31]
    v_mfma_f32_16x16x32_bf16 v[44:47], v[92:95], v[76:79], v[44:47]
    s_mov_b32 s11, 3
oproj_kernel_loop:
    v_add_u32 v9, s15, v7
    v_add_u32 v10, s15, v8
    s_add_u32 s15, s15, 24576
    s_cmp_eq_u32 s15, 147456
    s_cselect_b32 s15, 0, s15
    s_waitcnt vmcnt(24) lgkmcnt(0)
    s_barrier
    v_mfma_f32_16x16x32_bf16 v[16:19], v[104:107], v[96:99], v[16:19]
    ds_read_b128 v[48:51], v9 offset:0
    ds_read_b128 v[52:55], v9 offset:1024
    v_mfma_f32_16x16x32_bf16 v[32:35], v[104:107], v[100:103], v[32:35]
    s_add_u32 m0, s14, s12
    s_nop 0
    global_load_lds_dwordx4 v5, s[44:45]
    v_mfma_f32_16x16x32_bf16 v[20:23], v[108:111], v[96:99], v[20:23]
    ds_read_b128 v[56:59], v10 offset:0
    v_mfma_f32_16x16x32_bf16 v[36:39], v[108:111], v[100:103], v[36:39]
    ds_read_b128 v[60:63], v10 offset:1024
    global_load_lds_dwordx4 v5, s[44:45] offset:1024
    v_mfma_f32_16x16x32_bf16 v[24:27], v[112:115], v[96:99], v[24:27]
    ds_read_b128 v[64:67], v10 offset:2048
    v_mfma_f32_16x16x32_bf16 v[40:43], v[112:115], v[100:103], v[40:43]
    ds_read_b128 v[68:71], v10 offset:3072
    v_mfma_f32_16x16x32_bf16 v[28:31], v[116:119], v[96:99], v[28:31]
    global_load_lds_dwordx4 v5, s[44:45] offset:2048
    v_mfma_f32_16x16x32_bf16 v[44:47], v[116:119], v[100:103], v[44:47]
    ds_read_b128 v[72:75], v9 offset:8192
    ds_read_b128 v[76:79], v9 offset:9216
    v_mfma_f32_16x16x32_bf16 v[16:19], v[128:131], v[120:123], v[16:19]
    global_load_lds_dwordx4 v5, s[44:45] offset:3072
    v_mfma_f32_16x16x32_bf16 v[32:35], v[128:131], v[124:127], v[32:35]
    ds_read_b128 v[80:83], v10 offset:4096
    v_mfma_f32_16x16x32_bf16 v[20:23], v[132:135], v[120:123], v[20:23]
    ds_read_b128 v[84:87], v10 offset:5120
    s_add_u32 m0, s14, s13
    s_nop 0
    global_load_lds_dwordx4 v6, s[46:47]
    v_mfma_f32_16x16x32_bf16 v[36:39], v[132:135], v[124:127], v[36:39]
    ds_read_b128 v[88:91], v10 offset:6144
    v_mfma_f32_16x16x32_bf16 v[24:27], v[136:139], v[120:123], v[24:27]
    ds_read_b128 v[92:95], v10 offset:7168
    v_mfma_f32_16x16x32_bf16 v[40:43], v[136:139], v[124:127], v[40:43]
    global_load_lds_dwordx4 v6, s[46:47] offset:1024
    s_add_u32 s44, s44, 262144
    s_addc_u32 s45, s45, 0
    s_add_u32 s46, s46, 131072
    s_addc_u32 s47, s47, 0
    s_add_u32 s14, s14, 24576
    s_cmp_eq_u32 s14, 147456
    s_cselect_b32 s14, 0, s14
    v_mfma_f32_16x16x32_bf16 v[28:31], v[140:143], v[120:123], v[28:31]
    v_mfma_f32_16x16x32_bf16 v[44:47], v[140:143], v[124:127], v[44:47]
    v_add_u32 v9, s15, v7
    v_add_u32 v10, s15, v8
    s_add_u32 s15, s15, 24576
    s_cmp_eq_u32 s15, 147456
    s_cselect_b32 s15, 0, s15
    s_waitcnt vmcnt(24) lgkmcnt(0)
    s_barrier
    v_mfma_f32_16x16x32_bf16 v[16:19], v[56:59], v[48:51], v[16:19]
    ds_read_b128 v[96:99], v9 offset:0
    ds_read_b128 v[100:103], v9 offset:1024
    v_mfma_f32_16x16x32_bf16 v[32:35], v[56:59], v[52:55], v[32:35]
    s_add_u32 m0, s14, s12
    s_nop 0
    global_load_lds_dwordx4 v5, s[44:45]
    v_mfma_f32_16x16x32_bf16 v[20:23], v[60:63], v[48:51], v[20:23]
    ds_read_b128 v[104:107], v10 offset:0
    v_mfma_f32_16x16x32_bf16 v[36:39], v[60:63], v[52:55], v[36:39]
    ds_read_b128 v[108:111], v10 offset:1024
    global_load_lds_dwordx4 v5, s[44:45] offset:1024
    v_mfma_f32_16x16x32_bf16 v[24:27], v[64:67], v[48:51], v[24:27]
    ds_read_b128 v[112:115], v10 offset:2048
    v_mfma_f32_16x16x32_bf16 v[40:43], v[64:67], v[52:55], v[40:43]
    ds_read_b128 v[116:119], v10 offset:3072
    v_mfma_f32_16x16x32_bf16 v[28:31], v[68:71], v[48:51], v[28:31]
    global_load_lds_dwordx4 v5, s[44:45] offset:2048
    v_mfma_f32_16x16x32_bf16 v[44:47], v[68:71], v[52:55], v[44:47]
    ds_read_b128 v[120:123], v9 offset:8192
    ds_read_b128 v[124:127], v9 offset:9216
    v_mfma_f32_16x16x32_bf16 v[16:19], v[80:83], v[72:75], v[16:19]
    global_load_lds_dwordx4 v5, s[44:45] offset:3072
    v_mfma_f32_16x16x32_bf16 v[32:35], v[80:83], v[76:79], v[32:35]
    ds_read_b128 v[128:131], v10 offset:4096
    v_mfma_f32_16x16x32_bf16 v[20:23], v[84:87], v[72:75], v[20:23]
    ds_read_b128 v[132:135], v10 offset:5120
    s_add_u32 m0, s14, s13
    s_nop 0
    global_load_lds_dwordx4 v6, s[46:47]
    v_mfma_f32_16x16x32_bf16 v[36:39], v[84:87], v[76:79], v[36:39]
    ds_read_b128 v[136:139], v10 offset:6144
    v_mfma_f32_16x16x32_bf16 v[24:27], v[88:91], v[72:75], v[24:27]
    ds_read_b128 v[140:143], v10 offset:7168
    v_mfma_f32_16x16x32_bf16 v[40:43], v[88:91], v[76:79], v[40:43]
    global_load_lds_dwordx4 v6, s[46:47] offset:1024
    s_add_u32 s44, s44, 262144
    s_addc_u32 s45, s45, 0
    s_add_u32 s46, s46, 131072
    s_addc_u32 s47, s47, 0
    s_add_u32 s14, s14, 24576
    s_cmp_eq_u32 s14, 147456
    s_cselect_b32 s14, 0, s14
    v_mfma_f32_16x16x32_bf16 v[28:31], v[92:95], v[72:75], v[28:31]
    v_mfma_f32_16x16x32_bf16 v[44:47], v[92:95], v[76:79], v[44:47]
    s_sub_u32 s11, s11, 1
    s_cmp_lg_u32 s11, 0
    s_cbranch_scc1 oproj_kernel_loop
    v_add_u32 v9, s15, v7
    v_add_u32 v10, s15, v8
    s_add_u32 s15, s15, 24576
    s_cmp_eq_u32 s15, 147456
    s_cselect_b32 s15, 0, s15
    s_waitcnt vmcnt(24) lgkmcnt(0)
    s_barrier
    v_mfma_f32_16x16x32_bf16 v[16:19], v[104:107], v[96:99], v[16:19]
    ds_read_b128 v[48:51], v9 offset:0
    ds_read_b128 v[52:55], v9 offset:1024
    v_mfma_f32_16x16x32_bf16 v[32:35], v[104:107], v[100:103], v[32:35]
    s_add_u32 m0, s14, s12
    s_nop 0
    global_load_lds_dwordx4 v5, s[44:45]
    v_mfma_f32_16x16x32_bf16 v[20:23], v[108:111], v[96:99], v[20:23]
    ds_read_b128 v[56:59], v10 offset:0
    v_mfma_f32_16x16x32_bf16 v[36:39], v[108:111], v[100:103], v[36:39]
    ds_read_b128 v[60:63], v10 offset:1024
    global_load_lds_dwordx4 v5, s[44:45] offset:1024
    v_mfma_f32_16x16x32_bf16 v[24:27], v[112:115], v[96:99], v[24:27]
    ds_read_b128 v[64:67], v10 offset:2048
    v_mfma_f32_16x16x32_bf16 v[40:43], v[112:115], v[100:103], v[40:43]
    ds_read_b128 v[68:71], v10 offset:3072
    v_mfma_f32_16x16x32_bf16 v[28:31], v[116:119], v[96:99], v[28:31]
    global_load_lds_dwordx4 v5, s[44:45] offset:2048
    v_mfma_f32_16x16x32_bf16 v[44:47], v[116:119], v[100:103], v[44:47]
    ds_read_b128 v[72:75], v9 offset:8192
    ds_read_b128 v[76:79], v9 offset:9216
    v_mfma_f32_16x16x32_bf16 v[16:19], v[128:131], v[120:123], v[16:19]
    global_load_lds_dwordx4 v5, s[44:45] offset:3072
    v_mfma_f32_16x16x32_bf16 v[32:35], v[128:131], v[124:127], v[32:35]
    ds_read_b128 v[80:83], v10 offset:4096
    v_mfma_f32_16x16x32_bf16 v[20:23], v[132:135], v[120:123], v[20:23]
    ds_read_b128 v[84:87], v10 offset:5120
    s_add_u32 m0, s14, s13
    s_nop 0
    global_load_lds_dwordx4 v6, s[46:47]
    v_mfma_f32_16x16x32_bf16 v[36:39], v[132:135], v[124:127], v[36:39]
    ds_read_b128 v[88:91], v10 offset:6144
    v_mfma_f32_16x16x32_bf16 v[24:27], v[136:139], v[120:123], v[24:27]
    ds_read_b128 v[92:95], v10 offset:7168
    v_mfma_f32_16x16x32_bf16 v[40:43], v[136:139], v[124:127], v[40:43]
    global_load_lds_dwordx4 v6, s[46:47] offset:1024
    s_add_u32 s44, s44, 262144
    s_addc_u32 s45, s45, 0
    s_add_u32 s46, s46, 131072
    s_addc_u32 s47, s47, 0
    s_add_u32 s14, s14, 24576
    s_cmp_eq_u32 s14, 147456
    s_cselect_b32 s14, 0, s14
    v_mfma_f32_16x16x32_bf16 v[28:31], v[140:143], v[120:123], v[28:31]
    v_mfma_f32_16x16x32_bf16 v[44:47], v[140:143], v[124:127], v[44:47]
    v_add_u32 v9, s15, v7
    v_add_u32 v10, s15, v8
    s_add_u32 s15, s15, 24576
    s_cmp_eq_u32 s15, 147456
    s_cselect_b32 s15, 0, s15
    s_waitcnt vmcnt(24) lgkmcnt(0)
    s_barrier
    v_mfma_f32_16x16x32_bf16 v[16:19], v[56:59], v[48:51], v[16:19]
    ds_read_b128 v[96:99], v9 offset:0
    v_lshlrev_b32 v11, 2, v1
    s_lshl_b32 s8, s5, 8
    s_add_u32 s9, s8, 8192
    v_mfma_f32_16x16x32_bf16 v[32:35], v[56:59], v[52:55], v[32:35]
    ds_read_b128 v[100:103], v9 offset:1024
    s_add_u32 s48, s42, s9
    s_addc_u32 s49, s43, 0
    global_load_dword v192, v11, s[48:49]
    v_mfma_f32_16x16x32_bf16 v[20:23], v[60:63], v[48:51], v[20:23]
    ds_read_b128 v[104:107], v10 offset:0
    s_add_u32 s48, s48, 24576
    s_addc_u32 s49, s49, 0
    global_load_dword v193, v11, s[48:49]
    v_mfma_f32_16x16x32_bf16 v[36:39], v[60:63], v[52:55], v[36:39]
    ds_read_b128 v[108:111], v10 offset:1024
    s_add_u32 s48, s48, 24576
    s_addc_u32 s49, s49, 0
    global_load_dword v194, v11, s[48:49]
    v_mfma_f32_16x16x32_bf16 v[24:27], v[64:67], v[48:51], v[24:27]
    ds_read_b128 v[112:115], v10 offset:2048
    s_add_u32 s48, s48, 24576
    s_addc_u32 s49, s49, 0
    global_load_dword v195, v11, s[48:49]
    v_mfma_f32_16x16x32_bf16 v[40:43], v[64:67], v[52:55], v[40:43]
    ds_read_b128 v[116:119], v10 offset:3072
    s_add_u32 s9, s8, 114688
    s_add_u32 s48, s42, s9
    s_addc_u32 s49, s43, 0
    v_mfma_f32_16x16x32_bf16 v[28:31], v[68:71], v[48:51], v[28:31]
    global_load_dword v196, v11, s[48:49]
    v_lshrrev_b32 v12, 3, v1
    v_lshlrev_b32 v12, 11, v12
    v_mfma_f32_16x16x32_bf16 v[44:47], v[68:71], v[52:55], v[44:47]
    ds_read_b128 v[120:123], v9 offset:8192
    v_and_b32 v14, 7, v1
    v_lshl_add_u32 v12, v14, 4, v12
    s_lshl_b32 s8, s4, 18
    v_mfma_f32_16x16x32_bf16 v[16:19], v[80:83], v[72:75], v[16:19]
    ds_read_b128 v[124:127], v9 offset:9216
    s_lshl_b32 s9, s6, 16
    s_add_u32 s8, s8, s9
    s_lshl_b32 s9, s5, 7
    v_mfma_f32_16x16x32_bf16 v[32:35], v[80:83], v[76:79], v[32:35]
    ds_read_b128 v[128:131], v10 offset:4096
    s_add_u32 s8, s8, s9
    s_add_u32 s50, s16, s8
    s_addc_u32 s51, s17, 0
    v_mfma_f32_16x16x32_bf16 v[20:23], v[84:87], v[72:75], v[20:23]
    ds_read_b128 v[132:135], v10 offset:5120
    s_lshl_b32 s10, s3, 12
    s_add_u32 s10, s10, s14
    s_add_u32 m0, s10, 0
    v_mfma_f32_16x16x32_bf16 v[36:39], v[84:87], v[76:79], v[36:39]
    ds_read_b128 v[136:139], v10 offset:6144
    global_load_lds_dwordx4 v12, s[50:51]
    s_add_u32 s50, s50, 16384
    s_addc_u32 s51, s51, 0
    v_mfma_f32_16x16x32_bf16 v[24:27], v[88:91], v[72:75], v[24:27]
    ds_read_b128 v[140:143], v10 offset:7168
    s_add_u32 m0, s10, 1024
    s_nop 0
    global_load_lds_dwordx4 v12, s[50:51]
    s_add_u32 s50, s50, 16384
    v_mfma_f32_16x16x32_bf16 v[40:43], v[88:91], v[76:79], v[40:43]
    s_addc_u32 s51, s51, 0
    s_add_u32 m0, s10, 2048
    s_nop 0
    global_load_lds_dwordx4 v12, s[50:51]
    v_mfma_f32_16x16x32_bf16 v[28:31], v[92:95], v[72:75], v[28:31]
    s_add_u32 s50, s50, 16384
    s_addc_u32 s51, s51, 0
    v_mfma_f32_16x16x32_bf16 v[44:47], v[92:95], v[76:79], v[44:47]
    s_add_u32 m0, s10, 3072
    s_nop 0
    global_load_lds_dwordx4 v12, s[50:51]
    v_add_u32 v9, s15, v7
    v_add_u32 v10, s15, v8
    s_add_u32 s15, s15, 24576
    s_cmp_eq_u32 s15, 147456
    s_cselect_b32 s15, 0, s15
    s_waitcnt vmcnt(27) lgkmcnt(0)
    s_barrier
    v_mfma_f32_16x16x32_bf16 v[16:19], v[104:107], v[96:99], v[16:19]
    ds_read_b128 v[48:51], v9 offset:0
    v_mfma_f32_16x16x32_bf16 v[32:35], v[104:107], v[100:103], v[32:35]
    ds_read_b128 v[52:55], v9 offset:1024
    v_mfma_f32_16x16x32_bf16 v[20:23], v[108:111], v[96:99], v[20:23]
    ds_read_b128 v[56:59], v10 offset:0
    v_mfma_f32_16x16x32_bf16 v[36:39], v[108:111], v[100:103], v[36:39]
    ds_read_b128 v[60:63], v10 offset:1024
    v_mfma_f32_16x16x32_bf16 v[24:27], v[112:115], v[96:99], v[24:27]
    ds_read_b128 v[64:67], v10 offset:2048
    v_mfma_f32_16x16x32_bf16 v[40:43], v[112:115], v[100:103], v[40:43]
    ds_read_b128 v[68:71], v10 offset:3072
    v_mfma_f32_16x16x32_bf16 v[28:31], v[116:119], v[96:99], v[28:31]
    v_mfma_f32_16x16x32_bf16 v[44:47], v[116:119], v[100:103], v[44:47]
    ds_read_b128 v[72:75], v9 offset:8192
    v_mfma_f32_16x16x32_bf16 v[16:19], v[128:131], v[120:123], v[16:19]
    ds_read_b128 v[76:79], v9 offset:9216
    v_mfma_f32_16x16x32_bf16 v[32:35], v[128:131], v[124:127], v[32:35]
    ds_read_b128 v[80:83], v10 offset:4096
    v_mfma_f32_16x16x32_bf16 v[20:23], v[132:135], v[120:123], v[20:23]
    ds_read_b128 v[84:87], v10 offset:5120
    v_mfma_f32_16x16x32_bf16 v[36:39], v[132:135], v[124:127], v[36:39]
    ds_read_b128 v[88:91], v10 offset:6144
    v_mfma_f32_16x16x32_bf16 v[24:27], v[136:139], v[120:123], v[24:27]
    ds_read_b128 v[92:95], v10 offset:7168
    v_mfma_f32_16x16x32_bf16 v[40:43], v[136:139], v[124:127], v[40:43]
    v_mfma_f32_16x16x32_bf16 v[28:31], v[140:143], v[120:123], v[28:31]
    v_mfma_f32_16x16x32_bf16 v[44:47], v[140:143], v[124:127], v[44:47]
    v_add_u32 v9, s15, v7
    v_add_u32 v10, s15, v8
    s_add_u32 s15, s15, 24576
    s_cmp_eq_u32 s15, 147456
    s_cselect_b32 s15, 0, s15
    s_waitcnt vmcnt(21) lgkmcnt(0)
    s_barrier
    v_mfma_f32_16x16x32_bf16 v[16:19], v[56:59], v[48:51], v[16:19]
    ds_read_b128 v[96:99], v9 offset:0
    v_mfma_f32_16x16x32_bf16 v[32:35], v[56:59], v[52:55], v[32:35]
    ds_read_b128 v[100:103], v9 offset:1024
    v_mfma_f32_16x16x32_bf16 v[20:23], v[60:63], v[48:51], v[20:23]
    ds_read_b128 v[104:107], v10 offset:0
    v_mfma_f32_16x16x32_bf16 v[36:39], v[60:63], v[52:55], v[36:39]
    ds_read_b128 v[108:111], v10 offset:1024
    v_mfma_f32_16x16x32_bf16 v[24:27], v[64:67], v[48:51], v[24:27]
    ds_read_b128 v[112:115], v10 offset:2048
    v_mfma_f32_16x16x32_bf16 v[40:43], v[64:67], v[52:55], v[40:43]
    ds_read_b128 v[116:119], v10 offset:3072
    v_mfma_f32_16x16x32_bf16 v[28:31], v[68:71], v[48:51], v[28:31]
    v_mfma_f32_16x16x32_bf16 v[44:47], v[68:71], v[52:55], v[44:47]
    ds_read_b128 v[120:123], v9 offset:8192
    v_mfma_f32_16x16x32_bf16 v[16:19], v[80:83], v[72:75], v[16:19]
    ds_read_b128 v[124:127], v9 offset:9216
    v_mfma_f32_16x16x32_bf16 v[32:35], v[80:83], v[76:79], v[32:35]
    ds_read_b128 v[128:131], v10 offset:4096
    v_mfma_f32_16x16x32_bf16 v[20:23], v[84:87], v[72:75], v[20:23]
    ds_read_b128 v[132:135], v10 offset:5120
    v_mfma_f32_16x16x32_bf16 v[36:39], v[84:87], v[76:79], v[36:39]
    ds_read_b128 v[136:139], v10 offset:6144
    v_mfma_f32_16x16x32_bf16 v[24:27], v[88:91], v[72:75], v[24:27]
    ds_read_b128 v[140:143], v10 offset:7168
    v_mfma_f32_16x16x32_bf16 v[40:43], v[88:91], v[76:79], v[40:43]
    v_mfma_f32_16x16x32_bf16 v[28:31], v[92:95], v[72:75], v[28:31]
    v_mfma_f32_16x16x32_bf16 v[44:47], v[92:95], v[76:79], v[44:47]
    v_add_u32 v9, s15, v7
    v_add_u32 v10, s15, v8
    s_add_u32 s15, s15, 24576
    s_cmp_eq_u32 s15, 147456
    s_cselect_b32 s15, 0, s15
    s_waitcnt vmcnt(15) lgkmcnt(0)
    s_barrier
    v_mfma_f32_16x16x32_bf16 v[16:19], v[104:107], v[96:99], v[16:19]
    ds_read_b128 v[48:51], v9 offset:0
    s_waitcnt vmcnt(0)
    v_mfma_f32_16x16x32_bf16 v[32:35], v[104:107], v[100:103], v[32:35]
    ds_read_b128 v[52:55], v9 offset:1024
    v_add_f32 v192, v192, v193
    v_mfma_f32_16x16x32_bf16 v[20:23], v[108:111], v[96:99], v[20:23]
    ds_read_b128 v[56:59], v10 offset:0
    v_add_f32 v194, v194, v195
    v_mfma_f32_16x16x32_bf16 v[36:39], v[108:111], v[100:103], v[36:39]
    ds_read_b128 v[60:63], v10 offset:1024
    s_lshl_b32 s8, s3, 9
    v_mfma_f32_16x16x32_bf16 v[24:27], v[112:115], v[96:99], v[24:27]
    ds_read_b128 v[64:67], v10 offset:2048
    s_add_u32 s8, s8, 147456
    v_mfma_f32_16x16x32_bf16 v[40:43], v[112:115], v[100:103], v[40:43]
    ds_read_b128 v[68:71], v10 offset:3072
    v_add_f32 v192, v192, v194
    v_mfma_f32_16x16x32_bf16 v[28:31], v[116:119], v[96:99], v[28:31]
    v_add_u32 v11, s8, v11
    v_mfma_f32_16x16x32_bf16 v[44:47], v[116:119], v[100:103], v[44:47]
    ds_read_b128 v[72:75], v9 offset:8192
    v_cvt_pk_bf16_f32 v192, v192, v192
    v_mfma_f32_16x16x32_bf16 v[16:19], v[128:131], v[120:123], v[16:19]
    ds_read_b128 v[76:79], v9 offset:9216
    v_lshlrev_b32 v192, 16, v192
    v_mfma_f32_16x16x32_bf16 v[32:35], v[128:131], v[124:127], v[32:35]
    ds_read_b128 v[80:83], v10 offset:4096
    ds_write_b32 v11, v192
    v_mfma_f32_16x16x32_bf16 v[20:23], v[132:135], v[120:123], v[20:23]
    ds_read_b128 v[84:87], v10 offset:5120
    ds_write_b32 v11, v196 offset:256
    v_mfma_f32_16x16x32_bf16 v[36:39], v[132:135], v[124:127], v[36:39]
    ds_read_b128 v[88:91], v10 offset:6144
    v_lshlrev_b32 v13, 4, v4
    v_mfma_f32_16x16x32_bf16 v[24:27], v[136:139], v[120:123], v[24:27]
    ds_read_b128 v[92:95], v10 offset:7168
    v_add_u32 v13, s8, v13
    v_mfma_f32_16x16x32_bf16 v[40:43], v[136:139], v[124:127], v[40:43]
    v_lshlrev_b32 v14, 7, v3
    v_mfma_f32_16x16x32_bf16 v[28:31], v[140:143], v[120:123], v[28:31]
    v_lshl_add_u32 v14, v4, 3, v14
    v_mfma_f32_16x16x32_bf16 v[44:47], v[140:143], v[124:127], v[44:47]
    v_add_u32 v14, s10, v14
    v_add_u32 v9, s15, v7
    v_add_u32 v10, s15, v8
    s_add_u32 s15, s15, 24576
    s_cmp_eq_u32 s15, 147456
    s_cselect_b32 s15, 0, s15
    s_waitcnt vmcnt(9) lgkmcnt(0)
    s_barrier
    v_mfma_f32_16x16x32_bf16 v[16:19], v[56:59], v[48:51], v[16:19]
    ds_read_b128 v[96:99], v9 offset:0
    v_mfma_f32_16x16x32_bf16 v[32:35], v[56:59], v[52:55], v[32:35]
    ds_read_b128 v[100:103], v9 offset:1024
    v_mfma_f32_16x16x32_bf16 v[20:23], v[60:63], v[48:51], v[20:23]
    ds_read_b128 v[104:107], v10 offset:0
    v_mfma_f32_16x16x32_bf16 v[36:39], v[60:63], v[52:55], v[36:39]
    ds_read_b128 v[108:111], v10 offset:1024
    v_mfma_f32_16x16x32_bf16 v[24:27], v[64:67], v[48:51], v[24:27]
    ds_read_b128 v[112:115], v10 offset:2048
    v_mfma_f32_16x16x32_bf16 v[40:43], v[64:67], v[52:55], v[40:43]
    ds_read_b128 v[116:119], v10 offset:3072
    v_mfma_f32_16x16x32_bf16 v[28:31], v[68:71], v[48:51], v[28:31]
    v_mfma_f32_16x16x32_bf16 v[44:47], v[68:71], v[52:55], v[44:47]
    ds_read_b128 v[120:123], v9 offset:8192
    v_mfma_f32_16x16x32_bf16 v[16:19], v[80:83], v[72:75], v[16:19]
    ds_read_b128 v[124:127], v9 offset:9216
    v_mfma_f32_16x16x32_bf16 v[32:35], v[80:83], v[76:79], v[32:35]
    ds_read_b128 v[128:131], v10 offset:4096
    v_mfma_f32_16x16x32_bf16 v[20:23], v[84:87], v[72:75], v[20:23]
    ds_read_b128 v[132:135], v10 offset:5120
    v_mfma_f32_16x16x32_bf16 v[36:39], v[84:87], v[76:79], v[36:39]
    ds_read_b128 v[136:139], v10 offset:6144
    v_mfma_f32_16x16x32_bf16 v[24:27], v[88:91], v[72:75], v[24:27]
    ds_read_b128 v[140:143], v10 offset:7168
    v_mfma_f32_16x16x32_bf16 v[40:43], v[88:91], v[76:79], v[40:43]
    v_mfma_f32_16x16x32_bf16 v[28:31], v[92:95], v[72:75], v[28:31]
    v_mfma_f32_16x16x32_bf16 v[44:47], v[92:95], v[76:79], v[44:47]
    s_waitcnt lgkmcnt(0)
    v_mfma_f32_16x16x32_bf16 v[16:19], v[104:107], v[96:99], v[16:19]
    v_mfma_f32_16x16x32_bf16 v[32:35], v[104:107], v[100:103], v[32:35]
    v_mfma_f32_16x16x32_bf16 v[20:23], v[108:111], v[96:99], v[20:23]
    v_mfma_f32_16x16x32_bf16 v[36:39], v[108:111], v[100:103], v[36:39]
    v_mfma_f32_16x16x32_bf16 v[24:27], v[112:115], v[96:99], v[24:27]
    v_mfma_f32_16x16x32_bf16 v[40:43], v[112:115], v[100:103], v[40:43]
    v_mfma_f32_16x16x32_bf16 v[28:31], v[116:119], v[96:99], v[28:31]
    v_mfma_f32_16x16x32_bf16 v[44:47], v[116:119], v[100:103], v[44:47]
    v_mfma_f32_16x16x32_bf16 v[16:19], v[128:131], v[120:123], v[16:19]
    v_mfma_f32_16x16x32_bf16 v[32:35], v[128:131], v[124:127], v[32:35]
    v_mfma_f32_16x16x32_bf16 v[20:23], v[132:135], v[120:123], v[20:23]
    v_mfma_f32_16x16x32_bf16 v[36:39], v[132:135], v[124:127], v[36:39]
    v_mfma_f32_16x16x32_bf16 v[24:27], v[136:139], v[120:123], v[24:27]
    v_mfma_f32_16x16x32_bf16 v[40:43], v[136:139], v[124:127], v[40:43]
    v_mfma_f32_16x16x32_bf16 v[28:31], v[140:143], v[120:123], v[28:31]
    v_mfma_f32_16x16x32_bf16 v[44:47], v[140:143], v[124:127], v[44:47]
    ds_read_b64 v[144:145], v14 offset:0
    ds_read_b64 v[146:147], v14 offset:32
    ds_read_b64 v[148:149], v14 offset:64
    ds_read_b64 v[150:151], v14 offset:96
    ds_read_b64 v[152:153], v14 offset:2048
    ds_read_b64 v[154:155], v14 offset:2080
    ds_read_b64 v[156:157], v14 offset:2112
    ds_read_b64 v[158:159], v14 offset:2144
    ds_read_b128 v[176:179], v13 offset:0
    ds_read_b128 v[180:183], v13 offset:64
    ds_read_b128 v[184:187], v13 offset:128
    ds_read_b128 v[188:191], v13 offset:192
    ds_read_b128 v[160:163], v13 offset:256
    ds_read_b128 v[164:167], v13 offset:320
    ds_read_b128 v[168:171], v13 offset:384
    ds_read_b128 v[172:175], v13 offset:448
    s_lshl_b32 s8, s4, 4
    s_add_u32 s8, s8, s5
    s_lshl_b32 s8, s8, 2
    s_add_u32 s8, s8, s3
    s_lshl_b32 s8, s8, 12
    s_add_u32 s8, s8, 14680064
    s_add_u32 s48, s42, s8
    s_addc_u32 s49, s43, 0
    s_lshl_b32 s9, s5, 18
    s_lshl_b32 s10, s4, 13
    s_add_u32 s9, s9, s10
    s_lshl_b32 s10, s6, 11
    s_add_u32 s9, s9, s10
    s_add_u32 s9, s9, 18874368
    s_add_u32 s50, s42, s9
    s_addc_u32 s51, s43, 0
    s_add_u32 s52, s50, 131072
    s_addc_u32 s53, s51, 0
    s_lshl_b32 s9, s5, 14
    s_lshl_b32 s10, s4, 10
    s_add_u32 s9, s9, s10
    s_lshl_b32 s10, s6, 8
    s_add_u32 s9, s9, s10
    s_add_u32 s9, s9, 62914560
    s_add_u32 s54, s42, s9
    s_addc_u32 s55, s43, 0
    v_and_b32 v11, 1, v4
    v_lshlrev_b32 v11, 9, v11
    v_lshrrev_b32 v12, 1, v4
    v_lshl_add_u32 v11, v12, 8, v11
    v_lshl_add_u32 v11, v3, 4, v11
    s_waitcnt lgkmcnt(0)
    v_lshlrev_b32 v48, 16, v144
    v_and_b32 v49, 0xffff0000, v144
    v_lshlrev_b32 v50, 16, v145
    v_and_b32 v51, 0xffff0000, v145
    v_lshlrev_b32 v52, 16, v146
    v_and_b32 v53, 0xffff0000, v146
    v_lshlrev_b32 v54, 16, v147
    v_and_b32 v55, 0xffff0000, v147
    v_lshlrev_b32 v56, 16, v148
    v_and_b32 v57, 0xffff0000, v148
    v_lshlrev_b32 v58, 16, v149
    v_and_b32 v59, 0xffff0000, v149
    v_lshlrev_b32 v60, 16, v150
    v_and_b32 v61, 0xffff0000, v150
    v_lshlrev_b32 v62, 16, v151
    v_and_b32 v63, 0xffff0000, v151
    v_pk_fma_f32 v[48:49], v[176:177], v[16:17], v[48:49]
    v_pk_fma_f32 v[50:51], v[178:179], v[18:19], v[50:51]
    v_pk_fma_f32 v[52:53], v[180:181], v[20:21], v[52:53]
    v_pk_fma_f32 v[54:55], v[182:183], v[22:23], v[54:55]
    v_pk_fma_f32 v[56:57], v[184:185], v[24:25], v[56:57]
    v_pk_fma_f32 v[58:59], v[186:187], v[26:27], v[58:59]
    v_pk_fma_f32 v[60:61], v[188:189], v[28:29], v[60:61]
    v_pk_fma_f32 v[62:63], v[190:191], v[30:31], v[62:63]
    v_cvt_pk_bf16_f32 v64, v48, v49
    v_cvt_pk_bf16_f32 v65, v50, v51
    v_cvt_pk_bf16_f32 v66, v52, v53
    v_cvt_pk_bf16_f32 v67, v54, v55
    v_cvt_pk_bf16_f32 v68, v56, v57
    v_cvt_pk_bf16_f32 v69, v58, v59
    v_cvt_pk_bf16_f32 v70, v60, v61
    v_cvt_pk_bf16_f32 v71, v62, v63
    v_lshlrev_b32 v48, 16, v64
    v_and_b32 v49, 0xffff0000, v64
    v_lshlrev_b32 v50, 16, v65
    v_and_b32 v51, 0xffff0000, v65
    v_lshlrev_b32 v52, 16, v66
    v_and_b32 v53, 0xffff0000, v66
    v_lshlrev_b32 v54, 16, v67
    v_and_b32 v55, 0xffff0000, v67
    v_lshlrev_b32 v56, 16, v68
    v_and_b32 v57, 0xffff0000, v68
    v_lshlrev_b32 v58, 16, v69
    v_and_b32 v59, 0xffff0000, v69
    v_lshlrev_b32 v60, 16, v70
    v_and_b32 v61, 0xffff0000, v70
    v_lshlrev_b32 v62, 16, v71
    v_and_b32 v63, 0xffff0000, v71
    v_pk_mul_f32 v[16:17], v[48:49], v[160:161]
    v_pk_mul_f32 v[18:19], v[50:51], v[162:163]
    v_pk_mul_f32 v[20:21], v[52:53], v[164:165]
    v_pk_mul_f32 v[22:23], v[54:55], v[166:167]
    v_pk_mul_f32 v[24:25], v[56:57], v[168:169]
    v_pk_mul_f32 v[26:27], v[58:59], v[170:171]
    v_pk_mul_f32 v[28:29], v[60:61], v[172:173]
    v_pk_mul_f32 v[30:31], v[62:63], v[174:175]
    v_cvt_pk_bf16_f32 v72, v16, v17
    v_cvt_pk_bf16_f32 v73, v18, v19
    v_cvt_pk_bf16_f32 v74, v20, v21
    v_cvt_pk_bf16_f32 v75, v22, v23
    v_cvt_pk_bf16_f32 v76, v24, v25
    v_cvt_pk_bf16_f32 v77, v26, v27
    v_cvt_pk_bf16_f32 v78, v28, v29
    v_cvt_pk_bf16_f32 v79, v30, v31
    v_permlane16_swap_b32 v72, v74
    v_permlane16_swap_b32 v73, v75
    global_store_dwordx4 v11, v[72:75], s[50:51] offset:0 sc1
    v_permlane16_swap_b32 v76, v78
    v_permlane16_swap_b32 v77, v79
    global_store_dwordx4 v11, v[76:79], s[52:53] offset:0 sc1
    v_pk_add_f32 v[16:17], v[48:49], v[50:51]
    v_pk_add_f32 v[16:17], v[16:17], v[52:53]
    v_pk_add_f32 v[16:17], v[16:17], v[54:55]
    v_pk_add_f32 v[16:17], v[16:17], v[56:57]
    v_pk_add_f32 v[16:17], v[16:17], v[58:59]
    v_pk_add_f32 v[16:17], v[16:17], v[60:61]
    v_pk_add_f32 v[16:17], v[16:17], v[62:63]
    v_add_f32 v112, v16, v17
    v_lshlrev_b32 v80, 16, v152
    v_and_b32 v81, 0xffff0000, v152
    v_lshlrev_b32 v82, 16, v153
    v_and_b32 v83, 0xffff0000, v153
    v_lshlrev_b32 v84, 16, v154
    v_and_b32 v85, 0xffff0000, v154
    v_lshlrev_b32 v86, 16, v155
    v_and_b32 v87, 0xffff0000, v155
    v_lshlrev_b32 v88, 16, v156
    v_and_b32 v89, 0xffff0000, v156
    v_lshlrev_b32 v90, 16, v157
    v_and_b32 v91, 0xffff0000, v157
    v_lshlrev_b32 v92, 16, v158
    v_and_b32 v93, 0xffff0000, v158
    v_lshlrev_b32 v94, 16, v159
    v_and_b32 v95, 0xffff0000, v159
    v_pk_fma_f32 v[80:81], v[176:177], v[32:33], v[80:81]
    v_pk_fma_f32 v[82:83], v[178:179], v[34:35], v[82:83]
    v_pk_fma_f32 v[84:85], v[180:181], v[36:37], v[84:85]
    v_pk_fma_f32 v[86:87], v[182:183], v[38:39], v[86:87]
    v_pk_fma_f32 v[88:89], v[184:185], v[40:41], v[88:89]
    v_pk_fma_f32 v[90:91], v[186:187], v[42:43], v[90:91]
    v_pk_fma_f32 v[92:93], v[188:189], v[44:45], v[92:93]
    v_pk_fma_f32 v[94:95], v[190:191], v[46:47], v[94:95]
    v_cvt_pk_bf16_f32 v96, v80, v81
    v_cvt_pk_bf16_f32 v97, v82, v83
    v_cvt_pk_bf16_f32 v98, v84, v85
    v_cvt_pk_bf16_f32 v99, v86, v87
    v_cvt_pk_bf16_f32 v100, v88, v89
    v_cvt_pk_bf16_f32 v101, v90, v91
    v_cvt_pk_bf16_f32 v102, v92, v93
    v_cvt_pk_bf16_f32 v103, v94, v95
    v_lshlrev_b32 v80, 16, v96
    v_and_b32 v81, 0xffff0000, v96
    v_lshlrev_b32 v82, 16, v97
    v_and_b32 v83, 0xffff0000, v97
    v_lshlrev_b32 v84, 16, v98
    v_and_b32 v85, 0xffff0000, v98
    v_lshlrev_b32 v86, 16, v99
    v_and_b32 v87, 0xffff0000, v99
    v_lshlrev_b32 v88, 16, v100
    v_and_b32 v89, 0xffff0000, v100
    v_lshlrev_b32 v90, 16, v101
    v_and_b32 v91, 0xffff0000, v101
    v_lshlrev_b32 v92, 16, v102
    v_and_b32 v93, 0xffff0000, v102
    v_lshlrev_b32 v94, 16, v103
    v_and_b32 v95, 0xffff0000, v103
    v_pk_mul_f32 v[32:33], v[80:81], v[160:161]
    v_pk_mul_f32 v[34:35], v[82:83], v[162:163]
    v_pk_mul_f32 v[36:37], v[84:85], v[164:165]
    v_pk_mul_f32 v[38:39], v[86:87], v[166:167]
    v_pk_mul_f32 v[40:41], v[88:89], v[168:169]
    v_pk_mul_f32 v[42:43], v[90:91], v[170:171]
    v_pk_mul_f32 v[44:45], v[92:93], v[172:173]
    v_pk_mul_f32 v[46:47], v[94:95], v[174:175]
    v_cvt_pk_bf16_f32 v104, v32, v33
    v_cvt_pk_bf16_f32 v105, v34, v35
    v_cvt_pk_bf16_f32 v106, v36, v37
    v_cvt_pk_bf16_f32 v107, v38, v39
    v_cvt_pk_bf16_f32 v108, v40, v41
    v_cvt_pk_bf16_f32 v109, v42, v43
    v_cvt_pk_bf16_f32 v110, v44, v45
    v_cvt_pk_bf16_f32 v111, v46, v47
    v_permlane16_swap_b32 v104, v106
    v_permlane16_swap_b32 v105, v107
    global_store_dwordx4 v11, v[104:107], s[50:51] offset:1024 sc1
    v_permlane16_swap_b32 v108, v110
    v_permlane16_swap_b32 v109, v111
    global_store_dwordx4 v11, v[108:111], s[52:53] offset:1024 sc1
    v_pk_add_f32 v[32:33], v[80:81], v[82:83]
    v_pk_add_f32 v[32:33], v[32:33], v[84:85]
    v_pk_add_f32 v[32:33], v[32:33], v[86:87]
    v_pk_add_f32 v[32:33], v[32:33], v[88:89]
    v_pk_add_f32 v[32:33], v[32:33], v[90:91]
    v_pk_add_f32 v[32:33], v[32:33], v[92:93]
    v_pk_add_f32 v[32:33], v[32:33], v[94:95]
    v_add_f32 v113, v32, v33
    v_mov_b32 v116, v112
    v_mov_b32 v117, v113
    s_nop 0
    v_permlane16_swap_b32 v112, v116
    v_permlane16_swap_b32 v113, v117
    v_add_f32 v112, v112, v116
    v_add_f32 v113, v113, v117
    v_mov_b32 v116, v112
    v_mov_b32 v117, v113
    s_nop 0
    v_permlane32_swap_b32 v112, v116
    v_permlane32_swap_b32 v113, v117
    v_add_f32 v112, v112, v116
    v_add_f32 v113, v113, v117
    v_mul_f32 v116, 0xbc800000, v112
    v_pk_add_f32 v[48:49], v[48:49], v[116:117] op_sel_hi:[1,0]
    v_pk_add_f32 v[50:51], v[50:51], v[116:117] op_sel_hi:[1,0]
    v_pk_add_f32 v[52:53], v[52:53], v[116:117] op_sel_hi:[1,0]
    v_pk_add_f32 v[54:55], v[54:55], v[116:117] op_sel_hi:[1,0]
    v_pk_add_f32 v[56:57], v[56:57], v[116:117] op_sel_hi:[1,0]
    v_pk_add_f32 v[58:59], v[58:59], v[116:117] op_sel_hi:[1,0]
    v_pk_add_f32 v[60:61], v[60:61], v[116:117] op_sel_hi:[1,0]
    v_pk_add_f32 v[62:63], v[62:63], v[116:117] op_sel_hi:[1,0]
    v_pk_mul_f32 v[16:17], v[48:49], v[48:49]
    v_pk_fma_f32 v[16:17], v[50:51], v[50:51], v[16:17]
    v_pk_fma_f32 v[16:17], v[52:53], v[52:53], v[16:17]
    v_pk_fma_f32 v[16:17], v[54:55], v[54:55], v[16:17]
    v_pk_fma_f32 v[16:17], v[56:57], v[56:57], v[16:17]
    v_pk_fma_f32 v[16:17], v[58:59], v[58:59], v[16:17]
    v_pk_fma_f32 v[16:17], v[60:61], v[60:61], v[16:17]
    v_pk_fma_f32 v[16:17], v[62:63], v[62:63], v[16:17]
    v_add_f32 v114, v16, v17
    v_mul_f32 v116, 0xbc800000, v113
    v_pk_add_f32 v[80:81], v[80:81], v[116:117] op_sel_hi:[1,0]
    v_pk_add_f32 v[82:83], v[82:83], v[116:117] op_sel_hi:[1,0]
    v_pk_add_f32 v[84:85], v[84:85], v[116:117] op_sel_hi:[1,0]
    v_pk_add_f32 v[86:87], v[86:87], v[116:117] op_sel_hi:[1,0]
    v_pk_add_f32 v[88:89], v[88:89], v[116:117] op_sel_hi:[1,0]
    v_pk_add_f32 v[90:91], v[90:91], v[116:117] op_sel_hi:[1,0]
    v_pk_add_f32 v[92:93], v[92:93], v[116:117] op_sel_hi:[1,0]
    v_pk_add_f32 v[94:95], v[94:95], v[116:117] op_sel_hi:[1,0]
    v_pk_mul_f32 v[32:33], v[80:81], v[80:81]
    v_pk_fma_f32 v[32:33], v[82:83], v[82:83], v[32:33]
    v_pk_fma_f32 v[32:33], v[84:85], v[84:85], v[32:33]
    v_pk_fma_f32 v[32:33], v[86:87], v[86:87], v[32:33]
    v_pk_fma_f32 v[32:33], v[88:89], v[88:89], v[32:33]
    v_pk_fma_f32 v[32:33], v[90:91], v[90:91], v[32:33]
    v_pk_fma_f32 v[32:33], v[92:93], v[92:93], v[32:33]
    v_pk_fma_f32 v[32:33], v[94:95], v[94:95], v[32:33]
    v_add_f32 v115, v32, v33
    v_mov_b32 v116, v114
    v_mov_b32 v117, v115
    s_nop 0
    v_permlane16_swap_b32 v114, v116
    v_permlane16_swap_b32 v115, v117
    v_add_f32 v114, v114, v116
    v_add_f32 v115, v115, v117
    v_mov_b32 v116, v114
    v_mov_b32 v117, v115
    s_nop 0
    v_permlane32_swap_b32 v114, v116
    v_permlane32_swap_b32 v115, v117
    v_add_f32 v114, v114, v116
    v_add_f32 v115, v115, v117
    v_cmp_lt_u32 vcc, 15, v1
    s_nop 1
    v_cndmask_b32 v116, v112, v113, vcc
    v_cndmask_b32 v117, v114, v115, vcc
    v_lshlrev_b32 v12, 3, v1
    s_mov_b64 exec, 0xffffffff
    global_store_dwordx2 v12, v[116:117], s[54:55] sc1
    s_mov_b64 exec, -1
    s_mov_b64 s[58:59], s[48:49]
    s_waitcnt vmcnt(0)
    s_branch oproj_kernel_join
oproj_kernel_idle:
    s_mov_b32 s11, 16
oproj_kernel_idle_loop:
    s_barrier
    s_sub_u32 s11, s11, 1
    s_cmp_lg_u32 s11, 0
    s_cbranch_scc1 oproj_kernel_idle_loop
    s_waitcnt lgkmcnt(0)
    s_mov_b64 s[58:59], s[42:43]
    v_lshlrev_b32 v2, 4, v1
oproj_kernel_join:
    s_barrier
    s_cmp_lg_u32 s3, 7
    s_cbranch_scc1 ffn_kernel_sig1
    s_bfe_u32 s8, s2, 0x20001
    s_lshl_b32 s8, s8, 1
    s_lshr_b32 s9, s2, 7
    s_add_u32 s8, s8, s9
    s_add_u32 s63, s8, 24
    s_and_b32 s9, s2, 0x21
    s_cmp_eq_u32 s9, 0
    s_cselect_b32 s9, 0x10001, 1
    s_lshl_b32 s8, s8, 8
    s_add_u32 s8, s8, 81788928
    s_add_u32 s48, s42, s8
    s_addc_u32 s49, s43, 0
    v_lshlrev_b32 v11, 14, v1
    v_mov_b32 v12, s9
    s_mov_b64 exec, 0xff
    global_atomic_add v11, v12, s[48:49] sc1
    s_mov_b64 exec, -1
ffn_kernel_sig1:
    s_and_b32 s4, s2, 7
    s_lshr_b32 s5, s2, 3
    s_lshr_b32 s6, s4, 2
    s_and_b32 s7, s4, 3
    s_mul_i32 s6, s6, 4
    s_mul_i32 s7, s7, 8
    s_lshr_b32 s56, s5, 3
    s_and_b32 s57, s5, 7
    s_add_u32 s4, s56, s6
    s_add_u32 s5, s57, s7
    v_lshlrev_b32 v2, 4, v1
    s_mul_i32 s8, s3, 2
    s_lshl_b32 s12, s8, 10
    s_lshl_b32 s8, s8, 10
    v_add_u32 v5, s8, v2
    s_mul_i32 s8, s3, 2
    s_min_u32 s8, s8, 12
    s_lshl_b32 s13, s8, 10
    s_add_u32 s13, s13, 16384
    s_lshl_b32 s8, s8, 10
    v_add_u32 v6, s8, v2
    s_mul_i32 s8, s4, 16384
    s_add_u32 s8, s8, 18874368
    s_mul_i32 s9, s5, 14336
    s_add_u32 s9, s9, 23068672
    s_mov_b32 s14, 0
    s_waitcnt lgkmcnt(0)
    s_add_u32 s44, s42, s8
    s_addc_u32 s45, s43, 0
    s_add_u32 s46, s42, s9
    s_addc_u32 s47, s43, 0
    s_lshr_b32 s10, s2, 3
    s_and_b32 s10, s10, 7
    s_lshl_b32 s10, s10, 14
    s_add_u32 s10, s10, 81788928
    s_mov_b32 s8, s4
    s_lshl_b32 s8, s8, 8
    s_add_u32 s8, s8, s10
    s_add_u32 s54, s42, s8
    s_addc_u32 s55, s43, 0
    s_cmp_lg_u32 s3, 7
    s_cbranch_scc1 ffn_kernel_dep2
    s_mov_b32 s8, s4
    s_lshl_b32 s8, s8, 8
    s_add_u32 s8, s8, s10
    s_add_u32 s48, s42, s8
    s_addc_u32 s49, s43, 0
    v_mov_b32 v11, 0
    s_mov_b32 s11, 131072
    s_mov_b64 exec, 1
ffn_kernel_poll3:
    s_sleep 6
    s_sub_u32 s11, s11, 1
    s_cbranch_scc1 ffn_kernel_end
    global_load_dword v12, v11, s[48:49] sc1
    s_waitcnt vmcnt(0)
    v_cmp_le_u32 vcc, 524288, v12
    s_nop 4
    s_cbranch_vccz ffn_kernel_poll3
    s_mov_b64 exec, -1
ffn_kernel_dep2:
    s_add_u32 m0, s13, 0
    s_nop 0
    global_load_lds_dwordx4 v6, s[46:47] offset:0
    global_load_lds_dwordx4 v6, s[46:47] offset:1024
    s_add_u32 s46, s46, 458752
    s_addc_u32 s47, s47, 0
    s_add_u32 m0, s13, 30720
    s_nop 0
    global_load_lds_dwordx4 v6, s[46:47] offset:0
    global_load_lds_dwordx4 v6, s[46:47] offset:1024
    s_add_u32 s46, s46, 458752
    s_addc_u32 s47, s47, 0
    s_add_u32 m0, s13, 61440
    s_nop 0
    global_load_lds_dwordx4 v6, s[46:47] offset:0
    global_load_lds_dwordx4 v6, s[46:47] offset:1024
    s_add_u32 s46, s46, 458752
    s_addc_u32 s47, s47, 0
    s_add_u32 m0, s13, 92160
    s_nop 0
    global_load_lds_dwordx4 v6, s[46:47] offset:0
    global_load_lds_dwordx4 v6, s[46:47] offset:1024
    s_add_u32 s46, s46, 458752
    s_addc_u32 s47, s47, 0
    s_add_u32 m0, s13, 122880
    s_nop 0
    global_load_lds_dwordx4 v6, s[46:47] offset:0
    global_load_lds_dwordx4 v6, s[46:47] offset:1024
    s_add_u32 s46, s46, 458752
    s_addc_u32 s47, s47, 0
    s_barrier
    s_add_u32 m0, s12, 0
    s_nop 0
    global_load_lds_dwordx4 v5, s[44:45] offset:0 sc1
    global_load_lds_dwordx4 v5, s[44:45] offset:1024 sc1
    s_add_u32 s44, s44, 131072
    s_addc_u32 s45, s45, 0
    s_add_u32 m0, s12, 30720
    s_nop 0
    global_load_lds_dwordx4 v5, s[44:45] offset:0 sc1
    global_load_lds_dwordx4 v5, s[44:45] offset:1024 sc1
    s_add_u32 s44, s44, 131072
    s_addc_u32 s45, s45, 0
    s_add_u32 m0, s12, 61440
    s_nop 0
    global_load_lds_dwordx4 v5, s[44:45] offset:0 sc1
    global_load_lds_dwordx4 v5, s[44:45] offset:1024 sc1
    s_add_u32 s44, s44, 131072
    s_addc_u32 s45, s45, 0
    s_add_u32 m0, s12, 92160
    s_nop 0
    global_load_lds_dwordx4 v5, s[44:45] offset:0 sc1
    global_load_lds_dwordx4 v5, s[44:45] offset:1024 sc1
    s_add_u32 s44, s44, 131072
    s_addc_u32 s45, s45, 0
    s_add_u32 m0, s12, 122880
    s_nop 0
    global_load_lds_dwordx4 v5, s[44:45] offset:0 sc1
    global_load_lds_dwordx4 v5, s[44:45] offset:1024 sc1
    s_add_u32 s44, s44, 131072
    s_addc_u32 s45, s45, 0
    s_cmp_ge_u32 s3, 4
    s_cbranch_scc1 ffn_nox2
    global_store_dwordx4 v2, v[64:67], s[58:59] offset:0 sc1
    global_store_dwordx4 v2, v[68:71], s[58:59] offset:1024 sc1
    global_store_dwordx4 v2, v[96:99], s[58:59] offset:2048 sc1
    global_store_dwordx4 v2, v[100:103], s[58:59] offset:3072 sc1
ffn_nox2:
    s_mov_b32 s14, 0
    s_lshr_b32 s6, s3, 1
    s_and_b32 s7, s3, 1
    v_and_b32 v3, 15, v1
    v_lshrrev_b32 v4, 4, v1
    s_mul_i32 s8, s6, 4096
    v_add_u32 v7, s8, v2
    s_mul_i32 s8, s7, 7168
    s_add_u32 s8, s8, 16384
    v_add_u32 v8, s8, v2
    s_mov_b32 s15, 0
    s_waitcnt vmcnt(8) lgkmcnt(0)
    s_barrier
    v_add_u32 v9, s15, v7
    v_add_u32 v10, s15, v8
    s_add_u32 s15, s15, 30720
    s_cmp_eq_u32 s15, 153600
    s_cselect_b32 s15, 0, s15
    ds_read_b128 v[128:131], v9 offset:0
    ds_read_b128 v[132:135], v9 offset:1024
    ds_read_b128 v[136:139], v9 offset:2048
    ds_read_b128 v[140:143], v9 offset:3072
    ds_read_b128 v[144:147], v10 offset:0
    ds_read_b128 v[148:151], v10 offset:1024
    ds_read_b128 v[152:155], v10 offset:2048
    ds_read_b128 v[156:159], v10 offset:3072
    ds_read_b128 v[160:163], v10 offset:4096
    ds_read_b128 v[164:167], v10 offset:5120
    ds_read_b128 v[168:171], v10 offset:6144
    v_add_u32 v9, s15, v7
    v_add_u32 v10, s15, v8
    s_add_u32 s15, s15, 30720
    s_cmp_eq_u32 s15, 153600
    s_cselect_b32 s15, 0, s15
    s_waitcnt vmcnt(6) lgkmcnt(0)
    s_barrier
    v_mfma_f32_16x16x32_bf16 v[16:19], v[144:147], v[128:131], 0
    ds_read_b128 v[172:175], v9 offset:0
    v_mfma_f32_16x16x32_bf16 v[44:47], v[144:147], v[132:135], 0
    ds_read_b128 v[176:179], v9 offset:1024
    v_mfma_f32_16x16x32_bf16 v[72:75], v[144:147], v[136:139], 0
    v_mfma_f32_16x16x32_bf16 v[100:103], v[144:147], v[140:143], 0
    s_add_u32 m0, s14, s12
    s_nop 0
    global_load_lds_dwordx4 v5, s[44:45] sc1
    v_mfma_f32_16x16x32_bf16 v[20:23], v[148:151], v[128:131], 0
    v_mfma_f32_16x16x32_bf16 v[48:51], v[148:151], v[132:135], 0
    ds_read_b128 v[180:183], v9 offset:2048
    v_mfma_f32_16x16x32_bf16 v[76:79], v[148:151], v[136:139], 0
    ds_read_b128 v[184:187], v9 offset:3072
    v_mfma_f32_16x16x32_bf16 v[104:107], v[148:151], v[140:143], 0
    v_mfma_f32_16x16x32_bf16 v[24:27], v[152:155], v[128:131], 0
    global_load_lds_dwordx4 v5, s[44:45] offset:1024 sc1
    v_mfma_f32_16x16x32_bf16 v[52:55], v[152:155], v[132:135], 0
    v_mfma_f32_16x16x32_bf16 v[80:83], v[152:155], v[136:139], 0
    ds_read_b128 v[188:191], v10 offset:0
    v_mfma_f32_16x16x32_bf16 v[108:111], v[152:155], v[140:143], 0
    ds_read_b128 v[192:195], v10 offset:1024
    v_mfma_f32_16x16x32_bf16 v[28:31], v[156:159], v[128:131], 0
    v_mfma_f32_16x16x32_bf16 v[56:59], v[156:159], v[132:135], 0
    s_add_u32 m0, s14, s13
    s_nop 0
    global_load_lds_dwordx4 v6, s[46:47]
    v_mfma_f32_16x16x32_bf16 v[84:87], v[156:159], v[136:139], 0
    v_mfma_f32_16x16x32_bf16 v[112:115], v[156:159], v[140:143], 0
    ds_read_b128 v[196:199], v10 offset:2048
    v_mfma_f32_16x16x32_bf16 v[32:35], v[160:163], v[128:131], 0
    ds_read_b128 v[200:203], v10 offset:3072
    v_mfma_f32_16x16x32_bf16 v[60:63], v[160:163], v[132:135], 0
    v_mfma_f32_16x16x32_bf16 v[88:91], v[160:163], v[136:139], 0
    global_load_lds_dwordx4 v6, s[46:47] offset:1024
    s_add_u32 s44, s44, 131072
    s_addc_u32 s45, s45, 0
    s_add_u32 s46, s46, 458752
    s_addc_u32 s47, s47, 0
    s_add_u32 s14, s14, 30720
    s_cmp_eq_u32 s14, 153600
    s_cselect_b32 s14, 0, s14
    v_mfma_f32_16x16x32_bf16 v[116:119], v[160:163], v[140:143], 0
    v_mfma_f32_16x16x32_bf16 v[36:39], v[164:167], v[128:131], 0
    ds_read_b128 v[204:207], v10 offset:4096
    v_mfma_f32_16x16x32_bf16 v[64:67], v[164:167], v[132:135], 0
    ds_read_b128 v[208:211], v10 offset:5120
    v_mfma_f32_16x16x32_bf16 v[92:95], v[164:167], v[136:139], 0
    v_mfma_f32_16x16x32_bf16 v[120:123], v[164:167], v[140:143], 0
    ds_read_b128 v[212:215], v10 offset:6144
    v_mfma_f32_16x16x32_bf16 v[40:43], v[168:171], v[128:131], 0
    v_mfma_f32_16x16x32_bf16 v[68:71], v[168:171], v[132:135], 0
    v_mfma_f32_16x16x32_bf16 v[96:99], v[168:171], v[136:139], 0
    v_mfma_f32_16x16x32_bf16 v[124:127], v[168:171], v[140:143], 0
    v_add_u32 v9, s15, v7
    v_add_u32 v10, s15, v8
    s_add_u32 s15, s15, 30720
    s_cmp_eq_u32 s15, 153600
    s_cselect_b32 s15, 0, s15
    s_waitcnt vmcnt(8) lgkmcnt(0)
    s_barrier
    v_mfma_f32_16x16x32_bf16 v[16:19], v[188:191], v[172:175], v[16:19]
    ds_read_b128 v[128:131], v9 offset:0
    v_mfma_f32_16x16x32_bf16 v[44:47], v[188:191], v[176:179], v[44:47]
    ds_read_b128 v[132:135], v9 offset:1024
    v_mfma_f32_16x16x32_bf16 v[72:75], v[188:191], v[180:183], v[72:75]
    v_mfma_f32_16x16x32_bf16 v[100:103], v[188:191], v[184:187], v[100:103]
    s_add_u32 m0, s14, s12
    s_nop 0
    global_load_lds_dwordx4 v5, s[44:45] sc1
    v_mfma_f32_16x16x32_bf16 v[20:23], v[192:195], v[172:175], v[20:23]
    v_mfma_f32_16x16x32_bf16 v[48:51], v[192:195], v[176:179], v[48:51]
    ds_read_b128 v[136:139], v9 offset:2048
    v_mfma_f32_16x16x32_bf16 v[76:79], v[192:195], v[180:183], v[76:79]
    ds_read_b128 v[140:143], v9 offset:3072
    v_mfma_f32_16x16x32_bf16 v[104:107], v[192:195], v[184:187], v[104:107]
    v_mfma_f32_16x16x32_bf16 v[24:27], v[196:199], v[172:175], v[24:27]
    global_load_lds_dwordx4 v5, s[44:45] offset:1024 sc1
    v_mfma_f32_16x16x32_bf16 v[52:55], v[196:199], v[176:179], v[52:55]
    v_mfma_f32_16x16x32_bf16 v[80:83], v[196:199], v[180:183], v[80:83]
    ds_read_b128 v[144:147], v10 offset:0
    v_mfma_f32_16x16x32_bf16 v[108:111], v[196:199], v[184:187], v[108:111]
    ds_read_b128 v[148:151], v10 offset:1024
    v_mfma_f32_16x16x32_bf16 v[28:31], v[200:203], v[172:175], v[28:31]
    v_mfma_f32_16x16x32_bf16 v[56:59], v[200:203], v[176:179], v[56:59]
    s_add_u32 m0, s14, s13
    s_nop 0
    global_load_lds_dwordx4 v6, s[46:47]
    v_mfma_f32_16x16x32_bf16 v[84:87], v[200:203], v[180:183], v[84:87]
    v_mfma_f32_16x16x32_bf16 v[112:115], v[200:203], v[184:187], v[112:115]
    ds_read_b128 v[152:155], v10 offset:2048
    v_mfma_f32_16x16x32_bf16 v[32:35], v[204:207], v[172:175], v[32:35]
    ds_read_b128 v[156:159], v10 offset:3072
    v_mfma_f32_16x16x32_bf16 v[60:63], v[204:207], v[176:179], v[60:63]
    v_mfma_f32_16x16x32_bf16 v[88:91], v[204:207], v[180:183], v[88:91]
    global_load_lds_dwordx4 v6, s[46:47] offset:1024
    s_add_u32 s44, s44, 131072
    s_addc_u32 s45, s45, 0
    s_add_u32 s46, s46, 458752
    s_addc_u32 s47, s47, 0
    s_add_u32 s14, s14, 30720
    s_cmp_eq_u32 s14, 153600
    s_cselect_b32 s14, 0, s14
    v_mfma_f32_16x16x32_bf16 v[116:119], v[204:207], v[184:187], v[116:119]
    v_mfma_f32_16x16x32_bf16 v[36:39], v[208:211], v[172:175], v[36:39]
    ds_read_b128 v[160:163], v10 offset:4096
    v_mfma_f32_16x16x32_bf16 v[64:67], v[208:211], v[176:179], v[64:67]
    ds_read_b128 v[164:167], v10 offset:5120
    v_mfma_f32_16x16x32_bf16 v[92:95], v[208:211], v[180:183], v[92:95]
    v_mfma_f32_16x16x32_bf16 v[120:123], v[208:211], v[184:187], v[120:123]
    ds_read_b128 v[168:171], v10 offset:6144
    v_mfma_f32_16x16x32_bf16 v[40:43], v[212:215], v[172:175], v[40:43]
    v_mfma_f32_16x16x32_bf16 v[68:71], v[212:215], v[176:179], v[68:71]
    v_mfma_f32_16x16x32_bf16 v[96:99], v[212:215], v[180:183], v[96:99]
    v_mfma_f32_16x16x32_bf16 v[124:127], v[212:215], v[184:187], v[124:127]
    v_add_u32 v9, s15, v7
    v_add_u32 v10, s15, v8
    s_add_u32 s15, s15, 30720
    s_cmp_eq_u32 s15, 153600
    s_cselect_b32 s15, 0, s15
    s_waitcnt vmcnt(10) lgkmcnt(0)
    s_barrier
    v_mov_b32 v11, 0
    global_load_dword v13, v11, s[54:55] sc1
    v_mfma_f32_16x16x32_bf16 v[16:19], v[144:147], v[128:131], v[16:19]
    ds_read_b128 v[172:175], v9 offset:0
    v_mfma_f32_16x16x32_bf16 v[44:47], v[144:147], v[132:135], v[44:47]
    ds_read_b128 v[176:179], v9 offset:1024
    v_mfma_f32_16x16x32_bf16 v[72:75], v[144:147], v[136:139], v[72:75]
    v_mfma_f32_16x16x32_bf16 v[100:103], v[144:147], v[140:143], v[100:103]
    s_add_u32 m0, s14, s12
    s_nop 0
    global_load_lds_dwordx4 v5, s[44:45] sc1
    v_mfma_f32_16x16x32_bf16 v[20:23], v[148:151], v[128:131], v[20:23]
    v_mfma_f32_16x16x32_bf16 v[48:51], v[148:151], v[132:135], v[48:51]
    ds_read_b128 v[180:183], v9 offset:2048
    v_mfma_f32_16x16x32_bf16 v[76:79], v[148:151], v[136:139], v[76:79]
    ds_read_b128 v[184:187], v9 offset:3072
    v_mfma_f32_16x16x32_bf16 v[104:107], v[148:151], v[140:143], v[104:107]
    v_mfma_f32_16x16x32_bf16 v[24:27], v[152:155], v[128:131], v[24:27]
    global_load_lds_dwordx4 v5, s[44:45] offset:1024 sc1
    v_mfma_f32_16x16x32_bf16 v[52:55], v[152:155], v[132:135], v[52:55]
    v_mfma_f32_16x16x32_bf16 v[80:83], v[152:155], v[136:139], v[80:83]
    ds_read_b128 v[188:191], v10 offset:0
    v_mfma_f32_16x16x32_bf16 v[108:111], v[152:155], v[140:143], v[108:111]
    ds_read_b128 v[192:195], v10 offset:1024
    v_mfma_f32_16x16x32_bf16 v[28:31], v[156:159], v[128:131], v[28:31]
    v_mfma_f32_16x16x32_bf16 v[56:59], v[156:159], v[132:135], v[56:59]
    s_add_u32 m0, s14, s13
    s_nop 0
    global_load_lds_dwordx4 v6, s[46:47]
    v_mfma_f32_16x16x32_bf16 v[84:87], v[156:159], v[136:139], v[84:87]
    v_mfma_f32_16x16x32_bf16 v[112:115], v[156:159], v[140:143], v[112:115]
    ds_read_b128 v[196:199], v10 offset:2048
    v_mfma_f32_16x16x32_bf16 v[32:35], v[160:163], v[128:131], v[32:35]
    ds_read_b128 v[200:203], v10 offset:3072
    v_mfma_f32_16x16x32_bf16 v[60:63], v[160:163], v[132:135], v[60:63]
    v_mfma_f32_16x16x32_bf16 v[88:91], v[160:163], v[136:139], v[88:91]
    global_load_lds_dwordx4 v6, s[46:47] offset:1024
    s_add_u32 s44, s44, 131072
    s_addc_u32 s45, s45, 0
    s_add_u32 s46, s46, 458752
    s_addc_u32 s47, s47, 0
    s_add_u32 s14, s14, 30720
    s_cmp_eq_u32 s14, 153600
    s_cselect_b32 s14, 0, s14
    v_mfma_f32_16x16x32_bf16 v[116:119], v[160:163], v[140:143], v[116:119]
    v_mfma_f32_16x16x32_bf16 v[36:39], v[164:167], v[128:131], v[36:39]
    ds_read_b128 v[204:207], v10 offset:4096
    v_mfma_f32_16x16x32_bf16 v[64:67], v[164:167], v[132:135], v[64:67]
    ds_read_b128 v[208:211], v10 offset:5120
    v_mfma_f32_16x16x32_bf16 v[92:95], v[164:167], v[136:139], v[92:95]
    v_mfma_f32_16x16x32_bf16 v[120:123], v[164:167], v[140:143], v[120:123]
    ds_read_b128 v[212:215], v10 offset:6144
    v_mfma_f32_16x16x32_bf16 v[40:43], v[168:171], v[128:131], v[40:43]
    v_mfma_f32_16x16x32_bf16 v[68:71], v[168:171], v[132:135], v[68:71]
    v_mfma_f32_16x16x32_bf16 v[96:99], v[168:171], v[136:139], v[96:99]
    v_mfma_f32_16x16x32_bf16 v[124:127], v[168:171], v[140:143], v[124:127]
    s_waitcnt vmcnt(4)
    s_mov_b32 s11, 131072
ffn_kernel_fullr5:
    v_readfirstlane_b32 s8, v13
    s_nop 0
    s_and_b32 s8, s8, 0xffff
    s_cmp_ge_u32 s8, 32
    s_cbranch_scc1 ffn_kernel_full4
    s_sub_u32 s11, s11, 1
    s_cbranch_scc1 ffn_kernel_end
    global_load_dword v13, v11, s[54:55] sc1
    s_waitcnt vmcnt(0)
    s_branch ffn_kernel_fullr5
ffn_kernel_full4:
    v_add_u32 v9, s15, v7
    v_add_u32 v10, s15, v8
    s_add_u32 s15, s15, 30720
    s_cmp_eq_u32 s15, 153600
    s_cselect_b32 s15, 0, s15
    s_waitcnt vmcnt(12) lgkmcnt(0)
    s_barrier
    v_mfma_f32_16x16x32_bf16 v[16:19], v[188:191], v[172:175], v[16:19]
    ds_read_b128 v[128:131], v9 offset:0
    v_mfma_f32_16x16x32_bf16 v[44:47], v[188:191], v[176:179], v[44:47]
    ds_read_b128 v[132:135], v9 offset:1024
    v_mfma_f32_16x16x32_bf16 v[72:75], v[188:191], v[180:183], v[72:75]
    v_mfma_f32_16x16x32_bf16 v[100:103], v[188:191], v[184:187], v[100:103]
    s_add_u32 m0, s14, s12
    s_nop 0
    global_load_lds_dwordx4 v5, s[44:45] sc1
    v_mfma_f32_16x16x32_bf16 v[20:23], v[192:195], v[172:175], v[20:23]
    v_mfma_f32_16x16x32_bf16 v[48:51], v[192:195], v[176:179], v[48:51]
    ds_read_b128 v[136:139], v9 offset:2048
    v_mfma_f32_16x16x32_bf16 v[76:79], v[192:195], v[180:183], v[76:79]
    ds_read_b128 v[140:143], v9 offset:3072
    v_mfma_f32_16x16x32_bf16 v[104:107], v[192:195], v[184:187], v[104:107]
    v_mfma_f32_16x16x32_bf16 v[24:27], v[196:199], v[172:175], v[24:27]
    global_load_lds_dwordx4 v5, s[44:45] offset:1024 sc1
    v_mfma_f32_16x16x32_bf16 v[52:55], v[196:199], v[176:179], v[52:55]
    v_mfma_f32_16x16x32_bf16 v[80:83], v[196:199], v[180:183], v[80:83]
    ds_read_b128 v[144:147], v10 offset:0
    v_mfma_f32_16x16x32_bf16 v[108:111], v[196:199], v[184:187], v[108:111]
    ds_read_b128 v[148:151], v10 offset:1024
    v_mfma_f32_16x16x32_bf16 v[28:31], v[200:203], v[172:175], v[28:31]
    v_mfma_f32_16x16x32_bf16 v[56:59], v[200:203], v[176:179], v[56:59]
    s_add_u32 m0, s14, s13
    s_nop 0
    global_load_lds_dwordx4 v6, s[46:47]
    v_mfma_f32_16x16x32_bf16 v[84:87], v[200:203], v[180:183], v[84:87]
    v_mfma_f32_16x16x32_bf16 v[112:115], v[200:203], v[184:187], v[112:115]
    ds_read_b128 v[152:155], v10 offset:2048
    v_mfma_f32_16x16x32_bf16 v[32:35], v[204:207], v[172:175], v[32:35]
    ds_read_b128 v[156:159], v10 offset:3072
    v_mfma_f32_16x16x32_bf16 v[60:63], v[204:207], v[176:179], v[60:63]
    v_mfma_f32_16x16x32_bf16 v[88:91], v[204:207], v[180:183], v[88:91]
    global_load_lds_dwordx4 v6, s[46:47] offset:1024
    s_add_u32 s44, s44, 131072
    s_addc_u32 s45, s45, 0
    s_add_u32 s46, s46, 458752
    s_addc_u32 s47, s47, 0
    s_add_u32 s14, s14, 30720
    s_cmp_eq_u32 s14, 153600
    s_cselect_b32 s14, 0, s14
    v_mfma_f32_16x16x32_bf16 v[116:119], v[204:207], v[184:187], v[116:119]
    v_mfma_f32_16x16x32_bf16 v[36:39], v[208:211], v[172:175], v[36:39]
    ds_read_b128 v[160:163], v10 offset:4096
    v_mfma_f32_16x16x32_bf16 v[64:67], v[208:211], v[176:179], v[64:67]
    ds_read_b128 v[164:167], v10 offset:5120
    v_mfma_f32_16x16x32_bf16 v[92:95], v[208:211], v[180:183], v[92:95]
    v_mfma_f32_16x16x32_bf16 v[120:123], v[208:211], v[184:187], v[120:123]
    ds_read_b128 v[168:171], v10 offset:6144
    v_mfma_f32_16x16x32_bf16 v[40:43], v[212:215], v[172:175], v[40:43]
    v_mfma_f32_16x16x32_bf16 v[68:71], v[212:215], v[176:179], v[68:71]
    v_mfma_f32_16x16x32_bf16 v[96:99], v[212:215], v[180:183], v[96:99]
    v_mfma_f32_16x16x32_bf16 v[124:127], v[212:215], v[184:187], v[124:127]
    v_add_u32 v9, s15, v7
    v_add_u32 v10, s15, v8
    s_add_u32 s15, s15, 30720
    s_cmp_eq_u32 s15, 153600
    s_cselect_b32 s15, 0, s15
    s_waitcnt vmcnt(12) lgkmcnt(0)
    s_barrier
    s_cmp_lg_u32 s3, 7
    s_cbranch_scc1 ffn_kernel_sig6
    s_mov_b32 s8, s63
    s_mov_b32 s9, 1
    s_lshl_b32 s8, s8, 8
    s_add_u32 s8, s8, 81788928
    s_add_u32 s48, s42, s8
    s_addc_u32 s49, s43, 0
    v_lshlrev_b32 v11, 14, v1
    v_mov_b32 v12, s9
    s_mov_b64 exec, 0xff
    global_atomic_add v11, v12, s[48:49] sc1
    s_mov_b64 exec, -1
ffn_kernel_sig6:
    v_mfma_f32_16x16x32_bf16 v[16:19], v[144:147], v[128:131], v[16:19]
    ds_read_b128 v[172:175], v9 offset:0
    v_mfma_f32_16x16x32_bf16 v[44:47], v[144:147], v[132:135], v[44:47]
    ds_read_b128 v[176:179], v9 offset:1024
    v_mfma_f32_16x16x32_bf16 v[72:75], v[144:147], v[136:139], v[72:75]
    v_mfma_f32_16x16x32_bf16 v[100:103], v[144:147], v[140:143], v[100:103]
    s_add_u32 m0, s14, s12
    s_nop 0
    global_load_lds_dwordx4 v5, s[44:45] sc1
    v_mfma_f32_16x16x32_bf16 v[20:23], v[148:151], v[128:131], v[20:23]
    v_mfma_f32_16x16x32_bf16 v[48:51], v[148:151], v[132:135], v[48:51]
    ds_read_b128 v[180:183], v9 offset:2048
    v_mfma_f32_16x16x32_bf16 v[76:79], v[148:151], v[136:139], v[76:79]
    ds_read_b128 v[184:187], v9 offset:3072
    v_mfma_f32_16x16x32_bf16 v[104:107], v[148:151], v[140:143], v[104:107]
    v_mfma_f32_16x16x32_bf16 v[24:27], v[152:155], v[128:131], v[24:27]
    global_load_lds_dwordx4 v5, s[44:45] offset:1024 sc1
    v_mfma_f32_16x16x32_bf16 v[52:55], v[152:155], v[132:135], v[52:55]
    v_mfma_f32_16x16x32_bf16 v[80:83], v[152:155], v[136:139], v[80:83]
    ds_read_b128 v[188:191], v10 offset:0
    v_mfma_f32_16x16x32_bf16 v[108:111], v[152:155], v[140:143], v[108:111]
    ds_read_b128 v[192:195], v10 offset:1024
    v_mfma_f32_16x16x32_bf16 v[28:31], v[156:159], v[128:131], v[28:31]
    v_mfma_f32_16x16x32_bf16 v[56:59], v[156:159], v[132:135], v[56:59]
    s_add_u32 m0, s14, s13
    s_nop 0
    global_load_lds_dwordx4 v6, s[46:47]
    v_mfma_f32_16x16x32_bf16 v[84:87], v[156:159], v[136:139], v[84:87]
    v_mfma_f32_16x16x32_bf16 v[112:115], v[156:159], v[140:143], v[112:115]
    ds_read_b128 v[196:199], v10 offset:2048
    v_mfma_f32_16x16x32_bf16 v[32:35], v[160:163], v[128:131], v[32:35]
    ds_read_b128 v[200:203], v10 offset:3072
    v_mfma_f32_16x16x32_bf16 v[60:63], v[160:163], v[132:135], v[60:63]
    v_mfma_f32_16x16x32_bf16 v[88:91], v[160:163], v[136:139], v[88:91]
    global_load_lds_dwordx4 v6, s[46:47] offset:1024
    s_add_u32 s44, s44, 131072
    s_addc_u32 s45, s45, 0
    s_add_u32 s46, s46, 458752
    s_addc_u32 s47, s47, 0
    s_add_u32 s14, s14, 30720
    s_cmp_eq_u32 s14, 153600
    s_cselect_b32 s14, 0, s14
    v_mfma_f32_16x16x32_bf16 v[116:119], v[160:163], v[140:143], v[116:119]
    v_mfma_f32_16x16x32_bf16 v[36:39], v[164:167], v[128:131], v[36:39]
    ds_read_b128 v[204:207], v10 offset:4096
    v_mfma_f32_16x16x32_bf16 v[64:67], v[164:167], v[132:135], v[64:67]
    ds_read_b128 v[208:211], v10 offset:5120
    v_mfma_f32_16x16x32_bf16 v[92:95], v[164:167], v[136:139], v[92:95]
    v_mfma_f32_16x16x32_bf16 v[120:123], v[164:167], v[140:143], v[120:123]
    ds_read_b128 v[212:215], v10 offset:6144
    v_mfma_f32_16x16x32_bf16 v[40:43], v[168:171], v[128:131], v[40:43]
    v_mfma_f32_16x16x32_bf16 v[68:71], v[168:171], v[132:135], v[68:71]
    v_mfma_f32_16x16x32_bf16 v[96:99], v[168:171], v[136:139], v[96:99]
    v_mfma_f32_16x16x32_bf16 v[124:127], v[168:171], v[140:143], v[124:127]
    s_mov_b32 s11, 10
gateup_kernel_loop:
    v_add_u32 v9, s15, v7
    v_add_u32 v10, s15, v8
    s_add_u32 s15, s15, 30720
    s_cmp_eq_u32 s15, 153600
    s_cselect_b32 s15, 0, s15
    s_waitcnt vmcnt(12) lgkmcnt(0)
    s_barrier
    v_mfma_f32_16x16x32_bf16 v[16:19], v[188:191], v[172:175], v[16:19]
    ds_read_b128 v[128:131], v9 offset:0
    v_mfma_f32_16x16x32_bf16 v[44:47], v[188:191], v[176:179], v[44:47]
    ds_read_b128 v[132:135], v9 offset:1024
    v_mfma_f32_16x16x32_bf16 v[72:75], v[188:191], v[180:183], v[72:75]
    v_mfma_f32_16x16x32_bf16 v[100:103], v[188:191], v[184:187], v[100:103]
    s_add_u32 m0, s14, s12
    s_nop 0
    global_load_lds_dwordx4 v5, s[44:45] sc1
    v_mfma_f32_16x16x32_bf16 v[20:23], v[192:195], v[172:175], v[20:23]
    v_mfma_f32_16x16x32_bf16 v[48:51], v[192:195], v[176:179], v[48:51]
    ds_read_b128 v[136:139], v9 offset:2048
    v_mfma_f32_16x16x32_bf16 v[76:79], v[192:195], v[180:183], v[76:79]
    ds_read_b128 v[140:143], v9 offset:3072
    v_mfma_f32_16x16x32_bf16 v[104:107], v[192:195], v[184:187], v[104:107]
    v_mfma_f32_16x16x32_bf16 v[24:27], v[196:199], v[172:175], v[24:27]
    global_load_lds_dwordx4 v5, s[44:45] offset:1024 sc1
    v_mfma_f32_16x16x32_bf16 v[52:55], v[196:199], v[176:179], v[52:55]
    v_mfma_f32_16x16x32_bf16 v[80:83], v[196:199], v[180:183], v[80:83]
    ds_read_b128 v[144:147], v10 offset:0
    v_mfma_f32_16x16x32_bf16 v[108:111], v[196:199], v[184:187], v[108:111]
    ds_read_b128 v[148:151], v10 offset:1024
    v_mfma_f32_16x16x32_bf16 v[28:31], v[200:203], v[172:175], v[28:31]
    v_mfma_f32_16x16x32_bf16 v[56:59], v[200:203], v[176:179], v[56:59]
    s_add_u32 m0, s14, s13
    s_nop 0
    global_load_lds_dwordx4 v6, s[46:47]
    v_mfma_f32_16x16x32_bf16 v[84:87], v[200:203], v[180:183], v[84:87]
    v_mfma_f32_16x16x32_bf16 v[112:115], v[200:203], v[184:187], v[112:115]
    ds_read_b128 v[152:155], v10 offset:2048
    v_mfma_f32_16x16x32_bf16 v[32:35], v[204:207], v[172:175], v[32:35]
    ds_read_b128 v[156:159], v10 offset:3072
    v_mfma_f32_16x16x32_bf16 v[60:63], v[204:207], v[176:179], v[60:63]
    v_mfma_f32_16x16x32_bf16 v[88:91], v[204:207], v[180:183], v[88:91]
    global_load_lds_dwordx4 v6, s[46:47] offset:1024
    s_add_u32 s44, s44, 131072
    s_addc_u32 s45, s45, 0
    s_add_u32 s46, s46, 458752
    s_addc_u32 s47, s47, 0
    s_add_u32 s14, s14, 30720
    s_cmp_eq_u32 s14, 153600
    s_cselect_b32 s14, 0, s14
    v_mfma_f32_16x16x32_bf16 v[116:119], v[204:207], v[184:187], v[116:119]
    v_mfma_f32_16x16x32_bf16 v[36:39], v[208:211], v[172:175], v[36:39]
    ds_read_b128 v[160:163], v10 offset:4096
    v_mfma_f32_16x16x32_bf16 v[64:67], v[208:211], v[176:179], v[64:67]
    ds_read_b128 v[164:167], v10 offset:5120
    v_mfma_f32_16x16x32_bf16 v[92:95], v[208:211], v[180:183], v[92:95]
    v_mfma_f32_16x16x32_bf16 v[120:123], v[208:211], v[184:187], v[120:123]
    ds_read_b128 v[168:171], v10 offset:6144
    v_mfma_f32_16x16x32_bf16 v[40:43], v[212:215], v[172:175], v[40:43]
    v_mfma_f32_16x16x32_bf16 v[68:71], v[212:215], v[176:179], v[68:71]
    v_mfma_f32_16x16x32_bf16 v[96:99], v[212:215], v[180:183], v[96:99]
    v_mfma_f32_16x16x32_bf16 v[124:127], v[212:215], v[184:187], v[124:127]
    v_add_u32 v9, s15, v7
    v_add_u32 v10, s15, v8
    s_add_u32 s15, s15, 30720
    s_cmp_eq_u32 s15, 153600
    s_cselect_b32 s15, 0, s15
    s_waitcnt vmcnt(12) lgkmcnt(0)
    s_barrier
    v_mfma_f32_16x16x32_bf16 v[16:19], v[144:147], v[128:131], v[16:19]
    ds_read_b128 v[172:175], v9 offset:0
    v_mfma_f32_16x16x32_bf16 v[44:47], v[144:147], v[132:135], v[44:47]
    ds_read_b128 v[176:179], v9 offset:1024
    v_mfma_f32_16x16x32_bf16 v[72:75], v[144:147], v[136:139], v[72:75]
    v_mfma_f32_16x16x32_bf16 v[100:103], v[144:147], v[140:143], v[100:103]
    s_add_u32 m0, s14, s12
    s_nop 0
    global_load_lds_dwordx4 v5, s[44:45] sc1
    v_mfma_f32_16x16x32_bf16 v[20:23], v[148:151], v[128:131], v[20:23]
    v_mfma_f32_16x16x32_bf16 v[48:51], v[148:151], v[132:135], v[48:51]
    ds_read_b128 v[180:183], v9 offset:2048
    v_mfma_f32_16x16x32_bf16 v[76:79], v[148:151], v[136:139], v[76:79]
    ds_read_b128 v[184:187], v9 offset:3072
    v_mfma_f32_16x16x32_bf16 v[104:107], v[148:151], v[140:143], v[104:107]
    v_mfma_f32_16x16x32_bf16 v[24:27], v[152:155], v[128:131], v[24:27]
    global_load_lds_dwordx4 v5, s[44:45] offset:1024 sc1
    v_mfma_f32_16x16x32_bf16 v[52:55], v[152:155], v[132:135], v[52:55]
    v_mfma_f32_16x16x32_bf16 v[80:83], v[152:155], v[136:139], v[80:83]
    ds_read_b128 v[188:191], v10 offset:0
    v_mfma_f32_16x16x32_bf16 v[108:111], v[152:155], v[140:143], v[108:111]
    ds_read_b128 v[192:195], v10 offset:1024
    v_mfma_f32_16x16x32_bf16 v[28:31], v[156:159], v[128:131], v[28:31]
    v_mfma_f32_16x16x32_bf16 v[56:59], v[156:159], v[132:135], v[56:59]
    s_add_u32 m0, s14, s13
    s_nop 0
    global_load_lds_dwordx4 v6, s[46:47]
    v_mfma_f32_16x16x32_bf16 v[84:87], v[156:159], v[136:139], v[84:87]
    v_mfma_f32_16x16x32_bf16 v[112:115], v[156:159], v[140:143], v[112:115]
    ds_read_b128 v[196:199], v10 offset:2048
    v_mfma_f32_16x16x32_bf16 v[32:35], v[160:163], v[128:131], v[32:35]
    ds_read_b128 v[200:203], v10 offset:3072
    v_mfma_f32_16x16x32_bf16 v[60:63], v[160:163], v[132:135], v[60:63]
    v_mfma_f32_16x16x32_bf16 v[88:91], v[160:163], v[136:139], v[88:91]
    global_load_lds_dwordx4 v6, s[46:47] offset:1024
    s_add_u32 s44, s44, 131072
    s_addc_u32 s45, s45, 0
    s_add_u32 s46, s46, 458752
    s_addc_u32 s47, s47, 0
    s_add_u32 s14, s14, 30720
    s_cmp_eq_u32 s14, 153600
    s_cselect_b32 s14, 0, s14
    v_mfma_f32_16x16x32_bf16 v[116:119], v[160:163], v[140:143], v[116:119]
    v_mfma_f32_16x16x32_bf16 v[36:39], v[164:167], v[128:131], v[36:39]
    ds_read_b128 v[204:207], v10 offset:4096
    v_mfma_f32_16x16x32_bf16 v[64:67], v[164:167], v[132:135], v[64:67]
    ds_read_b128 v[208:211], v10 offset:5120
    v_mfma_f32_16x16x32_bf16 v[92:95], v[164:167], v[136:139], v[92:95]
    v_mfma_f32_16x16x32_bf16 v[120:123], v[164:167], v[140:143], v[120:123]
    ds_read_b128 v[212:215], v10 offset:6144
    v_mfma_f32_16x16x32_bf16 v[40:43], v[168:171], v[128:131], v[40:43]
    v_mfma_f32_16x16x32_bf16 v[68:71], v[168:171], v[132:135], v[68:71]
    v_mfma_f32_16x16x32_bf16 v[96:99], v[168:171], v[136:139], v[96:99]
    v_mfma_f32_16x16x32_bf16 v[124:127], v[168:171], v[140:143], v[124:127]
    s_sub_u32 s11, s11, 1
    s_cmp_lg_u32 s11, 0
    s_cbranch_scc1 gateup_kernel_loop
    v_add_u32 v9, s15, v7
    v_add_u32 v10, s15, v8
    s_add_u32 s15, s15, 30720
    s_cmp_eq_u32 s15, 153600
    s_cselect_b32 s15, 0, s15
    s_waitcnt vmcnt(12) lgkmcnt(0)
    s_barrier
    v_mfma_f32_16x16x32_bf16 v[16:19], v[188:191], v[172:175], v[16:19]
    ds_read_b128 v[128:131], v9 offset:0
    v_mfma_f32_16x16x32_bf16 v[44:47], v[188:191], v[176:179], v[44:47]
    ds_read_b128 v[132:135], v9 offset:1024
    v_mfma_f32_16x16x32_bf16 v[72:75], v[188:191], v[180:183], v[72:75]
    v_mfma_f32_16x16x32_bf16 v[100:103], v[188:191], v[184:187], v[100:103]
    s_add_u32 m0, s14, s12
    s_nop 0
    global_load_lds_dwordx4 v5, s[44:45] sc1
    v_mfma_f32_16x16x32_bf16 v[20:23], v[192:195], v[172:175], v[20:23]
    v_mfma_f32_16x16x32_bf16 v[48:51], v[192:195], v[176:179], v[48:51]
    ds_read_b128 v[136:139], v9 offset:2048
    v_mfma_f32_16x16x32_bf16 v[76:79], v[192:195], v[180:183], v[76:79]
    ds_read_b128 v[140:143], v9 offset:3072
    v_mfma_f32_16x16x32_bf16 v[104:107], v[192:195], v[184:187], v[104:107]
    v_mfma_f32_16x16x32_bf16 v[24:27], v[196:199], v[172:175], v[24:27]
    global_load_lds_dwordx4 v5, s[44:45] offset:1024 sc1
    v_mfma_f32_16x16x32_bf16 v[52:55], v[196:199], v[176:179], v[52:55]
    v_mfma_f32_16x16x32_bf16 v[80:83], v[196:199], v[180:183], v[80:83]
    ds_read_b128 v[144:147], v10 offset:0
    v_mfma_f32_16x16x32_bf16 v[108:111], v[196:199], v[184:187], v[108:111]
    ds_read_b128 v[148:151], v10 offset:1024
    v_mfma_f32_16x16x32_bf16 v[28:31], v[200:203], v[172:175], v[28:31]
    v_mfma_f32_16x16x32_bf16 v[56:59], v[200:203], v[176:179], v[56:59]
    s_add_u32 m0, s14, s13
    s_nop 0
    global_load_lds_dwordx4 v6, s[46:47]
    v_mfma_f32_16x16x32_bf16 v[84:87], v[200:203], v[180:183], v[84:87]
    v_mfma_f32_16x16x32_bf16 v[112:115], v[200:203], v[184:187], v[112:115]
    ds_read_b128 v[152:155], v10 offset:2048
    v_mfma_f32_16x16x32_bf16 v[32:35], v[204:207], v[172:175], v[32:35]
    ds_read_b128 v[156:159], v10 offset:3072
    v_mfma_f32_16x16x32_bf16 v[60:63], v[204:207], v[176:179], v[60:63]
    v_mfma_f32_16x16x32_bf16 v[88:91], v[204:207], v[180:183], v[88:91]
    global_load_lds_dwordx4 v6, s[46:47] offset:1024
    s_add_u32 s44, s44, 131072
    s_addc_u32 s45, s45, 0
    s_add_u32 s46, s46, 458752
    s_addc_u32 s47, s47, 0
    s_add_u32 s14, s14, 30720
    s_cmp_eq_u32 s14, 153600
    s_cselect_b32 s14, 0, s14
    v_mfma_f32_16x16x32_bf16 v[116:119], v[204:207], v[184:187], v[116:119]
    v_mfma_f32_16x16x32_bf16 v[36:39], v[208:211], v[172:175], v[36:39]
    ds_read_b128 v[160:163], v10 offset:4096
    v_mfma_f32_16x16x32_bf16 v[64:67], v[208:211], v[176:179], v[64:67]
    ds_read_b128 v[164:167], v10 offset:5120
    v_mfma_f32_16x16x32_bf16 v[92:95], v[208:211], v[180:183], v[92:95]
    v_mfma_f32_16x16x32_bf16 v[120:123], v[208:211], v[184:187], v[120:123]
    ds_read_b128 v[168:171], v10 offset:6144
    v_mfma_f32_16x16x32_bf16 v[40:43], v[212:215], v[172:175], v[40:43]
    v_mfma_f32_16x16x32_bf16 v[68:71], v[212:215], v[176:179], v[68:71]
    v_mfma_f32_16x16x32_bf16 v[96:99], v[212:215], v[180:183], v[96:99]
    v_mfma_f32_16x16x32_bf16 v[124:127], v[212:215], v[184:187], v[124:127]
    v_add_u32 v9, s15, v7
    v_add_u32 v10, s15, v8
    s_add_u32 s15, s15, 30720
    s_cmp_eq_u32 s15, 153600
    s_cselect_b32 s15, 0, s15
    s_waitcnt vmcnt(12) lgkmcnt(0)
    s_barrier
    v_mfma_f32_16x16x32_bf16 v[16:19], v[144:147], v[128:131], v[16:19]
    ds_read_b128 v[172:175], v9 offset:0
    v_mfma_f32_16x16x32_bf16 v[44:47], v[144:147], v[132:135], v[44:47]
    ds_read_b128 v[176:179], v9 offset:1024
    v_mfma_f32_16x16x32_bf16 v[72:75], v[144:147], v[136:139], v[72:75]
    v_mfma_f32_16x16x32_bf16 v[100:103], v[144:147], v[140:143], v[100:103]
    s_add_u32 m0, s14, s12
    s_nop 0
    global_load_lds_dwordx4 v5, s[44:45] sc1
    v_mfma_f32_16x16x32_bf16 v[20:23], v[148:151], v[128:131], v[20:23]
    v_mfma_f32_16x16x32_bf16 v[48:51], v[148:151], v[132:135], v[48:51]
    ds_read_b128 v[180:183], v9 offset:2048
    v_mfma_f32_16x16x32_bf16 v[76:79], v[148:151], v[136:139], v[76:79]
    ds_read_b128 v[184:187], v9 offset:3072
    v_mfma_f32_16x16x32_bf16 v[104:107], v[148:151], v[140:143], v[104:107]
    v_mfma_f32_16x16x32_bf16 v[24:27], v[152:155], v[128:131], v[24:27]
    global_load_lds_dwordx4 v5, s[44:45] offset:1024 sc1
    v_mfma_f32_16x16x32_bf16 v[52:55], v[152:155], v[132:135], v[52:55]
    v_mfma_f32_16x16x32_bf16 v[80:83], v[152:155], v[136:139], v[80:83]
    ds_read_b128 v[188:191], v10 offset:0
    v_mfma_f32_16x16x32_bf16 v[108:111], v[152:155], v[140:143], v[108:111]
    ds_read_b128 v[192:195], v10 offset:1024
    v_mfma_f32_16x16x32_bf16 v[28:31], v[156:159], v[128:131], v[28:31]
    v_mfma_f32_16x16x32_bf16 v[56:59], v[156:159], v[132:135], v[56:59]
    s_add_u32 m0, s14, s13
    s_nop 0
    global_load_lds_dwordx4 v6, s[46:47]
    v_mfma_f32_16x16x32_bf16 v[84:87], v[156:159], v[136:139], v[84:87]
    v_mfma_f32_16x16x32_bf16 v[112:115], v[156:159], v[140:143], v[112:115]
    ds_read_b128 v[196:199], v10 offset:2048
    v_mfma_f32_16x16x32_bf16 v[32:35], v[160:163], v[128:131], v[32:35]
    ds_read_b128 v[200:203], v10 offset:3072
    v_mfma_f32_16x16x32_bf16 v[60:63], v[160:163], v[132:135], v[60:63]
    v_mfma_f32_16x16x32_bf16 v[88:91], v[160:163], v[136:139], v[88:91]
    global_load_lds_dwordx4 v6, s[46:47] offset:1024
    s_add_u32 s44, s44, 131072
    s_addc_u32 s45, s45, 0
    s_add_u32 s46, s46, 458752
    s_addc_u32 s47, s47, 0
    s_add_u32 s14, s14, 30720
    s_cmp_eq_u32 s14, 153600
    s_cselect_b32 s14, 0, s14
    v_mfma_f32_16x16x32_bf16 v[116:119], v[160:163], v[140:143], v[116:119]
    v_mfma_f32_16x16x32_bf16 v[36:39], v[164:167], v[128:131], v[36:39]
    ds_read_b128 v[204:207], v10 offset:4096
    v_mfma_f32_16x16x32_bf16 v[64:67], v[164:167], v[132:135], v[64:67]
    ds_read_b128 v[208:211], v10 offset:5120
    v_mfma_f32_16x16x32_bf16 v[92:95], v[164:167], v[136:139], v[92:95]
    v_mfma_f32_16x16x32_bf16 v[120:123], v[164:167], v[140:143], v[120:123]
    ds_read_b128 v[212:215], v10 offset:6144
    v_mfma_f32_16x16x32_bf16 v[40:43], v[168:171], v[128:131], v[40:43]
    v_mfma_f32_16x16x32_bf16 v[68:71], v[168:171], v[132:135], v[68:71]
    v_mfma_f32_16x16x32_bf16 v[96:99], v[168:171], v[136:139], v[96:99]
    v_mfma_f32_16x16x32_bf16 v[124:127], v[168:171], v[140:143], v[124:127]
    v_add_u32 v9, s15, v7
    v_add_u32 v10, s15, v8
    s_add_u32 s15, s15, 30720
    s_cmp_eq_u32 s15, 153600
    s_cselect_b32 s15, 0, s15
    s_waitcnt vmcnt(12) lgkmcnt(0)
    s_barrier
    v_mfma_f32_16x16x32_bf16 v[16:19], v[188:191], v[172:175], v[16:19]
    ds_read_b128 v[128:131], v9 offset:0
    v_and_b32 v11, 1, v0
    v_lshlrev_b32 v11, 17, v11
    v_lshrrev_b32 v12, 1, v0
    v_mfma_f32_16x16x32_bf16 v[44:47], v[188:191], v[176:179], v[44:47]
    v_lshl_add_u32 v11, v12, 3, v11
    v_min_u32 v12, 447, v0
    v_lshlrev_b32 v12, 2, v12
    v_mfma_f32_16x16x32_bf16 v[72:75], v[188:191], v[180:183], v[72:75]
    ds_read_b128 v[132:135], v9 offset:1024
    s_lshl_b32 s8, s4, 11
    s_add_u32 s8, s8, 62914560
    v_mfma_f32_16x16x32_bf16 v[100:103], v[188:191], v[184:187], v[100:103]
    s_mul_i32 s9, s5, 1792
    s_add_u32 s9, s9, 196608
    v_mfma_f32_16x16x32_bf16 v[20:23], v[192:195], v[172:175], v[20:23]
    ds_read_b128 v[136:139], v9 offset:2048
    s_add_u32 s48, s42, s8
    s_addc_u32 s49, s43, 0
    v_mfma_f32_16x16x32_bf16 v[48:51], v[192:195], v[176:179], v[48:51]
    s_add_u32 s50, s42, s9
    s_addc_u32 s51, s43, 0
    v_mfma_f32_16x16x32_bf16 v[76:79], v[192:195], v[180:183], v[76:79]
    ds_read_b128 v[140:143], v9 offset:3072
    global_load_dwordx2 v[216:217], v11, s[48:49] sc1
    global_load_dword v232, v12, s[50:51]
    v_mfma_f32_16x16x32_bf16 v[104:107], v[192:195], v[184:187], v[104:107]
    s_add_u32 s48, s48, 16384
    s_addc_u32 s49, s49, 0
    v_mfma_f32_16x16x32_bf16 v[24:27], v[196:199], v[172:175], v[24:27]
    s_add_u32 s50, s50, 57344
    s_addc_u32 s51, s51, 0
    v_mfma_f32_16x16x32_bf16 v[52:55], v[196:199], v[176:179], v[52:55]
    ds_read_b128 v[144:147], v10 offset:0
    global_load_dwordx2 v[218:219], v11, s[48:49] sc1
    global_load_dword v233, v12, s[50:51]
    v_mfma_f32_16x16x32_bf16 v[80:83], v[196:199], v[180:183], v[80:83]
    s_add_u32 s48, s48, 16384
    s_addc_u32 s49, s49, 0
    v_mfma_f32_16x16x32_bf16 v[108:111], v[196:199], v[184:187], v[108:111]
    ds_read_b128 v[148:151], v10 offset:1024
    s_add_u32 s50, s50, 57344
    s_addc_u32 s51, s51, 0
    v_mfma_f32_16x16x32_bf16 v[28:31], v[200:203], v[172:175], v[28:31]
    global_load_dwordx2 v[220:221], v11, s[48:49] sc1
    global_load_dword v234, v12, s[50:51]
    v_mfma_f32_16x16x32_bf16 v[56:59], v[200:203], v[176:179], v[56:59]
    ds_read_b128 v[152:155], v10 offset:2048
    s_add_u32 s48, s48, 16384
    s_addc_u32 s49, s49, 0
    v_mfma_f32_16x16x32_bf16 v[84:87], v[200:203], v[180:183], v[84:87]
    s_add_u32 s50, s50, 57344
    s_addc_u32 s51, s51, 0
    v_mfma_f32_16x16x32_bf16 v[112:115], v[200:203], v[184:187], v[112:115]
    ds_read_b128 v[156:159], v10 offset:3072
    global_load_dwordx2 v[222:223], v11, s[48:49] sc1
    global_load_dword v235, v12, s[50:51]
    v_mfma_f32_16x16x32_bf16 v[32:35], v[204:207], v[172:175], v[32:35]
    s_add_u32 s48, s48, 16384
    s_addc_u32 s49, s49, 0
    v_mfma_f32_16x16x32_bf16 v[60:63], v[204:207], v[176:179], v[60:63]
    s_add_u32 s50, s50, 57344
    s_addc_u32 s51, s51, 0
    v_mfma_f32_16x16x32_bf16 v[88:91], v[204:207], v[180:183], v[88:91]
    ds_read_b128 v[160:163], v10 offset:4096
    global_load_dwordx2 v[224:225], v11, s[48:49] sc1
    global_load_dword v236, v12, s[50:51]
    v_mfma_f32_16x16x32_bf16 v[116:119], v[204:207], v[184:187], v[116:119]
    s_add_u32 s48, s48, 16384
    s_addc_u32 s49, s49, 0
    v_mfma_f32_16x16x32_bf16 v[36:39], v[208:211], v[172:175], v[36:39]
    ds_read_b128 v[164:167], v10 offset:5120
    s_add_u32 s50, s50, 57344
    s_addc_u32 s51, s51, 0
    v_mfma_f32_16x16x32_bf16 v[64:67], v[208:211], v[176:179], v[64:67]
    global_load_dwordx2 v[226:227], v11, s[48:49] sc1
    global_load_dword v237, v12, s[50:51]
    v_mfma_f32_16x16x32_bf16 v[92:95], v[208:211], v[180:183], v[92:95]
    ds_read_b128 v[168:171], v10 offset:6144
    s_add_u32 s48, s48, 16384
    s_addc_u32 s49, s49, 0
    v_mfma_f32_16x16x32_bf16 v[120:123], v[208:211], v[184:187], v[120:123]
    s_add_u32 s50, s50, 57344
    s_addc_u32 s51, s51, 0
    v_mfma_f32_16x16x32_bf16 v[40:43], v[212:215], v[172:175], v[40:43]
    global_load_dwordx2 v[228:229], v11, s[48:49] sc1
    global_load_dword v238, v12, s[50:51]
    v_mfma_f32_16x16x32_bf16 v[68:71], v[212:215], v[176:179], v[68:71]
    s_add_u32 s48, s48, 16384
    s_addc_u32 s49, s49, 0
    v_mfma_f32_16x16x32_bf16 v[96:99], v[212:215], v[180:183], v[96:99]
    s_add_u32 s50, s50, 57344
    s_addc_u32 s51, s51, 0
    v_mfma_f32_16x16x32_bf16 v[124:127], v[212:215], v[184:187], v[124:127]
    global_load_dwordx2 v[230:231], v11, s[48:49] sc1
    global_load_dword v239, v12, s[50:51]
    v_add_u32 v9, s15, v7
    v_add_u32 v10, s15, v8
    s_add_u32 s15, s15, 30720
    s_cmp_eq_u32 s15, 153600
    s_cselect_b32 s15, 0, s15
    s_waitcnt vmcnt(24) lgkmcnt(0)
    s_barrier
    v_mfma_f32_16x16x32_bf16 v[16:19], v[144:147], v[128:131], v[16:19]
    ds_read_b128 v[172:175], v9 offset:0
    v_mfma_f32_16x16x32_bf16 v[44:47], v[144:147], v[132:135], v[44:47]
    v_mfma_f32_16x16x32_bf16 v[72:75], v[144:147], v[136:139], v[72:75]
    ds_read_b128 v[176:179], v9 offset:1024
    v_mfma_f32_16x16x32_bf16 v[100:103], v[144:147], v[140:143], v[100:103]
    v_mfma_f32_16x16x32_bf16 v[20:23], v[148:151], v[128:131], v[20:23]
    ds_read_b128 v[180:183], v9 offset:2048
    v_mfma_f32_16x16x32_bf16 v[48:51], v[148:151], v[132:135], v[48:51]
    v_mfma_f32_16x16x32_bf16 v[76:79], v[148:151], v[136:139], v[76:79]
    ds_read_b128 v[184:187], v9 offset:3072
    v_mfma_f32_16x16x32_bf16 v[104:107], v[148:151], v[140:143], v[104:107]
    v_mfma_f32_16x16x32_bf16 v[24:27], v[152:155], v[128:131], v[24:27]
    v_mfma_f32_16x16x32_bf16 v[52:55], v[152:155], v[132:135], v[52:55]
    ds_read_b128 v[188:191], v10 offset:0
    v_mfma_f32_16x16x32_bf16 v[80:83], v[152:155], v[136:139], v[80:83]
    v_mfma_f32_16x16x32_bf16 v[108:111], v[152:155], v[140:143], v[108:111]
    ds_read_b128 v[192:195], v10 offset:1024
    v_mfma_f32_16x16x32_bf16 v[28:31], v[156:159], v[128:131], v[28:31]
    v_mfma_f32_16x16x32_bf16 v[56:59], v[156:159], v[132:135], v[56:59]
    ds_read_b128 v[196:199], v10 offset:2048
    v_mfma_f32_16x16x32_bf16 v[84:87], v[156:159], v[136:139], v[84:87]
    v_mfma_f32_16x16x32_bf16 v[112:115], v[156:159], v[140:143], v[112:115]
    ds_read_b128 v[200:203], v10 offset:3072
    v_mfma_f32_16x16x32_bf16 v[32:35], v[160:163], v[128:131], v[32:35]
    v_mfma_f32_16x16x32_bf16 v[60:63], v[160:163], v[132:135], v[60:63]
    v_mfma_f32_16x16x32_bf16 v[88:91], v[160:163], v[136:139], v[88:91]
    ds_read_b128 v[204:207], v10 offset:4096
    v_mfma_f32_16x16x32_bf16 v[116:119], v[160:163], v[140:143], v[116:119]
    v_mfma_f32_16x16x32_bf16 v[36:39], v[164:167], v[128:131], v[36:39]
    ds_read_b128 v[208:211], v10 offset:5120
    v_mfma_f32_16x16x32_bf16 v[64:67], v[164:167], v[132:135], v[64:67]
    v_mfma_f32_16x16x32_bf16 v[92:95], v[164:167], v[136:139], v[92:95]
    ds_read_b128 v[212:215], v10 offset:6144
    v_mfma_f32_16x16x32_bf16 v[120:123], v[164:167], v[140:143], v[120:123]
    v_mfma_f32_16x16x32_bf16 v[40:43], v[168:171], v[128:131], v[40:43]
    v_mfma_f32_16x16x32_bf16 v[68:71], v[168:171], v[132:135], v[68:71]
    v_mfma_f32_16x16x32_bf16 v[96:99], v[168:171], v[136:139], v[96:99]
    v_mfma_f32_16x16x32_bf16 v[124:127], v[168:171], v[140:143], v[124:127]
    v_add_u32 v9, s15, v7
    v_add_u32 v10, s15, v8
    s_add_u32 s15, s15, 30720
    s_cmp_eq_u32 s15, 153600
    s_cselect_b32 s15, 0, s15
    s_waitcnt vmcnt(20) lgkmcnt(0)
    s_barrier
    v_mfma_f32_16x16x32_bf16 v[16:19], v[188:191], v[172:175], v[16:19]
    ds_read_b128 v[128:131], v9 offset:0
    s_waitcnt vmcnt(0)
    v_pk_add_f32 v[240:241], v[216:217], v[218:219]
    v_add_f32 v232, v232, v233
    v_mfma_f32_16x16x32_bf16 v[44:47], v[188:191], v[176:179], v[44:47]
    v_pk_add_f32 v[240:241], v[240:241], v[220:221]
    v_add_f32 v232, v232, v234
    v_mfma_f32_16x16x32_bf16 v[72:75], v[188:191], v[180:183], v[72:75]
    ds_read_b128 v[132:135], v9 offset:1024
    v_pk_add_f32 v[240:241], v[240:241], v[222:223]
    v_add_f32 v232, v232, v235
    v_mfma_f32_16x16x32_bf16 v[100:103], v[188:191], v[184:187], v[100:103]
    v_pk_add_f32 v[240:241], v[240:241], v[224:225]
    v_add_f32 v232, v232, v236
    v_mfma_f32_16x16x32_bf16 v[20:23], v[192:195], v[172:175], v[20:23]
    ds_read_b128 v[136:139], v9 offset:2048
    v_pk_add_f32 v[240:241], v[240:241], v[226:227]
    v_add_f32 v232, v232, v237
    v_mfma_f32_16x16x32_bf16 v[48:51], v[192:195], v[176:179], v[48:51]
    v_pk_add_f32 v[240:241], v[240:241], v[228:229]
    v_add_f32 v232, v232, v238
    v_mfma_f32_16x16x32_bf16 v[76:79], v[192:195], v[180:183], v[76:79]
    ds_read_b128 v[140:143], v9 offset:3072
    v_pk_add_f32 v[240:241], v[240:241], v[230:231]
    v_add_f32 v232, v232, v239
    v_mfma_f32_16x16x32_bf16 v[104:107], v[192:195], v[184:187], v[104:107]
    v_add_u32 v12, 155648, v12
    ds_write_b32 v12, v232
    v_mfma_f32_16x16x32_bf16 v[24:27], v[196:199], v[172:175], v[24:27]
    v_add_f32 v240, v240, v240 quad_perm:[1,0,3,2] row_mask:0xf bank_mask:0xf
    v_mul_f32 v240, 0x3a800000, v240
    v_mfma_f32_16x16x32_bf16 v[52:55], v[196:199], v[176:179], v[52:55]
    ds_read_b128 v[144:147], v10 offset:0
    v_mul_f32 v242, 0xc2800000, v240
    v_mov_b32 v243, 0
    v_mfma_f32_16x16x32_bf16 v[80:83], v[196:199], v[180:183], v[80:83]
    v_add_f32 v216, v216, v242
    v_add_f32 v218, v218, v242
    v_mfma_f32_16x16x32_bf16 v[108:111], v[196:199], v[184:187], v[108:111]
    ds_read_b128 v[148:151], v10 offset:1024
    v_add_f32 v220, v220, v242
    v_add_f32 v222, v222, v242
    v_mfma_f32_16x16x32_bf16 v[28:31], v[200:203], v[172:175], v[28:31]
    v_add_f32 v224, v224, v242
    v_add_f32 v226, v226, v242
    v_mfma_f32_16x16x32_bf16 v[56:59], v[200:203], v[176:179], v[56:59]
    ds_read_b128 v[152:155], v10 offset:2048
    v_add_f32 v228, v228, v242
    v_add_f32 v230, v230, v242
    v_mfma_f32_16x16x32_bf16 v[84:87], v[200:203], v[180:183], v[84:87]
    v_fmac_f32 v243, v216, v216
    v_fmac_f32 v243, v218, v218
    v_mfma_f32_16x16x32_bf16 v[112:115], v[200:203], v[184:187], v[112:115]
    ds_read_b128 v[156:159], v10 offset:3072
    v_fmac_f32 v243, v220, v220
    v_fmac_f32 v243, v222, v222
    v_mfma_f32_16x16x32_bf16 v[32:35], v[204:207], v[172:175], v[32:35]
    v_fmac_f32 v243, v224, v224
    v_fmac_f32 v243, v226, v226
    v_mfma_f32_16x16x32_bf16 v[60:63], v[204:207], v[176:179], v[60:63]
    v_fmac_f32 v243, v228, v228
    v_fmac_f32 v243, v230, v230
    v_mfma_f32_16x16x32_bf16 v[88:91], v[204:207], v[180:183], v[88:91]
    ds_read_b128 v[160:163], v10 offset:4096
    v_fmac_f32 v241, 0x3c800000, v243
    v_lshrrev_b32 v11, 1, v0
    v_mfma_f32_16x16x32_bf16 v[116:119], v[204:207], v[184:187], v[116:119]
    v_lshlrev_b32 v11, 3, v11
    v_add_f32 v241, v241, v241 quad_perm:[1,0,3,2] row_mask:0xf bank_mask:0xf
    v_mfma_f32_16x16x32_bf16 v[36:39], v[208:211], v[172:175], v[36:39]
    ds_read_b128 v[164:167], v10 offset:5120
    v_mul_f32 v241, 0x3a800000, v241
    v_cvt_pk_bf16_f32 v241, v241, v241
    v_mfma_f32_16x16x32_bf16 v[64:67], v[208:211], v[176:179], v[64:67]
    v_lshlrev_b32 v241, 16, v241
    v_add_f32 v241, 0x3727c5ac, v241
    v_mfma_f32_16x16x32_bf16 v[92:95], v[208:211], v[180:183], v[92:95]
    ds_read_b128 v[168:171], v10 offset:6144
    v_cvt_pk_bf16_f32 v241, v241, v241
    v_lshlrev_b32 v241, 16, v241
    v_mfma_f32_16x16x32_bf16 v[120:123], v[208:211], v[184:187], v[120:123]
    v_sqrt_f32 v241, v241
    v_cvt_pk_bf16_f32 v240, v240, v240
    v_mfma_f32_16x16x32_bf16 v[40:43], v[212:215], v[172:175], v[40:43]
    v_lshlrev_b32 v240, 16, v240
    v_cvt_pk_bf16_f32 v241, v241, v241
    v_mfma_f32_16x16x32_bf16 v[68:71], v[212:215], v[176:179], v[68:71]
    v_lshlrev_b32 v241, 16, v241
    v_rcp_f32 v242, v241
    v_mfma_f32_16x16x32_bf16 v[96:99], v[212:215], v[180:183], v[96:99]
    v_add_u32 v11, 153600, v11
    v_mul_f32 v243, v242, v240
    v_mfma_f32_16x16x32_bf16 v[124:127], v[212:215], v[184:187], v[124:127]
    v_sub_f32 v243, 0, v243
    ds_write_b64 v11, v[242:243]
    v_add_u32 v9, s15, v7
    v_add_u32 v10, s15, v8
    s_add_u32 s15, s15, 30720
    s_cmp_eq_u32 s15, 153600
    s_cselect_b32 s15, 0, s15
    s_waitcnt vmcnt(16) lgkmcnt(0)
    s_barrier
    v_mfma_f32_16x16x32_bf16 v[16:19], v[144:147], v[128:131], v[16:19]
    ds_read_b128 v[172:175], v9 offset:0
    v_mfma_f32_16x16x32_bf16 v[44:47], v[144:147], v[132:135], v[44:47]
    v_mfma_f32_16x16x32_bf16 v[72:75], v[144:147], v[136:139], v[72:75]
    ds_read_b128 v[176:179], v9 offset:1024
    v_mfma_f32_16x16x32_bf16 v[100:103], v[144:147], v[140:143], v[100:103]
    v_mfma_f32_16x16x32_bf16 v[20:23], v[148:151], v[128:131], v[20:23]
    ds_read_b128 v[180:183], v9 offset:2048
    v_mfma_f32_16x16x32_bf16 v[48:51], v[148:151], v[132:135], v[48:51]
    v_mfma_f32_16x16x32_bf16 v[76:79], v[148:151], v[136:139], v[76:79]
    ds_read_b128 v[184:187], v9 offset:3072
    v_mfma_f32_16x16x32_bf16 v[104:107], v[148:151], v[140:143], v[104:107]
    v_mfma_f32_16x16x32_bf16 v[24:27], v[152:155], v[128:131], v[24:27]
    v_mfma_f32_16x16x32_bf16 v[52:55], v[152:155], v[132:135], v[52:55]
    ds_read_b128 v[188:191], v10 offset:0
    v_mfma_f32_16x16x32_bf16 v[80:83], v[152:155], v[136:139], v[80:83]
    v_mfma_f32_16x16x32_bf16 v[108:111], v[152:155], v[140:143], v[108:111]
    ds_read_b128 v[192:195], v10 offset:1024
    v_mfma_f32_16x16x32_bf16 v[28:31], v[156:159], v[128:131], v[28:31]
    v_mfma_f32_16x16x32_bf16 v[56:59], v[156:159], v[132:135], v[56:59]
    ds_read_b128 v[196:199], v10 offset:2048
    v_mfma_f32_16x16x32_bf16 v[84:87], v[156:159], v[136:139], v[84:87]
    v_mfma_f32_16x16x32_bf16 v[112:115], v[156:159], v[140:143], v[112:115]
    ds_read_b128 v[200:203], v10 offset:3072
    v_mfma_f32_16x16x32_bf16 v[32:35], v[160:163], v[128:131], v[32:35]
    v_mfma_f32_16x16x32_bf16 v[60:63], v[160:163], v[132:135], v[60:63]
    v_mfma_f32_16x16x32_bf16 v[88:91], v[160:163], v[136:139], v[88:91]
    ds_read_b128 v[204:207], v10 offset:4096
    v_mfma_f32_16x16x32_bf16 v[116:119], v[160:163], v[140:143], v[116:119]
    v_mfma_f32_16x16x32_bf16 v[36:39], v[164:167], v[128:131], v[36:39]
    ds_read_b128 v[208:211], v10 offset:5120
    v_mfma_f32_16x16x32_bf16 v[64:67], v[164:167], v[132:135], v[64:67]
    v_mfma_f32_16x16x32_bf16 v[92:95], v[164:167], v[136:139], v[92:95]
    ds_read_b128 v[212:215], v10 offset:6144
    v_mfma_f32_16x16x32_bf16 v[120:123], v[164:167], v[140:143], v[120:123]
    v_mfma_f32_16x16x32_bf16 v[40:43], v[168:171], v[128:131], v[40:43]
    v_mfma_f32_16x16x32_bf16 v[68:71], v[168:171], v[132:135], v[68:71]
    v_mfma_f32_16x16x32_bf16 v[96:99], v[168:171], v[136:139], v[96:99]
    v_mfma_f32_16x16x32_bf16 v[124:127], v[168:171], v[140:143], v[124:127]
    s_waitcnt lgkmcnt(0)
    v_mfma_f32_16x16x32_bf16 v[16:19], v[188:191], v[172:175], v[16:19]
    v_mfma_f32_16x16x32_bf16 v[44:47], v[188:191], v[176:179], v[44:47]
    v_mfma_f32_16x16x32_bf16 v[72:75], v[188:191], v[180:183], v[72:75]
    v_mfma_f32_16x16x32_bf16 v[100:103], v[188:191], v[184:187], v[100:103]
    v_mfma_f32_16x16x32_bf16 v[20:23], v[192:195], v[172:175], v[20:23]
    v_mfma_f32_16x16x32_bf16 v[48:51], v[192:195], v[176:179], v[48:51]
    v_mfma_f32_16x16x32_bf16 v[76:79], v[192:195], v[180:183], v[76:79]
    v_mfma_f32_16x16x32_bf16 v[104:107], v[192:195], v[184:187], v[104:107]
    v_mfma_f32_16x16x32_bf16 v[24:27], v[196:199], v[172:175], v[24:27]
    v_mfma_f32_16x16x32_bf16 v[52:55], v[196:199], v[176:179], v[52:55]
    v_mfma_f32_16x16x32_bf16 v[80:83], v[196:199], v[180:183], v[80:83]
    v_mfma_f32_16x16x32_bf16 v[108:111], v[196:199], v[184:187], v[108:111]
    v_mfma_f32_16x16x32_bf16 v[28:31], v[200:203], v[172:175], v[28:31]
    v_mfma_f32_16x16x32_bf16 v[56:59], v[200:203], v[176:179], v[56:59]
    v_mfma_f32_16x16x32_bf16 v[84:87], v[200:203], v[180:183], v[84:87]
    v_mfma_f32_16x16x32_bf16 v[112:115], v[200:203], v[184:187], v[112:115]
    v_mfma_f32_16x16x32_bf16 v[32:35], v[204:207], v[172:175], v[32:35]
    v_mfma_f32_16x16x32_bf16 v[60:63], v[204:207], v[176:179], v[60:63]
    v_mfma_f32_16x16x32_bf16 v[88:91], v[204:207], v[180:183], v[88:91]
    v_mfma_f32_16x16x32_bf16 v[116:119], v[204:207], v[184:187], v[116:119]
    v_mfma_f32_16x16x32_bf16 v[36:39], v[208:211], v[172:175], v[36:39]
    v_mfma_f32_16x16x32_bf16 v[64:67], v[208:211], v[176:179], v[64:67]
    v_mfma_f32_16x16x32_bf16 v[92:95], v[208:211], v[180:183], v[92:95]
    v_mfma_f32_16x16x32_bf16 v[120:123], v[208:211], v[184:187], v[120:123]
    v_mfma_f32_16x16x32_bf16 v[40:43], v[212:215], v[172:175], v[40:43]
    v_mfma_f32_16x16x32_bf16 v[68:71], v[212:215], v[176:179], v[68:71]
    v_mfma_f32_16x16x32_bf16 v[96:99], v[212:215], v[180:183], v[96:99]
    v_mfma_f32_16x16x32_bf16 v[124:127], v[212:215], v[184:187], v[124:127]
    s_lshl_b32 s8, s6, 9
    s_add_u32 s8, s8, 153600
    v_lshlrev_b32 v11, 3, v3
    v_add_u32 v11, s8, v11
    ds_read_b64 v[128:129], v11 offset:0
    ds_read_b64 v[130:131], v11 offset:128
    ds_read_b64 v[132:133], v11 offset:256
    ds_read_b64 v[134:135], v11 offset:384
    s_mul_i32 s8, s7, 896
    s_add_u32 s8, s8, 155648
    v_lshlrev_b32 v12, 4, v4
    v_add_u32 v12, s8, v12
    ds_read_b128 v[136:139], v12 offset:0
    ds_read_b128 v[140:143], v12 offset:64
    v_lshrrev_b32 v13, 1, v4
    v_lshlrev_b32 v13, 10, v13
    v_lshl_add_u32 v13, v3, 4, v13
    v_and_b32 v14, 1, v4
    v_lshl_add_u32 v13, v14, 11, v13
    s_mul_i32 s8, s5, 14
    s_mul_i32 s9, s7, 7
    s_add_u32 s8, s8, s9
    s_lshl_b32 s9, s4, 14
    s_lshl_b32 s10, s6, 12
    s_add_u32 s9, s9, s10
    s_add_u32 s9, s9, 47185920
    v_mov_b32 v168, 0xc0135761
    v_mov_b32 v169, 0xbdd2d3e8
    ds_read_b128 v[144:147], v12 offset:128
    ds_read_b128 v[148:151], v12 offset:192
    s_waitcnt lgkmcnt(2)
    s_add_u32 s10, s8, 0
    s_lshr_b32 s11, s10, 2
    s_lshl_b32 s11, s11, 17
    s_and_b32 s10, s10, 3
    s_lshl_b32 s10, s10, 8
    s_add_u32 s10, s10, s11
    s_add_u32 s10, s10, s9
    s_add_u32 s48, s42, s10
    s_addc_u32 s49, s43, 0
    v_pk_fma_f32 v[152:153], v[136:137], v[128:129], v[140:141] op_sel:[0,1,0] op_sel_hi:[1,1,1]
    v_pk_fma_f32 v[154:155], v[138:139], v[128:129], v[142:143] op_sel:[0,1,0] op_sel_hi:[1,1,1]
    v_pk_fma_f32 v[156:157], v[136:137], v[130:131], v[140:141] op_sel:[0,1,0] op_sel_hi:[1,1,1]
    v_pk_fma_f32 v[158:159], v[138:139], v[130:131], v[142:143] op_sel:[0,1,0] op_sel_hi:[1,1,1]
    v_pk_fma_f32 v[160:161], v[136:137], v[132:133], v[140:141] op_sel:[0,1,0] op_sel_hi:[1,1,1]
    v_pk_fma_f32 v[162:163], v[138:139], v[132:133], v[142:143] op_sel:[0,1,0] op_sel_hi:[1,1,1]
    v_pk_fma_f32 v[164:165], v[136:137], v[134:135], v[140:141] op_sel:[0,1,0] op_sel_hi:[1,1,1]
    v_pk_fma_f32 v[166:167], v[138:139], v[134:135], v[142:143] op_sel:[0,1,0] op_sel_hi:[1,1,1]
    v_pk_fma_f32 v[16:17], v[16:17], v[128:129], v[152:153] op_sel_hi:[1,0,1]
    v_pk_fma_f32 v[18:19], v[18:19], v[128:129], v[154:155] op_sel_hi:[1,0,1]
    v_pk_fma_f32 v[44:45], v[44:45], v[130:131], v[156:157] op_sel_hi:[1,0,1]
    v_pk_fma_f32 v[46:47], v[46:47], v[130:131], v[158:159] op_sel_hi:[1,0,1]
    v_pk_fma_f32 v[72:73], v[72:73], v[132:133], v[160:161] op_sel_hi:[1,0,1]
    v_pk_fma_f32 v[74:75], v[74:75], v[132:133], v[162:163] op_sel_hi:[1,0,1]
    v_pk_fma_f32 v[100:101], v[100:101], v[134:135], v[164:165] op_sel_hi:[1,0,1]
    v_pk_fma_f32 v[102:103], v[102:103], v[134:135], v[166:167] op_sel_hi:[1,0,1]
    v_permlane32_swap_b32 v16, v44
    v_permlane32_swap_b32 v17, v45
    v_permlane32_swap_b32 v18, v46
    v_permlane32_swap_b32 v19, v47
    v_permlane32_swap_b32 v72, v100
    v_permlane32_swap_b32 v73, v101
    v_permlane32_swap_b32 v74, v102
    v_permlane32_swap_b32 v75, v103
    v_pk_mul_f32 v[152:153], v[16:17], v[16:17]
    v_pk_mul_f32 v[154:155], v[18:19], v[18:19]
    v_pk_mul_f32 v[156:157], v[72:73], v[72:73]
    v_pk_mul_f32 v[158:159], v[74:75], v[74:75]
    v_pk_fma_f32 v[152:153], v[152:153], v[168:169], v[168:169] op_sel:[0,1,0] op_sel_hi:[1,1,0]
    v_pk_fma_f32 v[154:155], v[154:155], v[168:169], v[168:169] op_sel:[0,1,0] op_sel_hi:[1,1,0]
    v_pk_fma_f32 v[156:157], v[156:157], v[168:169], v[168:169] op_sel:[0,1,0] op_sel_hi:[1,1,0]
    v_pk_fma_f32 v[158:159], v[158:159], v[168:169], v[168:169] op_sel:[0,1,0] op_sel_hi:[1,1,0]
    v_pk_mul_f32 v[152:153], v[152:153], v[16:17]
    v_pk_mul_f32 v[154:155], v[154:155], v[18:19]
    v_pk_mul_f32 v[156:157], v[156:157], v[72:73]
    v_pk_mul_f32 v[158:159], v[158:159], v[74:75]
    v_exp_f32 v152, v152
    v_exp_f32 v153, v153
    v_exp_f32 v154, v154
    v_exp_f32 v155, v155
    v_exp_f32 v156, v156
    v_exp_f32 v157, v157
    v_exp_f32 v158, v158
    v_exp_f32 v159, v159
    v_pk_mul_f32 v[16:17], v[16:17], v[44:45]
    v_pk_mul_f32 v[18:19], v[18:19], v[46:47]
    v_pk_mul_f32 v[72:73], v[72:73], v[100:101]
    v_pk_mul_f32 v[74:75], v[74:75], v[102:103]
    v_pk_add_f32 v[152:153], v[152:153], 1.0 op_sel_hi:[1,0]
    v_pk_add_f32 v[154:155], v[154:155], 1.0 op_sel_hi:[1,0]
    v_pk_add_f32 v[156:157], v[156:157], 1.0 op_sel_hi:[1,0]
    v_pk_add_f32 v[158:159], v[158:159], 1.0 op_sel_hi:[1,0]
    v_rcp_f32 v152, v152
    v_rcp_f32 v153, v153
    v_rcp_f32 v154, v154
    v_rcp_f32 v155, v155
    v_rcp_f32 v156, v156
    v_rcp_f32 v157, v157
    v_rcp_f32 v158, v158
    v_rcp_f32 v159, v159
    v_pk_mul_f32 v[16:17], v[16:17], v[152:153]
    v_pk_mul_f32 v[18:19], v[18:19], v[154:155]
    v_pk_mul_f32 v[72:73], v[72:73], v[156:157]
    v_pk_mul_f32 v[74:75], v[74:75], v[158:159]
    v_cvt_pk_bf16_f32 v44, v16, v17
    v_cvt_pk_bf16_f32 v45, v18, v19
    v_cvt_pk_bf16_f32 v46, v72, v73
    v_cvt_pk_bf16_f32 v47, v74, v75
    s_nop 0
    v_permlane16_swap_b32 v44, v46
    v_permlane16_swap_b32 v45, v47
    global_store_dwordx4 v13, v[44:47], s[48:49] sc1
    ds_read_b128 v[136:139], v12 offset:256
    ds_read_b128 v[140:143], v12 offset:320
    s_waitcnt lgkmcnt(2)
    s_add_u32 s10, s8, 1
    s_lshr_b32 s11, s10, 2
    s_lshl_b32 s11, s11, 17
    s_and_b32 s10, s10, 3
    s_lshl_b32 s10, s10, 8
    s_add_u32 s10, s10, s11
    s_add_u32 s10, s10, s9
    s_add_u32 s50, s42, s10
    s_addc_u32 s51, s43, 0
    v_pk_fma_f32 v[152:153], v[144:145], v[128:129], v[148:149] op_sel:[0,1,0] op_sel_hi:[1,1,1]
    v_pk_fma_f32 v[154:155], v[146:147], v[128:129], v[150:151] op_sel:[0,1,0] op_sel_hi:[1,1,1]
    v_pk_fma_f32 v[156:157], v[144:145], v[130:131], v[148:149] op_sel:[0,1,0] op_sel_hi:[1,1,1]
    v_pk_fma_f32 v[158:159], v[146:147], v[130:131], v[150:151] op_sel:[0,1,0] op_sel_hi:[1,1,1]
    v_pk_fma_f32 v[160:161], v[144:145], v[132:133], v[148:149] op_sel:[0,1,0] op_sel_hi:[1,1,1]
    v_pk_fma_f32 v[162:163], v[146:147], v[132:133], v[150:151] op_sel:[0,1,0] op_sel_hi:[1,1,1]
    v_pk_fma_f32 v[164:165], v[144:145], v[134:135], v[148:149] op_sel:[0,1,0] op_sel_hi:[1,1,1]
    v_pk_fma_f32 v[166:167], v[146:147], v[134:135], v[150:151] op_sel:[0,1,0] op_sel_hi:[1,1,1]
    v_pk_fma_f32 v[20:21], v[20:21], v[128:129], v[152:153] op_sel_hi:[1,0,1]
    v_pk_fma_f32 v[22:23], v[22:23], v[128:129], v[154:155] op_sel_hi:[1,0,1]
    v_pk_fma_f32 v[48:49], v[48:49], v[130:131], v[156:157] op_sel_hi:[1,0,1]
    v_pk_fma_f32 v[50:51], v[50:51], v[130:131], v[158:159] op_sel_hi:[1,0,1]
    v_pk_fma_f32 v[76:77], v[76:77], v[132:133], v[160:161] op_sel_hi:[1,0,1]
    v_pk_fma_f32 v[78:79], v[78:79], v[132:133], v[162:163] op_sel_hi:[1,0,1]
    v_pk_fma_f32 v[104:105], v[104:105], v[134:135], v[164:165] op_sel_hi:[1,0,1]
    v_pk_fma_f32 v[106:107], v[106:107], v[134:135], v[166:167] op_sel_hi:[1,0,1]
    v_permlane32_swap_b32 v20, v48
    v_permlane32_swap_b32 v21, v49
    v_permlane32_swap_b32 v22, v50
    v_permlane32_swap_b32 v23, v51
    v_permlane32_swap_b32 v76, v104
    v_permlane32_swap_b32 v77, v105
    v_permlane32_swap_b32 v78, v106
    v_permlane32_swap_b32 v79, v107
    v_pk_mul_f32 v[152:153], v[20:21], v[20:21]
    v_pk_mul_f32 v[154:155], v[22:23], v[22:23]
    v_pk_mul_f32 v[156:157], v[76:77], v[76:77]
    v_pk_mul_f32 v[158:159], v[78:79], v[78:79]
    v_pk_fma_f32 v[152:153], v[152:153], v[168:169], v[168:169] op_sel:[0,1,0] op_sel_hi:[1,1,0]
    v_pk_fma_f32 v[154:155], v[154:155], v[168:169], v[168:169] op_sel:[0,1,0] op_sel_hi:[1,1,0]
    v_pk_fma_f32 v[156:157], v[156:157], v[168:169], v[168:169] op_sel:[0,1,0] op_sel_hi:[1,1,0]
    v_pk_fma_f32 v[158:159], v[158:159], v[168:169], v[168:169] op_sel:[0,1,0] op_sel_hi:[1,1,0]
    v_pk_mul_f32 v[152:153], v[152:153], v[20:21]
    v_pk_mul_f32 v[154:155], v[154:155], v[22:23]
    v_pk_mul_f32 v[156:157], v[156:157], v[76:77]
    v_pk_mul_f32 v[158:159], v[158:159], v[78:79]
    v_exp_f32 v152, v152
    v_exp_f32 v153, v153
    v_exp_f32 v154, v154
    v_exp_f32 v155, v155
    v_exp_f32 v156, v156
    v_exp_f32 v157, v157
    v_exp_f32 v158, v158
    v_exp_f32 v159, v159
    v_pk_mul_f32 v[20:21], v[20:21], v[48:49]
    v_pk_mul_f32 v[22:23], v[22:23], v[50:51]
    v_pk_mul_f32 v[76:77], v[76:77], v[104:105]
    v_pk_mul_f32 v[78:79], v[78:79], v[106:107]
    v_pk_add_f32 v[152:153], v[152:153], 1.0 op_sel_hi:[1,0]
    v_pk_add_f32 v[154:155], v[154:155], 1.0 op_sel_hi:[1,0]
    v_pk_add_f32 v[156:157], v[156:157], 1.0 op_sel_hi:[1,0]
    v_pk_add_f32 v[158:159], v[158:159], 1.0 op_sel_hi:[1,0]
    v_rcp_f32 v152, v152
    v_rcp_f32 v153, v153
    v_rcp_f32 v154, v154
    v_rcp_f32 v155, v155
    v_rcp_f32 v156, v156
    v_rcp_f32 v157, v157
    v_rcp_f32 v158, v158
    v_rcp_f32 v159, v159
    v_pk_mul_f32 v[20:21], v[20:21], v[152:153]
    v_pk_mul_f32 v[22:23], v[22:23], v[154:155]
    v_pk_mul_f32 v[76:77], v[76:77], v[156:157]
    v_pk_mul_f32 v[78:79], v[78:79], v[158:159]
    v_cvt_pk_bf16_f32 v48, v20, v21
    v_cvt_pk_bf16_f32 v49, v22, v23
    v_cvt_pk_bf16_f32 v50, v76, v77
    v_cvt_pk_bf16_f32 v51, v78, v79
    s_nop 0
    v_permlane16_swap_b32 v48, v50
    v_permlane16_swap_b32 v49, v51
    global_store_dwordx4 v13, v[48:51], s[50:51] sc1
    ds_read_b128 v[144:147], v12 offset:384
    ds_read_b128 v[148:151], v12 offset:448
    s_waitcnt lgkmcnt(2)
    s_add_u32 s10, s8, 2
    s_lshr_b32 s11, s10, 2
    s_lshl_b32 s11, s11, 17
    s_and_b32 s10, s10, 3
    s_lshl_b32 s10, s10, 8
    s_add_u32 s10, s10, s11
    s_add_u32 s10, s10, s9
    s_add_u32 s48, s42, s10
    s_addc_u32 s49, s43, 0
    v_pk_fma_f32 v[152:153], v[136:137], v[128:129], v[140:141] op_sel:[0,1,0] op_sel_hi:[1,1,1]
    v_pk_fma_f32 v[154:155], v[138:139], v[128:129], v[142:143] op_sel:[0,1,0] op_sel_hi:[1,1,1]
    v_pk_fma_f32 v[156:157], v[136:137], v[130:131], v[140:141] op_sel:[0,1,0] op_sel_hi:[1,1,1]
    v_pk_fma_f32 v[158:159], v[138:139], v[130:131], v[142:143] op_sel:[0,1,0] op_sel_hi:[1,1,1]
    v_pk_fma_f32 v[160:161], v[136:137], v[132:133], v[140:141] op_sel:[0,1,0] op_sel_hi:[1,1,1]
    v_pk_fma_f32 v[162:163], v[138:139], v[132:133], v[142:143] op_sel:[0,1,0] op_sel_hi:[1,1,1]
    v_pk_fma_f32 v[164:165], v[136:137], v[134:135], v[140:141] op_sel:[0,1,0] op_sel_hi:[1,1,1]
    v_pk_fma_f32 v[166:167], v[138:139], v[134:135], v[142:143] op_sel:[0,1,0] op_sel_hi:[1,1,1]
    v_pk_fma_f32 v[24:25], v[24:25], v[128:129], v[152:153] op_sel_hi:[1,0,1]
    v_pk_fma_f32 v[26:27], v[26:27], v[128:129], v[154:155] op_sel_hi:[1,0,1]
    v_pk_fma_f32 v[52:53], v[52:53], v[130:131], v[156:157] op_sel_hi:[1,0,1]
    v_pk_fma_f32 v[54:55], v[54:55], v[130:131], v[158:159] op_sel_hi:[1,0,1]
    v_pk_fma_f32 v[80:81], v[80:81], v[132:133], v[160:161] op_sel_hi:[1,0,1]
    v_pk_fma_f32 v[82:83], v[82:83], v[132:133], v[162:163] op_sel_hi:[1,0,1]
    v_pk_fma_f32 v[108:109], v[108:109], v[134:135], v[164:165] op_sel_hi:[1,0,1]
    v_pk_fma_f32 v[110:111], v[110:111], v[134:135], v[166:167] op_sel_hi:[1,0,1]
    v_permlane32_swap_b32 v24, v52
    v_permlane32_swap_b32 v25, v53
    v_permlane32_swap_b32 v26, v54
    v_permlane32_swap_b32 v27, v55
    v_permlane32_swap_b32 v80, v108
    v_permlane32_swap_b32 v81, v109
    v_permlane32_swap_b32 v82, v110
    v_permlane32_swap_b32 v83, v111
    v_pk_mul_f32 v[152:153], v[24:25], v[24:25]
    v_pk_mul_f32 v[154:155], v[26:27], v[26:27]
    v_pk_mul_f32 v[156:157], v[80:81], v[80:81]
    v_pk_mul_f32 v[158:159], v[82:83], v[82:83]
    v_pk_fma_f32 v[152:153], v[152:153], v[168:169], v[168:169] op_sel:[0,1,0] op_sel_hi:[1,1,0]
    v_pk_fma_f32 v[154:155], v[154:155], v[168:169], v[168:169] op_sel:[0,1,0] op_sel_hi:[1,1,0]
    v_pk_fma_f32 v[156:157], v[156:157], v[168:169], v[168:169] op_sel:[0,1,0] op_sel_hi:[1,1,0]
    v_pk_fma_f32 v[158:159], v[158:159], v[168:169], v[168:169] op_sel:[0,1,0] op_sel_hi:[1,1,0]
    v_pk_mul_f32 v[152:153], v[152:153], v[24:25]
    v_pk_mul_f32 v[154:155], v[154:155], v[26:27]
    v_pk_mul_f32 v[156:157], v[156:157], v[80:81]
    v_pk_mul_f32 v[158:159], v[158:159], v[82:83]
    v_exp_f32 v152, v152
    v_exp_f32 v153, v153
    v_exp_f32 v154, v154
    v_exp_f32 v155, v155
    v_exp_f32 v156, v156
    v_exp_f32 v157, v157
    v_exp_f32 v158, v158
    v_exp_f32 v159, v159
    v_pk_mul_f32 v[24:25], v[24:25], v[52:53]
    v_pk_mul_f32 v[26:27], v[26:27], v[54:55]
    v_pk_mul_f32 v[80:81], v[80:81], v[108:109]
    v_pk_mul_f32 v[82:83], v[82:83], v[110:111]
    v_pk_add_f32 v[152:153], v[152:153], 1.0 op_sel_hi:[1,0]
    v_pk_add_f32 v[154:155], v[154:155], 1.0 op_sel_hi:[1,0]
    v_pk_add_f32 v[156:157], v[156:157], 1.0 op_sel_hi:[1,0]
    v_pk_add_f32 v[158:159], v[158:159], 1.0 op_sel_hi:[1,0]
    v_rcp_f32 v152, v152
    v_rcp_f32 v153, v153
    v_rcp_f32 v154, v154
    v_rcp_f32 v155, v155
    v_rcp_f32 v156, v156
    v_rcp_f32 v157, v157
    v_rcp_f32 v158, v158
    v_rcp_f32 v159, v159
    v_pk_mul_f32 v[24:25], v[24:25], v[152:153]
    v_pk_mul_f32 v[26:27], v[26:27], v[154:155]
    v_pk_mul_f32 v[80:81], v[80:81], v[156:157]
    v_pk_mul_f32 v[82:83], v[82:83], v[158:159]
    v_cvt_pk_bf16_f32 v52, v24, v25
    v_cvt_pk_bf16_f32 v53, v26, v27
    v_cvt_pk_bf16_f32 v54, v80, v81
    v_cvt_pk_bf16_f32 v55, v82, v83
    s_nop 0
    v_permlane16_swap_b32 v52, v54
    v_permlane16_swap_b32 v53, v55
    global_store_dwordx4 v13, v[52:55], s[48:49] sc1
    ds_read_b128 v[136:139], v12 offset:512
    ds_read_b128 v[140:143], v12 offset:576
    s_waitcnt lgkmcnt(2)
    s_add_u32 s10, s8, 3
    s_lshr_b32 s11, s10, 2
    s_lshl_b32 s11, s11, 17
    s_and_b32 s10, s10, 3
    s_lshl_b32 s10, s10, 8
    s_add_u32 s10, s10, s11
    s_add_u32 s10, s10, s9
    s_add_u32 s50, s42, s10
    s_addc_u32 s51, s43, 0
    v_pk_fma_f32 v[152:153], v[144:145], v[128:129], v[148:149] op_sel:[0,1,0] op_sel_hi:[1,1,1]
    v_pk_fma_f32 v[154:155], v[146:147], v[128:129], v[150:151] op_sel:[0,1,0] op_sel_hi:[1,1,1]
    v_pk_fma_f32 v[156:157], v[144:145], v[130:131], v[148:149] op_sel:[0,1,0] op_sel_hi:[1,1,1]
    v_pk_fma_f32 v[158:159], v[146:147], v[130:131], v[150:151] op_sel:[0,1,0] op_sel_hi:[1,1,1]
    v_pk_fma_f32 v[160:161], v[144:145], v[132:133], v[148:149] op_sel:[0,1,0] op_sel_hi:[1,1,1]
    v_pk_fma_f32 v[162:163], v[146:147], v[132:133], v[150:151] op_sel:[0,1,0] op_sel_hi:[1,1,1]
    v_pk_fma_f32 v[164:165], v[144:145], v[134:135], v[148:149] op_sel:[0,1,0] op_sel_hi:[1,1,1]
    v_pk_fma_f32 v[166:167], v[146:147], v[134:135], v[150:151] op_sel:[0,1,0] op_sel_hi:[1,1,1]
    v_pk_fma_f32 v[28:29], v[28:29], v[128:129], v[152:153] op_sel_hi:[1,0,1]
    v_pk_fma_f32 v[30:31], v[30:31], v[128:129], v[154:155] op_sel_hi:[1,0,1]
    v_pk_fma_f32 v[56:57], v[56:57], v[130:131], v[156:157] op_sel_hi:[1,0,1]
    v_pk_fma_f32 v[58:59], v[58:59], v[130:131], v[158:159] op_sel_hi:[1,0,1]
    v_pk_fma_f32 v[84:85], v[84:85], v[132:133], v[160:161] op_sel_hi:[1,0,1]
    v_pk_fma_f32 v[86:87], v[86:87], v[132:133], v[162:163] op_sel_hi:[1,0,1]
    v_pk_fma_f32 v[112:113], v[112:113], v[134:135], v[164:165] op_sel_hi:[1,0,1]
    v_pk_fma_f32 v[114:115], v[114:115], v[134:135], v[166:167] op_sel_hi:[1,0,1]
    v_permlane32_swap_b32 v28, v56
    v_permlane32_swap_b32 v29, v57
    v_permlane32_swap_b32 v30, v58
    v_permlane32_swap_b32 v31, v59
    v_permlane32_swap_b32 v84, v112
    v_permlane32_swap_b32 v85, v113
    v_permlane32_swap_b32 v86, v114
    v_permlane32_swap_b32 v87, v115
    v_pk_mul_f32 v[152:153], v[28:29], v[28:29]
    v_pk_mul_f32 v[154:155], v[30:31], v[30:31]
    v_pk_mul_f32 v[156:157], v[84:85], v[84:85]
    v_pk_mul_f32 v[158:159], v[86:87], v[86:87]
    v_pk_fma_f32 v[152:153], v[152:153], v[168:169], v[168:169] op_sel:[0,1,0] op_sel_hi:[1,1,0]
    v_pk_fma_f32 v[154:155], v[154:155], v[168:169], v[168:169] op_sel:[0,1,0] op_sel_hi:[1,1,0]
    v_pk_fma_f32 v[156:157], v[156:157], v[168:169], v[168:169] op_sel:[0,1,0] op_sel_hi:[1,1,0]
    v_pk_fma_f32 v[158:159], v[158:159], v[168:169], v[168:169] op_sel:[0,1,0] op_sel_hi:[1,1,0]
    v_pk_mul_f32 v[152:153], v[152:153], v[28:29]
    v_pk_mul_f32 v[154:155], v[154:155], v[30:31]
    v_pk_mul_f32 v[156:157], v[156:157], v[84:85]
    v_pk_mul_f32 v[158:159], v[158:159], v[86:87]
    v_exp_f32 v152, v152
    v_exp_f32 v153, v153
    v_exp_f32 v154, v154
    v_exp_f32 v155, v155
    v_exp_f32 v156, v156
    v_exp_f32 v157, v157
    v_exp_f32 v158, v158
    v_exp_f32 v159, v159
    v_pk_mul_f32 v[28:29], v[28:29], v[56:57]
    v_pk_mul_f32 v[30:31], v[30:31], v[58:59]
    v_pk_mul_f32 v[84:85], v[84:85], v[112:113]
    v_pk_mul_f32 v[86:87], v[86:87], v[114:115]
    v_pk_add_f32 v[152:153], v[152:153], 1.0 op_sel_hi:[1,0]
    v_pk_add_f32 v[154:155], v[154:155], 1.0 op_sel_hi:[1,0]
    v_pk_add_f32 v[156:157], v[156:157], 1.0 op_sel_hi:[1,0]
    v_pk_add_f32 v[158:159], v[158:159], 1.0 op_sel_hi:[1,0]
    v_rcp_f32 v152, v152
    v_rcp_f32 v153, v153
    v_rcp_f32 v154, v154
    v_rcp_f32 v155, v155
    v_rcp_f32 v156, v156
    v_rcp_f32 v157, v157
    v_rcp_f32 v158, v158
    v_rcp_f32 v159, v159
    v_pk_mul_f32 v[28:29], v[28:29], v[152:153]
    v_pk_mul_f32 v[30:31], v[30:31], v[154:155]
    v_pk_mul_f32 v[84:85], v[84:85], v[156:157]
    v_pk_mul_f32 v[86:87], v[86:87], v[158:159]
    v_cvt_pk_bf16_f32 v56, v28, v29
    v_cvt_pk_bf16_f32 v57, v30, v31
    v_cvt_pk_bf16_f32 v58, v84, v85
    v_cvt_pk_bf16_f32 v59, v86, v87
    s_nop 0
    v_permlane16_swap_b32 v56, v58
    v_permlane16_swap_b32 v57, v59
    global_store_dwordx4 v13, v[56:59], s[50:51] sc1
    ds_read_b128 v[144:147], v12 offset:640
    ds_read_b128 v[148:151], v12 offset:704
    s_waitcnt lgkmcnt(2)
    s_add_u32 s10, s8, 4
    s_lshr_b32 s11, s10, 2
    s_lshl_b32 s11, s11, 17
    s_and_b32 s10, s10, 3
    s_lshl_b32 s10, s10, 8
    s_add_u32 s10, s10, s11
    s_add_u32 s10, s10, s9
    s_add_u32 s48, s42, s10
    s_addc_u32 s49, s43, 0
    v_pk_fma_f32 v[152:153], v[136:137], v[128:129], v[140:141] op_sel:[0,1,0] op_sel_hi:[1,1,1]
    v_pk_fma_f32 v[154:155], v[138:139], v[128:129], v[142:143] op_sel:[0,1,0] op_sel_hi:[1,1,1]
    v_pk_fma_f32 v[156:157], v[136:137], v[130:131], v[140:141] op_sel:[0,1,0] op_sel_hi:[1,1,1]
    v_pk_fma_f32 v[158:159], v[138:139], v[130:131], v[142:143] op_sel:[0,1,0] op_sel_hi:[1,1,1]
    v_pk_fma_f32 v[160:161], v[136:137], v[132:133], v[140:141] op_sel:[0,1,0] op_sel_hi:[1,1,1]
    v_pk_fma_f32 v[162:163], v[138:139], v[132:133], v[142:143] op_sel:[0,1,0] op_sel_hi:[1,1,1]
    v_pk_fma_f32 v[164:165], v[136:137], v[134:135], v[140:141] op_sel:[0,1,0] op_sel_hi:[1,1,1]
    v_pk_fma_f32 v[166:167], v[138:139], v[134:135], v[142:143] op_sel:[0,1,0] op_sel_hi:[1,1,1]
    v_pk_fma_f32 v[32:33], v[32:33], v[128:129], v[152:153] op_sel_hi:[1,0,1]
    v_pk_fma_f32 v[34:35], v[34:35], v[128:129], v[154:155] op_sel_hi:[1,0,1]
    v_pk_fma_f32 v[60:61], v[60:61], v[130:131], v[156:157] op_sel_hi:[1,0,1]
    v_pk_fma_f32 v[62:63], v[62:63], v[130:131], v[158:159] op_sel_hi:[1,0,1]
    v_pk_fma_f32 v[88:89], v[88:89], v[132:133], v[160:161] op_sel_hi:[1,0,1]
    v_pk_fma_f32 v[90:91], v[90:91], v[132:133], v[162:163] op_sel_hi:[1,0,1]
    v_pk_fma_f32 v[116:117], v[116:117], v[134:135], v[164:165] op_sel_hi:[1,0,1]
    v_pk_fma_f32 v[118:119], v[118:119], v[134:135], v[166:167] op_sel_hi:[1,0,1]
    v_permlane32_swap_b32 v32, v60
    v_permlane32_swap_b32 v33, v61
    v_permlane32_swap_b32 v34, v62
    v_permlane32_swap_b32 v35, v63
    v_permlane32_swap_b32 v88, v116
    v_permlane32_swap_b32 v89, v117
    v_permlane32_swap_b32 v90, v118
    v_permlane32_swap_b32 v91, v119
    v_pk_mul_f32 v[152:153], v[32:33], v[32:33]
    v_pk_mul_f32 v[154:155], v[34:35], v[34:35]
    v_pk_mul_f32 v[156:157], v[88:89], v[88:89]
    v_pk_mul_f32 v[158:159], v[90:91], v[90:91]
    v_pk_fma_f32 v[152:153], v[152:153], v[168:169], v[168:169] op_sel:[0,1,0] op_sel_hi:[1,1,0]
    v_pk_fma_f32 v[154:155], v[154:155], v[168:169], v[168:169] op_sel:[0,1,0] op_sel_hi:[1,1,0]
    v_pk_fma_f32 v[156:157], v[156:157], v[168:169], v[168:169] op_sel:[0,1,0] op_sel_hi:[1,1,0]
    v_pk_fma_f32 v[158:159], v[158:159], v[168:169], v[168:169] op_sel:[0,1,0] op_sel_hi:[1,1,0]
    v_pk_mul_f32 v[152:153], v[152:153], v[32:33]
    v_pk_mul_f32 v[154:155], v[154:155], v[34:35]
    v_pk_mul_f32 v[156:157], v[156:157], v[88:89]
    v_pk_mul_f32 v[158:159], v[158:159], v[90:91]
    v_exp_f32 v152, v152
    v_exp_f32 v153, v153
    v_exp_f32 v154, v154
    v_exp_f32 v155, v155
    v_exp_f32 v156, v156
    v_exp_f32 v157, v157
    v_exp_f32 v158, v158
    v_exp_f32 v159, v159
    v_pk_mul_f32 v[32:33], v[32:33], v[60:61]
    v_pk_mul_f32 v[34:35], v[34:35], v[62:63]
    v_pk_mul_f32 v[88:89], v[88:89], v[116:117]
    v_pk_mul_f32 v[90:91], v[90:91], v[118:119]
    v_pk_add_f32 v[152:153], v[152:153], 1.0 op_sel_hi:[1,0]
    v_pk_add_f32 v[154:155], v[154:155], 1.0 op_sel_hi:[1,0]
    v_pk_add_f32 v[156:157], v[156:157], 1.0 op_sel_hi:[1,0]
    v_pk_add_f32 v[158:159], v[158:159], 1.0 op_sel_hi:[1,0]
    v_rcp_f32 v152, v152
    v_rcp_f32 v153, v153
    v_rcp_f32 v154, v154
    v_rcp_f32 v155, v155
    v_rcp_f32 v156, v156
    v_rcp_f32 v157, v157
    v_rcp_f32 v158, v158
    v_rcp_f32 v159, v159
    v_pk_mul_f32 v[32:33], v[32:33], v[152:153]
    v_pk_mul_f32 v[34:35], v[34:35], v[154:155]
    v_pk_mul_f32 v[88:89], v[88:89], v[156:157]
    v_pk_mul_f32 v[90:91], v[90:91], v[158:159]
    v_cvt_pk_bf16_f32 v60, v32, v33
    v_cvt_pk_bf16_f32 v61, v34, v35
    v_cvt_pk_bf16_f32 v62, v88, v89
    v_cvt_pk_bf16_f32 v63, v90, v91
    s_nop 0
    v_permlane16_swap_b32 v60, v62
    v_permlane16_swap_b32 v61, v63
    global_store_dwordx4 v13, v[60:63], s[48:49] sc1
    ds_read_b128 v[136:139], v12 offset:768
    ds_read_b128 v[140:143], v12 offset:832
    s_waitcnt lgkmcnt(2)
    s_add_u32 s10, s8, 5
    s_lshr_b32 s11, s10, 2
    s_lshl_b32 s11, s11, 17
    s_and_b32 s10, s10, 3
    s_lshl_b32 s10, s10, 8
    s_add_u32 s10, s10, s11
    s_add_u32 s10, s10, s9
    s_add_u32 s50, s42, s10
    s_addc_u32 s51, s43, 0
    v_pk_fma_f32 v[152:153], v[144:145], v[128:129], v[148:149] op_sel:[0,1,0] op_sel_hi:[1,1,1]
    v_pk_fma_f32 v[154:155], v[146:147], v[128:129], v[150:151] op_sel:[0,1,0] op_sel_hi:[1,1,1]
    v_pk_fma_f32 v[156:157], v[144:145], v[130:131], v[148:149] op_sel:[0,1,0] op_sel_hi:[1,1,1]
    v_pk_fma_f32 v[158:159], v[146:147], v[130:131], v[150:151] op_sel:[0,1,0] op_sel_hi:[1,1,1]
    v_pk_fma_f32 v[160:161], v[144:145], v[132:133], v[148:149] op_sel:[0,1,0] op_sel_hi:[1,1,1]
    v_pk_fma_f32 v[162:163], v[146:147], v[132:133], v[150:151] op_sel:[0,1,0] op_sel_hi:[1,1,1]
    v_pk_fma_f32 v[164:165], v[144:145], v[134:135], v[148:149] op_sel:[0,1,0] op_sel_hi:[1,1,1]
    v_pk_fma_f32 v[166:167], v[146:147], v[134:135], v[150:151] op_sel:[0,1,0] op_sel_hi:[1,1,1]
    v_pk_fma_f32 v[36:37], v[36:37], v[128:129], v[152:153] op_sel_hi:[1,0,1]
    v_pk_fma_f32 v[38:39], v[38:39], v[128:129], v[154:155] op_sel_hi:[1,0,1]
    v_pk_fma_f32 v[64:65], v[64:65], v[130:131], v[156:157] op_sel_hi:[1,0,1]
    v_pk_fma_f32 v[66:67], v[66:67], v[130:131], v[158:159] op_sel_hi:[1,0,1]
    v_pk_fma_f32 v[92:93], v[92:93], v[132:133], v[160:161] op_sel_hi:[1,0,1]
    v_pk_fma_f32 v[94:95], v[94:95], v[132:133], v[162:163] op_sel_hi:[1,0,1]
    v_pk_fma_f32 v[120:121], v[120:121], v[134:135], v[164:165] op_sel_hi:[1,0,1]
    v_pk_fma_f32 v[122:123], v[122:123], v[134:135], v[166:167] op_sel_hi:[1,0,1]
    v_permlane32_swap_b32 v36, v64
    v_permlane32_swap_b32 v37, v65
    v_permlane32_swap_b32 v38, v66
    v_permlane32_swap_b32 v39, v67
    v_permlane32_swap_b32 v92, v120
    v_permlane32_swap_b32 v93, v121
    v_permlane32_swap_b32 v94, v122
    v_permlane32_swap_b32 v95, v123
    v_pk_mul_f32 v[152:153], v[36:37], v[36:37]
    v_pk_mul_f32 v[154:155], v[38:39], v[38:39]
    v_pk_mul_f32 v[156:157], v[92:93], v[92:93]
    v_pk_mul_f32 v[158:159], v[94:95], v[94:95]
    v_pk_fma_f32 v[152:153], v[152:153], v[168:169], v[168:169] op_sel:[0,1,0] op_sel_hi:[1,1,0]
    v_pk_fma_f32 v[154:155], v[154:155], v[168:169], v[168:169] op_sel:[0,1,0] op_sel_hi:[1,1,0]
    v_pk_fma_f32 v[156:157], v[156:157], v[168:169], v[168:169] op_sel:[0,1,0] op_sel_hi:[1,1,0]
    v_pk_fma_f32 v[158:159], v[158:159], v[168:169], v[168:169] op_sel:[0,1,0] op_sel_hi:[1,1,0]
    v_pk_mul_f32 v[152:153], v[152:153], v[36:37]
    v_pk_mul_f32 v[154:155], v[154:155], v[38:39]
    v_pk_mul_f32 v[156:157], v[156:157], v[92:93]
    v_pk_mul_f32 v[158:159], v[158:159], v[94:95]
    v_exp_f32 v152, v152
    v_exp_f32 v153, v153
    v_exp_f32 v154, v154
    v_exp_f32 v155, v155
    v_exp_f32 v156, v156
    v_exp_f32 v157, v157
    v_exp_f32 v158, v158
    v_exp_f32 v159, v159
    v_pk_mul_f32 v[36:37], v[36:37], v[64:65]
    v_pk_mul_f32 v[38:39], v[38:39], v[66:67]
    v_pk_mul_f32 v[92:93], v[92:93], v[120:121]
    v_pk_mul_f32 v[94:95], v[94:95], v[122:123]
    v_pk_add_f32 v[152:153], v[152:153], 1.0 op_sel_hi:[1,0]
    v_pk_add_f32 v[154:155], v[154:155], 1.0 op_sel_hi:[1,0]
    v_pk_add_f32 v[156:157], v[156:157], 1.0 op_sel_hi:[1,0]
    v_pk_add_f32 v[158:159], v[158:159], 1.0 op_sel_hi:[1,0]
    v_rcp_f32 v152, v152
    v_rcp_f32 v153, v153
    v_rcp_f32 v154, v154
    v_rcp_f32 v155, v155
    v_rcp_f32 v156, v156
    v_rcp_f32 v157, v157
    v_rcp_f32 v158, v158
    v_rcp_f32 v159, v159
    v_pk_mul_f32 v[36:37], v[36:37], v[152:153]
    v_pk_mul_f32 v[38:39], v[38:39], v[154:155]
    v_pk_mul_f32 v[92:93], v[92:93], v[156:157]
    v_pk_mul_f32 v[94:95], v[94:95], v[158:159]
    v_cvt_pk_bf16_f32 v64, v36, v37
    v_cvt_pk_bf16_f32 v65, v38, v39
    v_cvt_pk_bf16_f32 v66, v92, v93
    v_cvt_pk_bf16_f32 v67, v94, v95
    s_nop 0
    v_permlane16_swap_b32 v64, v66
    v_permlane16_swap_b32 v65, v67
    global_store_dwordx4 v13, v[64:67], s[50:51] sc1
    s_waitcnt lgkmcnt(0)
    s_add_u32 s10, s8, 6
    s_lshr_b32 s11, s10, 2
    s_lshl_b32 s11, s11, 17
    s_and_b32 s10, s10, 3
    s_lshl_b32 s10, s10, 8
    s_add_u32 s10, s10, s11
    s_add_u32 s10, s10, s9
    s_add_u32 s48, s42, s10
    s_addc_u32 s49, s43, 0
    v_pk_fma_f32 v[152:153], v[136:137], v[128:129], v[140:141] op_sel:[0,1,0] op_sel_hi:[1,1,1]
    v_pk_fma_f32 v[154:155], v[138:139], v[128:129], v[142:143] op_sel:[0,1,0] op_sel_hi:[1,1,1]
    v_pk_fma_f32 v[156:157], v[136:137], v[130:131], v[140:141] op_sel:[0,1,0] op_sel_hi:[1,1,1]
    v_pk_fma_f32 v[158:159], v[138:139], v[130:131], v[142:143] op_sel:[0,1,0] op_sel_hi:[1,1,1]
    v_pk_fma_f32 v[160:161], v[136:137], v[132:133], v[140:141] op_sel:[0,1,0] op_sel_hi:[1,1,1]
    v_pk_fma_f32 v[162:163], v[138:139], v[132:133], v[142:143] op_sel:[0,1,0] op_sel_hi:[1,1,1]
    v_pk_fma_f32 v[164:165], v[136:137], v[134:135], v[140:141] op_sel:[0,1,0] op_sel_hi:[1,1,1]
    v_pk_fma_f32 v[166:167], v[138:139], v[134:135], v[142:143] op_sel:[0,1,0] op_sel_hi:[1,1,1]
    v_pk_fma_f32 v[40:41], v[40:41], v[128:129], v[152:153] op_sel_hi:[1,0,1]
    v_pk_fma_f32 v[42:43], v[42:43], v[128:129], v[154:155] op_sel_hi:[1,0,1]
    v_pk_fma_f32 v[68:69], v[68:69], v[130:131], v[156:157] op_sel_hi:[1,0,1]
    v_pk_fma_f32 v[70:71], v[70:71], v[130:131], v[158:159] op_sel_hi:[1,0,1]
    v_pk_fma_f32 v[96:97], v[96:97], v[132:133], v[160:161] op_sel_hi:[1,0,1]
    v_pk_fma_f32 v[98:99], v[98:99], v[132:133], v[162:163] op_sel_hi:[1,0,1]
    v_pk_fma_f32 v[124:125], v[124:125], v[134:135], v[164:165] op_sel_hi:[1,0,1]
    v_pk_fma_f32 v[126:127], v[126:127], v[134:135], v[166:167] op_sel_hi:[1,0,1]
    v_permlane32_swap_b32 v40, v68
    v_permlane32_swap_b32 v41, v69
    v_permlane32_swap_b32 v42, v70
    v_permlane32_swap_b32 v43, v71
    v_permlane32_swap_b32 v96, v124
    v_permlane32_swap_b32 v97, v125
    v_permlane32_swap_b32 v98, v126
    v_permlane32_swap_b32 v99, v127
    v_pk_mul_f32 v[152:153], v[40:41], v[40:41]
    v_pk_mul_f32 v[154:155], v[42:43], v[42:43]
    v_pk_mul_f32 v[156:157], v[96:97], v[96:97]
    v_pk_mul_f32 v[158:159], v[98:99], v[98:99]
    v_pk_fma_f32 v[152:153], v[152:153], v[168:169], v[168:169] op_sel:[0,1,0] op_sel_hi:[1,1,0]
    v_pk_fma_f32 v[154:155], v[154:155], v[168:169], v[168:169] op_sel:[0,1,0] op_sel_hi:[1,1,0]
    v_pk_fma_f32 v[156:157], v[156:157], v[168:169], v[168:169] op_sel:[0,1,0] op_sel_hi:[1,1,0]
    v_pk_fma_f32 v[158:159], v[158:159], v[168:169], v[168:169] op_sel:[0,1,0] op_sel_hi:[1,1,0]
    v_pk_mul_f32 v[152:153], v[152:153], v[40:41]
    v_pk_mul_f32 v[154:155], v[154:155], v[42:43]
    v_pk_mul_f32 v[156:157], v[156:157], v[96:97]
    v_pk_mul_f32 v[158:159], v[158:159], v[98:99]
    v_exp_f32 v152, v152
    v_exp_f32 v153, v153
    v_exp_f32 v154, v154
    v_exp_f32 v155, v155
    v_exp_f32 v156, v156
    v_exp_f32 v157, v157
    v_exp_f32 v158, v158
    v_exp_f32 v159, v159
    v_pk_mul_f32 v[40:41], v[40:41], v[68:69]
    v_pk_mul_f32 v[42:43], v[42:43], v[70:71]
    v_pk_mul_f32 v[96:97], v[96:97], v[124:125]
    v_pk_mul_f32 v[98:99], v[98:99], v[126:127]
    v_pk_add_f32 v[152:153], v[152:153], 1.0 op_sel_hi:[1,0]
    v_pk_add_f32 v[154:155], v[154:155], 1.0 op_sel_hi:[1,0]
    v_pk_add_f32 v[156:157], v[156:157], 1.0 op_sel_hi:[1,0]
    v_pk_add_f32 v[158:159], v[158:159], 1.0 op_sel_hi:[1,0]
    v_rcp_f32 v152, v152
    v_rcp_f32 v153, v153
    v_rcp_f32 v154, v154
    v_rcp_f32 v155, v155
    v_rcp_f32 v156, v156
    v_rcp_f32 v157, v157
    v_rcp_f32 v158, v158
    v_rcp_f32 v159, v159
    v_pk_mul_f32 v[40:41], v[40:41], v[152:153]
    v_pk_mul_f32 v[42:43], v[42:43], v[154:155]
    v_pk_mul_f32 v[96:97], v[96:97], v[156:157]
    v_pk_mul_f32 v[98:99], v[98:99], v[158:159]
    v_cvt_pk_bf16_f32 v68, v40, v41
    v_cvt_pk_bf16_f32 v69, v42, v43
    v_cvt_pk_bf16_f32 v70, v96, v97
    v_cvt_pk_bf16_f32 v71, v98, v99
    s_nop 0
    v_permlane16_swap_b32 v68, v70
    v_permlane16_swap_b32 v69, v71
    global_store_dwordx4 v13, v[68:71], s[48:49] sc1
    s_waitcnt vmcnt(0)
    s_barrier
    s_cmp_lg_u32 s3, 7
    s_cbranch_scc1 ffn_kernel_sig7
    s_lshl_b32 s8, s4, 1
    s_lshr_b32 s9, s5, 4
    s_add_u32 s8, s8, s9
    s_add_u32 s8, s8, 8
    s_and_b32 s9, s5, 12
    s_cmp_eq_u32 s9, 0
    s_cselect_b32 s9, 0x10001, 1
    s_lshl_b32 s8, s8, 8
    s_add_u32 s8, s8, 81788928
    s_add_u32 s48, s42, s8
    s_addc_u32 s49, s43, 0
    v_lshlrev_b32 v11, 14, v1
    v_mov_b32 v12, s9
    s_mov_b64 exec, 0xff
    global_atomic_add v11, v12, s[48:49] sc1
    s_mov_b64 exec, -1
ffn_kernel_sig7:
    s_and_b32 s60, s3, 3
    s_and_b32 s4, s2, 7
    s_lshr_b32 s5, s2, 3
    s_lshr_b32 s6, s4, 0
    s_and_b32 s7, s4, 0
    s_mul_i32 s6, s6, 4
    s_mul_i32 s7, s7, 8
    s_lshr_b32 s56, s5, 3
    s_and_b32 s57, s5, 7
    s_add_u32 s4, s56, s6
    s_add_u32 s5, s57, s7
    s_and_b32 s61, s2, 1
    s_bfe_u32 s4, s2, 0x20001
    s_lshl_b32 s4, s4, 2
    s_lshr_b32 s5, s2, 6
    s_add_u32 s4, s4, s5
    s_bfe_u32 s5, s2, 0x30003
    v_lshlrev_b32 v2, 4, v1
    s_mul_i32 s8, s60, 4
    s_lshl_b32 s12, s8, 10
    s_lshr_b32 s9, s8, 3
    s_and_b32 s8, s8, 7
    s_lshl_b32 s9, s9, 7
    s_add_u32 s8, s8, s9
    s_lshl_b32 s8, s8, 10
    v_add_u32 v5, s8, v2
    s_mul_i32 s8, s60, 4
    s_min_u32 s8, s8, 12
    s_lshl_b32 s13, s8, 10
    s_add_u32 s13, s13, 16384
    s_lshr_b32 s9, s8, 3
    s_and_b32 s8, s8, 7
    s_mul_i32 s9, s9, 64
    s_add_u32 s8, s8, s9
    s_lshl_b32 s8, s8, 10
    v_add_u32 v6, s8, v2
    s_mul_i32 s8, s4, 8192
    s_add_u32 s8, s8, 47185920
    s_mul_i32 s9, s5, 8192
    s_add_u32 s9, s9, 38797312
    s_mul_i32 s10, s61, 7340032
    s_add_u32 s8, s8, s10
    s_mul_i32 s10, s61, 3670016
    s_add_u32 s9, s9, s10
    s_mov_b32 s14, 0
    s_waitcnt lgkmcnt(0)
    s_add_u32 s44, s42, s8
    s_addc_u32 s45, s43, 0
    s_add_u32 s46, s42, s9
    s_addc_u32 s47, s43, 0
    s_cmp_lt_u32 s3, 4
    s_cbranch_scc1 down_kernel_comp
    s_lshr_b32 s10, s2, 3
    s_and_b32 s10, s10, 7
    s_lshl_b32 s10, s10, 14
    s_add_u32 s10, s10, 81788928
    s_and_b32 s8, s4, 14
    s_add_u32 s8, s8, s61
    s_add_u32 s8, s8, 8
    s_lshl_b32 s8, s8, 8
    s_add_u32 s8, s8, s10
    s_add_u32 s54, s42, s8
    s_addc_u32 s55, s43, 0
    s_cmp_lg_u32 s3, 7
    s_cbranch_scc1 ffn_kernel_dep8
    s_lshr_b32 s8, s4, 1
    s_add_u32 s8, s8, 24
    s_lshl_b32 s8, s8, 8
    s_add_u32 s8, s8, s10
    s_add_u32 s50, s42, s8
    s_addc_u32 s51, s43, 0
    s_and_b32 s8, s4, 14
    s_add_u32 s8, s8, s61
    s_add_u32 s8, s8, 8
    s_lshl_b32 s8, s8, 8
    s_add_u32 s8, s8, s10
    s_add_u32 s48, s42, s8
    s_addc_u32 s49, s43, 0
    v_mov_b32 v11, 0
    s_mov_b32 s11, 131072
    s_mov_b64 exec, 1
ffn_kernel_poll9:
    s_sleep 6
    s_sub_u32 s11, s11, 1
    s_cbranch_scc1 ffn_kernel_end
    global_load_dword v12, v11, s[48:49] sc1
    global_load_dword v13, v11, s[50:51] sc1
    s_waitcnt vmcnt(0)
    v_cmp_le_u32 vcc, 32, v13
    s_nop 4
    s_cbranch_vccz ffn_kernel_poll9
    v_cmp_le_u32 vcc, 262144, v12
    s_nop 4
    s_cbranch_vccz ffn_kernel_poll9
    s_mov_b64 exec, -1
ffn_kernel_dep8:
    s_add_u32 m0, s13, 0
    s_nop 0
    global_load_lds_dwordx4 v6, s[46:47] offset:0
    global_load_lds_dwordx4 v6, s[46:47] offset:1024
    global_load_lds_dwordx4 v6, s[46:47] offset:2048
    global_load_lds_dwordx4 v6, s[46:47] offset:3072
    s_add_u32 s46, s46, 131072
    s_addc_u32 s47, s47, 0
    s_add_u32 m0, s13, 32768
    s_nop 0
    global_load_lds_dwordx4 v6, s[46:47] offset:0
    global_load_lds_dwordx4 v6, s[46:47] offset:1024
    global_load_lds_dwordx4 v6, s[46:47] offset:2048
    global_load_lds_dwordx4 v6, s[46:47] offset:3072
    s_add_u32 s46, s46, 131072
    s_addc_u32 s47, s47, 0
    s_add_u32 m0, s13, 65536
    s_nop 0
    global_load_lds_dwordx4 v6, s[46:47] offset:0
    global_load_lds_dwordx4 v6, s[46:47] offset:1024
    global_load_lds_dwordx4 v6, s[46:47] offset:2048
    global_load_lds_dwordx4 v6, s[46:47] offset:3072
    s_add_u32 s46, s46, 131072
    s_addc_u32 s47, s47, 0
    s_add_u32 m0, s13, 98304
    s_nop 0
    global_load_lds_dwordx4 v6, s[46:47] offset:0
    global_load_lds_dwordx4 v6, s[46:47] offset:1024
    global_load_lds_dwordx4 v6, s[46:47] offset:2048
    global_load_lds_dwordx4 v6, s[46:47] offset:3072
    s_add_u32 s46, s46, 131072
    s_addc_u32 s47, s47, 0
    s_barrier
    s_add_u32 m0, s12, 0
    s_nop 0
    global_load_lds_dwordx4 v5, s[44:45] offset:0 sc1
    global_load_lds_dwordx4 v5, s[44:45] offset:1024 sc1
    global_load_lds_dwordx4 v5, s[44:45] offset:2048 sc1
    global_load_lds_dwordx4 v5, s[44:45] offset:3072 sc1
    s_add_u32 s44, s44, 262144
    s_addc_u32 s45, s45, 0
    s_add_u32 m0, s12, 32768
    s_nop 0
    global_load_lds_dwordx4 v5, s[44:45] offset:0 sc1
    global_load_lds_dwordx4 v5, s[44:45] offset:1024 sc1
    global_load_lds_dwordx4 v5, s[44:45] offset:2048 sc1
    global_load_lds_dwordx4 v5, s[44:45] offset:3072 sc1
    s_add_u32 s44, s44, 262144
    s_addc_u32 s45, s45, 0
    s_add_u32 m0, s12, 65536
    s_nop 0
    global_load_lds_dwordx4 v5, s[44:45] offset:0 sc1
    global_load_lds_dwordx4 v5, s[44:45] offset:1024 sc1
    global_load_lds_dwordx4 v5, s[44:45] offset:2048 sc1
    global_load_lds_dwordx4 v5, s[44:45] offset:3072 sc1
    s_add_u32 s44, s44, 262144
    s_addc_u32 s45, s45, 0
    s_add_u32 m0, s12, 98304
    s_nop 0
    global_load_lds_dwordx4 v5, s[44:45] offset:0 sc1
    global_load_lds_dwordx4 v5, s[44:45] offset:1024 sc1
    global_load_lds_dwordx4 v5, s[44:45] offset:2048 sc1
    global_load_lds_dwordx4 v5, s[44:45] offset:3072 sc1
    s_add_u32 s44, s44, 262144
    s_addc_u32 s45, s45, 0
    s_mov_b32 s14, 0
    s_waitcnt vmcnt(12)
    s_barrier
    s_waitcnt vmcnt(8)
    s_barrier
    s_add_u32 m0, s14, s12
    s_nop 0
    global_load_lds_dwordx4 v5, s[44:45] sc1
    global_load_lds_dwordx4 v5, s[44:45] offset:1024 sc1
    global_load_lds_dwordx4 v5, s[44:45] offset:2048 sc1
    global_load_lds_dwordx4 v5, s[44:45] offset:3072 sc1
    s_add_u32 m0, s14, s13
    s_nop 0
    global_load_lds_dwordx4 v6, s[46:47]
    global_load_lds_dwordx4 v6, s[46:47] offset:1024
    global_load_lds_dwordx4 v6, s[46:47] offset:2048
    global_load_lds_dwordx4 v6, s[46:47] offset:3072
    s_add_u32 s44, s44, 262144
    s_addc_u32 s45, s45, 0
    s_add_u32 s46, s46, 131072
    s_addc_u32 s47, s47, 0
    s_add_u32 s14, s14, 32768
    s_cmp_eq_u32 s14, 131072
    s_cselect_b32 s14, 0, s14
    s_waitcnt vmcnt(12)
    s_barrier
    s_add_u32 m0, s14, s12
    s_nop 0
    global_load_lds_dwordx4 v5, s[44:45] sc1
    global_load_lds_dwordx4 v5, s[44:45] offset:1024 sc1
    global_load_lds_dwordx4 v5, s[44:45] offset:2048 sc1
    global_load_lds_dwordx4 v5, s[44:45] offset:3072 sc1
    s_add_u32 m0, s14, s13
    s_nop 0
    global_load_lds_dwordx4 v6, s[46:47]
    global_load_lds_dwordx4 v6, s[46:47] offset:1024
    global_load_lds_dwordx4 v6, s[46:47] offset:2048
    global_load_lds_dwordx4 v6, s[46:47] offset:3072
    s_add_u32 s44, s44, 262144
    s_addc_u32 s45, s45, 0
    s_add_u32 s46, s46, 131072
    s_addc_u32 s47, s47, 0
    s_add_u32 s14, s14, 32768
    s_cmp_eq_u32 s14, 131072
    s_cselect_b32 s14, 0, s14
    s_waitcnt vmcnt(16)
    s_barrier
    v_mov_b32 v11, 0
    global_load_dword v13, v11, s[54:55] sc1
    s_add_u32 m0, s14, s12
    s_nop 0
    global_load_lds_dwordx4 v5, s[44:45] sc1
    global_load_lds_dwordx4 v5, s[44:45] offset:1024 sc1
    global_load_lds_dwordx4 v5, s[44:45] offset:2048 sc1
    global_load_lds_dwordx4 v5, s[44:45] offset:3072 sc1
    s_add_u32 m0, s14, s13
    s_nop 0
    global_load_lds_dwordx4 v6, s[46:47]
    global_load_lds_dwordx4 v6, s[46:47] offset:1024
    global_load_lds_dwordx4 v6, s[46:47] offset:2048
    global_load_lds_dwordx4 v6, s[46:47] offset:3072
    s_add_u32 s44, s44, 262144
    s_addc_u32 s45, s45, 0
    s_add_u32 s46, s46, 131072
    s_addc_u32 s47, s47, 0
    s_add_u32 s14, s14, 32768
    s_cmp_eq_u32 s14, 131072
    s_cselect_b32 s14, 0, s14
    s_waitcnt vmcnt(8)
    s_mov_b32 s11, 131072
ffn_kernel_fullr11:
    v_readfirstlane_b32 s8, v13
    s_nop 0
    s_and_b32 s8, s8, 0xffff
    s_cmp_ge_u32 s8, 16
    s_cbranch_scc1 ffn_kernel_full10
    s_sub_u32 s11, s11, 1
    s_cbranch_scc1 ffn_kernel_end
    global_load_dword v13, v11, s[54:55] sc1
    s_waitcnt vmcnt(0)
    s_branch ffn_kernel_fullr11
ffn_kernel_full10:
    s_waitcnt vmcnt(16)
    s_barrier
    s_add_u32 m0, s14, s12
    s_nop 0
    global_load_lds_dwordx4 v5, s[44:45] sc1
    global_load_lds_dwordx4 v5, s[44:45] offset:1024 sc1
    global_load_lds_dwordx4 v5, s[44:45] offset:2048 sc1
    global_load_lds_dwordx4 v5, s[44:45] offset:3072 sc1
    s_add_u32 m0, s14, s13
    s_nop 0
    global_load_lds_dwordx4 v6, s[46:47]
    global_load_lds_dwordx4 v6, s[46:47] offset:1024
    global_load_lds_dwordx4 v6, s[46:47] offset:2048
    global_load_lds_dwordx4 v6, s[46:47] offset:3072
    s_add_u32 s44, s44, 262144
    s_addc_u32 s45, s45, 0
    s_add_u32 s46, s46, 131072
    s_addc_u32 s47, s47, 0
    s_add_u32 s14, s14, 32768
    s_cmp_eq_u32 s14, 131072
    s_cselect_b32 s14, 0, s14
    s_waitcnt vmcnt(16)
    s_barrier
    s_add_u32 m0, s14, s12
    s_nop 0
    global_load_lds_dwordx4 v5, s[44:45] sc1
    global_load_lds_dwordx4 v5, s[44:45] offset:1024 sc1
    global_load_lds_dwordx4 v5, s[44:45] offset:2048 sc1
    global_load_lds_dwordx4 v5, s[44:45] offset:3072 sc1
    s_add_u32 m0, s14, s13
    s_nop 0
    global_load_lds_dwordx4 v6, s[46:47]
    global_load_lds_dwordx4 v6, s[46:47] offset:1024
    global_load_lds_dwordx4 v6, s[46:47] offset:2048
    global_load_lds_dwordx4 v6, s[46:47] offset:3072
    s_add_u32 s44, s44, 262144
    s_addc_u32 s45, s45, 0
    s_add_u32 s46, s46, 131072
    s_addc_u32 s47, s47, 0
    s_add_u32 s14, s14, 32768
    s_cmp_eq_u32 s14, 131072
    s_cselect_b32 s14, 0, s14
    s_mov_b32 s11, 9
down_kernel_lloop:
    s_waitcnt vmcnt(16)
    s_barrier
    s_add_u32 m0, s14, s12
    s_nop 0
    global_load_lds_dwordx4 v5, s[44:45] sc1
    global_load_lds_dwordx4 v5, s[44:45] offset:1024 sc1
    global_load_lds_dwordx4 v5, s[44:45] offset:2048 sc1
    global_load_lds_dwordx4 v5, s[44:45] offset:3072 sc1
    s_add_u32 m0, s14, s13
    s_nop 0
    global_load_lds_dwordx4 v6, s[46:47]
    global_load_lds_dwordx4 v6, s[46:47] offset:1024
    global_load_lds_dwordx4 v6, s[46:47] offset:2048
    global_load_lds_dwordx4 v6, s[46:47] offset:3072
    s_add_u32 s44, s44, 262144
    s_addc_u32 s45, s45, 0
    s_add_u32 s46, s46, 131072
    s_addc_u32 s47, s47, 0
    s_add_u32 s14, s14, 32768
    s_cmp_eq_u32 s14, 131072
    s_cselect_b32 s14, 0, s14
    s_waitcnt vmcnt(16)
    s_barrier
    s_add_u32 m0, s14, s12
    s_nop 0
    global_load_lds_dwordx4 v5, s[44:45] sc1
    global_load_lds_dwordx4 v5, s[44:45] offset:1024 sc1
    global_load_lds_dwordx4 v5, s[44:45] offset:2048 sc1
    global_load_lds_dwordx4 v5, s[44:45] offset:3072 sc1
    s_add_u32 m0, s14, s13
    s_nop 0
    global_load_lds_dwordx4 v6, s[46:47]
    global_load_lds_dwordx4 v6, s[46:47] offset:1024
    global_load_lds_dwordx4 v6, s[46:47] offset:2048
    global_load_lds_dwordx4 v6, s[46:47] offset:3072
    s_add_u32 s44, s44, 262144
    s_addc_u32 s45, s45, 0
    s_add_u32 s46, s46, 131072
    s_addc_u32 s47, s47, 0
    s_add_u32 s14, s14, 32768
    s_cmp_eq_u32 s14, 131072
    s_cselect_b32 s14, 0, s14
    s_sub_u32 s11, s11, 1
    s_cmp_lg_u32 s11, 0
    s_cbranch_scc1 down_kernel_lloop
    s_waitcnt vmcnt(16)
    s_barrier
    s_add_u32 m0, s14, s12
    s_nop 0
    global_load_lds_dwordx4 v5, s[44:45] sc1
    global_load_lds_dwordx4 v5, s[44:45] offset:1024 sc1
    global_load_lds_dwordx4 v5, s[44:45] offset:2048 sc1
    global_load_lds_dwordx4 v5, s[44:45] offset:3072 sc1
    s_add_u32 m0, s14, s13
    s_nop 0
    global_load_lds_dwordx4 v6, s[46:47]
    global_load_lds_dwordx4 v6, s[46:47] offset:1024
    global_load_lds_dwordx4 v6, s[46:47] offset:2048
    global_load_lds_dwordx4 v6, s[46:47] offset:3072
    s_add_u32 s44, s44, 262144
    s_addc_u32 s45, s45, 0
    s_add_u32 s46, s46, 131072
    s_addc_u32 s47, s47, 0
    s_add_u32 s14, s14, 32768
    s_cmp_eq_u32 s14, 131072
    s_cselect_b32 s14, 0, s14
    s_waitcnt vmcnt(16)
    s_barrier
    s_waitcnt vmcnt(8)
    s_barrier
    s_waitcnt vmcnt(0)
    s_barrier
    s_endpgm
down_kernel_comp:
    s_barrier
    s_lshr_b32 s6, s3, 1
    s_and_b32 s7, s3, 1
    v_and_b32 v3, 15, v1
    v_lshrrev_b32 v4, 4, v1
    s_mul_i32 s8, s6, 4096
    s_lshl_b32 s9, s61, 11
    s_add_u32 s10, s8, s9
    v_add_u32 v7, s10, v2
    s_sub_u32 s10, s8, s9
    v_add_u32 v15, s10, v2
    s_mul_i32 s8, s7, 4096
    s_add_u32 s8, s8, 16384
    v_add_u32 v8, s8, v2
    s_mov_b32 s15, 0
    s_waitcnt lgkmcnt(0)
    s_barrier
    v_add_u32 v9, s15, v7
    v_add_u32 v10, s15, v8
    v_add_u32 v12, s15, v15
    s_add_u32 s15, s15, 32768
    s_cmp_eq_u32 s15, 131072
    s_cselect_b32 s15, 0, s15
    ds_read_b128 v[80:83], v9 offset:0
    ds_read_b128 v[84:87], v9 offset:1024
    ds_read_b128 v[88:91], v12 offset:2048
    ds_read_b128 v[92:95], v12 offset:3072
    ds_read_b128 v[96:99], v10 offset:0
    ds_read_b128 v[100:103], v10 offset:1024
    ds_read_b128 v[104:107], v10 offset:2048
    ds_read_b128 v[108:111], v10 offset:3072
    ds_read_b128 v[112:115], v9 offset:8192
    ds_read_b128 v[116:119], v9 offset:9216
    ds_read_b128 v[120:123], v12 offset:10240
    ds_read_b128 v[124:127], v12 offset:11264
    ds_read_b128 v[128:131], v10 offset:8192
    ds_read_b128 v[132:135], v10 offset:9216
    ds_read_b128 v[136:139], v10 offset:10240
    ds_read_b128 v[140:143], v10 offset:11264
    v_add_u32 v9, s15, v7
    v_add_u32 v10, s15, v8
    v_add_u32 v12, s15, v15
    s_add_u32 s15, s15, 32768
    s_cmp_eq_u32 s15, 131072
    s_cselect_b32 s15, 0, s15
    s_waitcnt lgkmcnt(0)
    s_barrier
    v_mfma_f32_16x16x32_bf16 v[16:19], v[96:99], v[80:83], 0
    ds_read_b128 v[144:147], v9 offset:0
    v_mfma_f32_16x16x32_bf16 v[32:35], v[96:99], v[84:87], 0
    ds_read_b128 v[148:151], v9 offset:1024
    v_mfma_f32_16x16x32_bf16 v[48:51], v[96:99], v[88:91], 0
    v_mfma_f32_16x16x32_bf16 v[64:67], v[96:99], v[92:95], 0
    ds_read_b128 v[152:155], v12 offset:2048
    v_mfma_f32_16x16x32_bf16 v[20:23], v[100:103], v[80:83], 0
    ds_read_b128 v[156:159], v12 offset:3072
    v_mfma_f32_16x16x32_bf16 v[36:39], v[100:103], v[84:87], 0
    v_mfma_f32_16x16x32_bf16 v[52:55], v[100:103], v[88:91], 0
    v_mfma_f32_16x16x32_bf16 v[68:71], v[100:103], v[92:95], 0
    ds_read_b128 v[160:163], v10 offset:0
    v_mfma_f32_16x16x32_bf16 v[24:27], v[104:107], v[80:83], 0
    ds_read_b128 v[164:167], v10 offset:1024
    v_mfma_f32_16x16x32_bf16 v[40:43], v[104:107], v[84:87], 0
    v_mfma_f32_16x16x32_bf16 v[56:59], v[104:107], v[88:91], 0
    ds_read_b128 v[168:171], v10 offset:2048
    v_mfma_f32_16x16x32_bf16 v[72:75], v[104:107], v[92:95], 0
    ds_read_b128 v[172:175], v10 offset:3072
    v_mfma_f32_16x16x32_bf16 v[28:31], v[108:111], v[80:83], 0
    v_mfma_f32_16x16x32_bf16 v[44:47], v[108:111], v[84:87], 0
    v_mfma_f32_16x16x32_bf16 v[60:63], v[108:111], v[88:91], 0
    ds_read_b128 v[176:179], v9 offset:8192
    v_mfma_f32_16x16x32_bf16 v[76:79], v[108:111], v[92:95], 0
    ds_read_b128 v[180:183], v9 offset:9216
    v_mfma_f32_16x16x32_bf16 v[16:19], v[128:131], v[112:115], v[16:19]
    v_mfma_f32_16x16x32_bf16 v[32:35], v[128:131], v[116:119], v[32:35]
    ds_read_b128 v[184:187], v12 offset:10240
    v_mfma_f32_16x16x32_bf16 v[48:51], v[128:131], v[120:123], v[48:51]
    ds_read_b128 v[188:191], v12 offset:11264
    v_mfma_f32_16x16x32_bf16 v[64:67], v[128:131], v[124:127], v[64:67]
    v_mfma_f32_16x16x32_bf16 v[20:23], v[132:135], v[112:115], v[20:23]
    v_mfma_f32_16x16x32_bf16 v[36:39], v[132:135], v[116:119], v[36:39]
    ds_read_b128 v[192:195], v10 offset:8192
    v_mfma_f32_16x16x32_bf16 v[52:55], v[132:135], v[120:123], v[52:55]
    ds_read_b128 v[196:199], v10 offset:9216
    v_mfma_f32_16x16x32_bf16 v[68:71], v[132:135], v[124:127], v[68:71]
    v_mfma_f32_16x16x32_bf16 v[24:27], v[136:139], v[112:115], v[24:27]
    ds_read_b128 v[200:203], v10 offset:10240
    v_mfma_f32_16x16x32_bf16 v[40:43], v[136:139], v[116:119], v[40:43]
    ds_read_b128 v[204:207], v10 offset:11264
    v_mfma_f32_16x16x32_bf16 v[56:59], v[136:139], v[120:123], v[56:59]
    v_mfma_f32_16x16x32_bf16 v[72:75], v[136:139], v[124:127], v[72:75]
    v_mfma_f32_16x16x32_bf16 v[28:31], v[140:143], v[112:115], v[28:31]
    v_mfma_f32_16x16x32_bf16 v[44:47], v[140:143], v[116:119], v[44:47]
    v_mfma_f32_16x16x32_bf16 v[60:63], v[140:143], v[120:123], v[60:63]
    v_mfma_f32_16x16x32_bf16 v[76:79], v[140:143], v[124:127], v[76:79]
    v_add_u32 v9, s15, v7
    v_add_u32 v10, s15, v8
    v_add_u32 v12, s15, v15
    s_add_u32 s15, s15, 32768
    s_cmp_eq_u32 s15, 131072
    s_cselect_b32 s15, 0, s15
    s_waitcnt lgkmcnt(0)
    s_barrier
    v_mfma_f32_16x16x32_bf16 v[16:19], v[160:163], v[144:147], v[16:19]
    ds_read_b128 v[80:83], v9 offset:0
    v_mfma_f32_16x16x32_bf16 v[32:35], v[160:163], v[148:151], v[32:35]
    ds_read_b128 v[84:87], v9 offset:1024
    v_mfma_f32_16x16x32_bf16 v[48:51], v[160:163], v[152:155], v[48:51]
    v_mfma_f32_16x16x32_bf16 v[64:67], v[160:163], v[156:159], v[64:67]
    ds_read_b128 v[88:91], v12 offset:2048
    v_mfma_f32_16x16x32_bf16 v[20:23], v[164:167], v[144:147], v[20:23]
    ds_read_b128 v[92:95], v12 offset:3072
    v_mfma_f32_16x16x32_bf16 v[36:39], v[164:167], v[148:151], v[36:39]
    v_mfma_f32_16x16x32_bf16 v[52:55], v[164:167], v[152:155], v[52:55]
    v_mfma_f32_16x16x32_bf16 v[68:71], v[164:167], v[156:159], v[68:71]
    ds_read_b128 v[96:99], v10 offset:0
    v_mfma_f32_16x16x32_bf16 v[24:27], v[168:171], v[144:147], v[24:27]
    ds_read_b128 v[100:103], v10 offset:1024
    v_mfma_f32_16x16x32_bf16 v[40:43], v[168:171], v[148:151], v[40:43]
    v_mfma_f32_16x16x32_bf16 v[56:59], v[168:171], v[152:155], v[56:59]
    ds_read_b128 v[104:107], v10 offset:2048
    v_mfma_f32_16x16x32_bf16 v[72:75], v[168:171], v[156:159], v[72:75]
    ds_read_b128 v[108:111], v10 offset:3072
    v_mfma_f32_16x16x32_bf16 v[28:31], v[172:175], v[144:147], v[28:31]
    v_mfma_f32_16x16x32_bf16 v[44:47], v[172:175], v[148:151], v[44:47]
    v_mfma_f32_16x16x32_bf16 v[60:63], v[172:175], v[152:155], v[60:63]
    ds_read_b128 v[112:115], v9 offset:8192
    v_mfma_f32_16x16x32_bf16 v[76:79], v[172:175], v[156:159], v[76:79]
    ds_read_b128 v[116:119], v9 offset:9216
    v_mfma_f32_16x16x32_bf16 v[16:19], v[192:195], v[176:179], v[16:19]
    v_mfma_f32_16x16x32_bf16 v[32:35], v[192:195], v[180:183], v[32:35]
    ds_read_b128 v[120:123], v12 offset:10240
    v_mfma_f32_16x16x32_bf16 v[48:51], v[192:195], v[184:187], v[48:51]
    ds_read_b128 v[124:127], v12 offset:11264
    v_mfma_f32_16x16x32_bf16 v[64:67], v[192:195], v[188:191], v[64:67]
    v_mfma_f32_16x16x32_bf16 v[20:23], v[196:199], v[176:179], v[20:23]
    v_mfma_f32_16x16x32_bf16 v[36:39], v[196:199], v[180:183], v[36:39]
    ds_read_b128 v[128:131], v10 offset:8192
    v_mfma_f32_16x16x32_bf16 v[52:55], v[196:199], v[184:187], v[52:55]
    ds_read_b128 v[132:135], v10 offset:9216
    v_mfma_f32_16x16x32_bf16 v[68:71], v[196:199], v[188:191], v[68:71]
    v_mfma_f32_16x16x32_bf16 v[24:27], v[200:203], v[176:179], v[24:27]
    ds_read_b128 v[136:139], v10 offset:10240
    v_mfma_f32_16x16x32_bf16 v[40:43], v[200:203], v[180:183], v[40:43]
    ds_read_b128 v[140:143], v10 offset:11264
    v_mfma_f32_16x16x32_bf16 v[56:59], v[200:203], v[184:187], v[56:59]
    v_mfma_f32_16x16x32_bf16 v[72:75], v[200:203], v[188:191], v[72:75]
    v_mfma_f32_16x16x32_bf16 v[28:31], v[204:207], v[176:179], v[28:31]
    v_mfma_f32_16x16x32_bf16 v[44:47], v[204:207], v[180:183], v[44:47]
    v_mfma_f32_16x16x32_bf16 v[60:63], v[204:207], v[184:187], v[60:63]
    v_mfma_f32_16x16x32_bf16 v[76:79], v[204:207], v[188:191], v[76:79]
    v_add_u32 v9, s15, v7
    v_add_u32 v10, s15, v8
    v_add_u32 v12, s15, v15
    s_add_u32 s15, s15, 32768
    s_cmp_eq_u32 s15, 131072
    s_cselect_b32 s15, 0, s15
    s_waitcnt lgkmcnt(0)
    s_barrier
    v_mfma_f32_16x16x32_bf16 v[16:19], v[96:99], v[80:83], v[16:19]
    ds_read_b128 v[144:147], v9 offset:0
    v_mfma_f32_16x16x32_bf16 v[32:35], v[96:99], v[84:87], v[32:35]
    ds_read_b128 v[148:151], v9 offset:1024
    v_mfma_f32_16x16x32_bf16 v[48:51], v[96:99], v[88:91], v[48:51]
    v_mfma_f32_16x16x32_bf16 v[64:67], v[96:99], v[92:95], v[64:67]
    ds_read_b128 v[152:155], v12 offset:2048
    v_mfma_f32_16x16x32_bf16 v[20:23], v[100:103], v[80:83], v[20:23]
    ds_read_b128 v[156:159], v12 offset:3072
    v_mfma_f32_16x16x32_bf16 v[36:39], v[100:103], v[84:87], v[36:39]
    v_mfma_f32_16x16x32_bf16 v[52:55], v[100:103], v[88:91], v[52:55]
    v_mfma_f32_16x16x32_bf16 v[68:71], v[100:103], v[92:95], v[68:71]
    ds_read_b128 v[160:163], v10 offset:0
    v_mfma_f32_16x16x32_bf16 v[24:27], v[104:107], v[80:83], v[24:27]
    ds_read_b128 v[164:167], v10 offset:1024
    v_mfma_f32_16x16x32_bf16 v[40:43], v[104:107], v[84:87], v[40:43]
    v_mfma_f32_16x16x32_bf16 v[56:59], v[104:107], v[88:91], v[56:59]
    ds_read_b128 v[168:171], v10 offset:2048
    v_mfma_f32_16x16x32_bf16 v[72:75], v[104:107], v[92:95], v[72:75]
    ds_read_b128 v[172:175], v10 offset:3072
    v_mfma_f32_16x16x32_bf16 v[28:31], v[108:111], v[80:83], v[28:31]
    v_mfma_f32_16x16x32_bf16 v[44:47], v[108:111], v[84:87], v[44:47]
    v_mfma_f32_16x16x32_bf16 v[60:63], v[108:111], v[88:91], v[60:63]
    ds_read_b128 v[176:179], v9 offset:8192
    v_mfma_f32_16x16x32_bf16 v[76:79], v[108:111], v[92:95], v[76:79]
    ds_read_b128 v[180:183], v9 offset:9216
    v_mfma_f32_16x16x32_bf16 v[16:19], v[128:131], v[112:115], v[16:19]
    v_mfma_f32_16x16x32_bf16 v[32:35], v[128:131], v[116:119], v[32:35]
    ds_read_b128 v[184:187], v12 offset:10240
    v_mfma_f32_16x16x32_bf16 v[48:51], v[128:131], v[120:123], v[48:51]
    ds_read_b128 v[188:191], v12 offset:11264
    v_mfma_f32_16x16x32_bf16 v[64:67], v[128:131], v[124:127], v[64:67]
    v_mfma_f32_16x16x32_bf16 v[20:23], v[132:135], v[112:115], v[20:23]
    v_mfma_f32_16x16x32_bf16 v[36:39], v[132:135], v[116:119], v[36:39]
    ds_read_b128 v[192:195], v10 offset:8192
    v_mfma_f32_16x16x32_bf16 v[52:55], v[132:135], v[120:123], v[52:55]
    ds_read_b128 v[196:199], v10 offset:9216
    v_mfma_f32_16x16x32_bf16 v[68:71], v[132:135], v[124:127], v[68:71]
    v_mfma_f32_16x16x32_bf16 v[24:27], v[136:139], v[112:115], v[24:27]
    ds_read_b128 v[200:203], v10 offset:10240
    v_mfma_f32_16x16x32_bf16 v[40:43], v[136:139], v[116:119], v[40:43]
    ds_read_b128 v[204:207], v10 offset:11264
    v_mfma_f32_16x16x32_bf16 v[56:59], v[136:139], v[120:123], v[56:59]
    v_mfma_f32_16x16x32_bf16 v[72:75], v[136:139], v[124:127], v[72:75]
    v_mfma_f32_16x16x32_bf16 v[28:31], v[140:143], v[112:115], v[28:31]
    v_mfma_f32_16x16x32_bf16 v[44:47], v[140:143], v[116:119], v[44:47]
    v_mfma_f32_16x16x32_bf16 v[60:63], v[140:143], v[120:123], v[60:63]
    v_mfma_f32_16x16x32_bf16 v[76:79], v[140:143], v[124:127], v[76:79]
    v_add_u32 v9, s15, v7
    v_add_u32 v10, s15, v8
    v_add_u32 v12, s15, v15
    s_add_u32 s15, s15, 32768
    s_cmp_eq_u32 s15, 131072
    s_cselect_b32 s15, 0, s15
    s_waitcnt lgkmcnt(0)
    s_barrier
    v_mfma_f32_16x16x32_bf16 v[16:19], v[160:163], v[144:147], v[16:19]
    ds_read_b128 v[80:83], v9 offset:0
    v_mfma_f32_16x16x32_bf16 v[32:35], v[160:163], v[148:151], v[32:35]
    ds_read_b128 v[84:87], v9 offset:1024
    v_mfma_f32_16x16x32_bf16 v[48:51], v[160:163], v[152:155], v[48:51]
    v_mfma_f32_16x16x32_bf16 v[64:67], v[160:163], v[156:159], v[64:67]
    ds_read_b128 v[88:91], v12 offset:2048
    v_mfma_f32_16x16x32_bf16 v[20:23], v[164:167], v[144:147], v[20:23]
    ds_read_b128 v[92:95], v12 offset:3072
    v_mfma_f32_16x16x32_bf16 v[36:39], v[164:167], v[148:151], v[36:39]
    v_mfma_f32_16x16x32_bf16 v[52:55], v[164:167], v[152:155], v[52:55]
    v_mfma_f32_16x16x32_bf16 v[68:71], v[164:167], v[156:159], v[68:71]
    ds_read_b128 v[96:99], v10 offset:0
    v_mfma_f32_16x16x32_bf16 v[24:27], v[168:171], v[144:147], v[24:27]
    ds_read_b128 v[100:103], v10 offset:1024
    v_mfma_f32_16x16x32_bf16 v[40:43], v[168:171], v[148:151], v[40:43]
    v_mfma_f32_16x16x32_bf16 v[56:59], v[168:171], v[152:155], v[56:59]
    ds_read_b128 v[104:107], v10 offset:2048
    v_mfma_f32_16x16x32_bf16 v[72:75], v[168:171], v[156:159], v[72:75]
    ds_read_b128 v[108:111], v10 offset:3072
    v_mfma_f32_16x16x32_bf16 v[28:31], v[172:175], v[144:147], v[28:31]
    v_mfma_f32_16x16x32_bf16 v[44:47], v[172:175], v[148:151], v[44:47]
    v_mfma_f32_16x16x32_bf16 v[60:63], v[172:175], v[152:155], v[60:63]
    ds_read_b128 v[112:115], v9 offset:8192
    v_mfma_f32_16x16x32_bf16 v[76:79], v[172:175], v[156:159], v[76:79]
    ds_read_b128 v[116:119], v9 offset:9216
    v_mfma_f32_16x16x32_bf16 v[16:19], v[192:195], v[176:179], v[16:19]
    v_mfma_f32_16x16x32_bf16 v[32:35], v[192:195], v[180:183], v[32:35]
    ds_read_b128 v[120:123], v12 offset:10240
    v_mfma_f32_16x16x32_bf16 v[48:51], v[192:195], v[184:187], v[48:51]
    ds_read_b128 v[124:127], v12 offset:11264
    v_mfma_f32_16x16x32_bf16 v[64:67], v[192:195], v[188:191], v[64:67]
    v_mfma_f32_16x16x32_bf16 v[20:23], v[196:199], v[176:179], v[20:23]
    v_mfma_f32_16x16x32_bf16 v[36:39], v[196:199], v[180:183], v[36:39]
    ds_read_b128 v[128:131], v10 offset:8192
    v_mfma_f32_16x16x32_bf16 v[52:55], v[196:199], v[184:187], v[52:55]
    ds_read_b128 v[132:135], v10 offset:9216
    v_mfma_f32_16x16x32_bf16 v[68:71], v[196:199], v[188:191], v[68:71]
    v_mfma_f32_16x16x32_bf16 v[24:27], v[200:203], v[176:179], v[24:27]
    ds_read_b128 v[136:139], v10 offset:10240
    v_mfma_f32_16x16x32_bf16 v[40:43], v[200:203], v[180:183], v[40:43]
    ds_read_b128 v[140:143], v10 offset:11264
    v_mfma_f32_16x16x32_bf16 v[56:59], v[200:203], v[184:187], v[56:59]
    v_mfma_f32_16x16x32_bf16 v[72:75], v[200:203], v[188:191], v[72:75]
    v_mfma_f32_16x16x32_bf16 v[28:31], v[204:207], v[176:179], v[28:31]
    v_mfma_f32_16x16x32_bf16 v[44:47], v[204:207], v[180:183], v[44:47]
    v_mfma_f32_16x16x32_bf16 v[60:63], v[204:207], v[184:187], v[60:63]
    v_mfma_f32_16x16x32_bf16 v[76:79], v[204:207], v[188:191], v[76:79]
    v_add_u32 v9, s15, v7
    v_add_u32 v10, s15, v8
    v_add_u32 v12, s15, v15
    s_add_u32 s15, s15, 32768
    s_cmp_eq_u32 s15, 131072
    s_cselect_b32 s15, 0, s15
    s_waitcnt lgkmcnt(0)
    s_barrier
    v_mfma_f32_16x16x32_bf16 v[16:19], v[96:99], v[80:83], v[16:19]
    ds_read_b128 v[144:147], v9 offset:0
    v_mfma_f32_16x16x32_bf16 v[32:35], v[96:99], v[84:87], v[32:35]
    ds_read_b128 v[148:151], v9 offset:1024
    v_mfma_f32_16x16x32_bf16 v[48:51], v[96:99], v[88:91], v[48:51]
    v_mfma_f32_16x16x32_bf16 v[64:67], v[96:99], v[92:95], v[64:67]
    ds_read_b128 v[152:155], v12 offset:2048
    v_mfma_f32_16x16x32_bf16 v[20:23], v[100:103], v[80:83], v[20:23]
    ds_read_b128 v[156:159], v12 offset:3072
    v_mfma_f32_16x16x32_bf16 v[36:39], v[100:103], v[84:87], v[36:39]
    v_mfma_f32_16x16x32_bf16 v[52:55], v[100:103], v[88:91], v[52:55]
    v_mfma_f32_16x16x32_bf16 v[68:71], v[100:103], v[92:95], v[68:71]
    ds_read_b128 v[160:163], v10 offset:0
    v_mfma_f32_16x16x32_bf16 v[24:27], v[104:107], v[80:83], v[24:27]
    ds_read_b128 v[164:167], v10 offset:1024
    v_mfma_f32_16x16x32_bf16 v[40:43], v[104:107], v[84:87], v[40:43]
    v_mfma_f32_16x16x32_bf16 v[56:59], v[104:107], v[88:91], v[56:59]
    ds_read_b128 v[168:171], v10 offset:2048
    v_mfma_f32_16x16x32_bf16 v[72:75], v[104:107], v[92:95], v[72:75]
    ds_read_b128 v[172:175], v10 offset:3072
    v_mfma_f32_16x16x32_bf16 v[28:31], v[108:111], v[80:83], v[28:31]
    v_mfma_f32_16x16x32_bf16 v[44:47], v[108:111], v[84:87], v[44:47]
    v_mfma_f32_16x16x32_bf16 v[60:63], v[108:111], v[88:91], v[60:63]
    ds_read_b128 v[176:179], v9 offset:8192
    v_mfma_f32_16x16x32_bf16 v[76:79], v[108:111], v[92:95], v[76:79]
    ds_read_b128 v[180:183], v9 offset:9216
    v_mfma_f32_16x16x32_bf16 v[16:19], v[128:131], v[112:115], v[16:19]
    v_mfma_f32_16x16x32_bf16 v[32:35], v[128:131], v[116:119], v[32:35]
    ds_read_b128 v[184:187], v12 offset:10240
    v_mfma_f32_16x16x32_bf16 v[48:51], v[128:131], v[120:123], v[48:51]
    ds_read_b128 v[188:191], v12 offset:11264
    v_mfma_f32_16x16x32_bf16 v[64:67], v[128:131], v[124:127], v[64:67]
    v_mfma_f32_16x16x32_bf16 v[20:23], v[132:135], v[112:115], v[20:23]
    v_mfma_f32_16x16x32_bf16 v[36:39], v[132:135], v[116:119], v[36:39]
    ds_read_b128 v[192:195], v10 offset:8192
    v_mfma_f32_16x16x32_bf16 v[52:55], v[132:135], v[120:123], v[52:55]
    ds_read_b128 v[196:199], v10 offset:9216
    v_mfma_f32_16x16x32_bf16 v[68:71], v[132:135], v[124:127], v[68:71]
    v_mfma_f32_16x16x32_bf16 v[24:27], v[136:139], v[112:115], v[24:27]
    ds_read_b128 v[200:203], v10 offset:10240
    v_mfma_f32_16x16x32_bf16 v[40:43], v[136:139], v[116:119], v[40:43]
    ds_read_b128 v[204:207], v10 offset:11264
    v_mfma_f32_16x16x32_bf16 v[56:59], v[136:139], v[120:123], v[56:59]
    v_mfma_f32_16x16x32_bf16 v[72:75], v[136:139], v[124:127], v[72:75]
    v_mfma_f32_16x16x32_bf16 v[28:31], v[140:143], v[112:115], v[28:31]
    v_mfma_f32_16x16x32_bf16 v[44:47], v[140:143], v[116:119], v[44:47]
    v_mfma_f32_16x16x32_bf16 v[60:63], v[140:143], v[120:123], v[60:63]
    v_mfma_f32_16x16x32_bf16 v[76:79], v[140:143], v[124:127], v[76:79]
    s_mov_b32 s11, 9
down_kernel_loop:
    v_add_u32 v9, s15, v7
    v_add_u32 v10, s15, v8
    v_add_u32 v12, s15, v15
    s_add_u32 s15, s15, 32768
    s_cmp_eq_u32 s15, 131072
    s_cselect_b32 s15, 0, s15
    s_waitcnt lgkmcnt(0)
    s_barrier
    v_mfma_f32_16x16x32_bf16 v[16:19], v[160:163], v[144:147], v[16:19]
    ds_read_b128 v[80:83], v9 offset:0
    v_mfma_f32_16x16x32_bf16 v[32:35], v[160:163], v[148:151], v[32:35]
    ds_read_b128 v[84:87], v9 offset:1024
    v_mfma_f32_16x16x32_bf16 v[48:51], v[160:163], v[152:155], v[48:51]
    v_mfma_f32_16x16x32_bf16 v[64:67], v[160:163], v[156:159], v[64:67]
    ds_read_b128 v[88:91], v12 offset:2048
    v_mfma_f32_16x16x32_bf16 v[20:23], v[164:167], v[144:147], v[20:23]
    ds_read_b128 v[92:95], v12 offset:3072
    v_mfma_f32_16x16x32_bf16 v[36:39], v[164:167], v[148:151], v[36:39]
    v_mfma_f32_16x16x32_bf16 v[52:55], v[164:167], v[152:155], v[52:55]
    v_mfma_f32_16x16x32_bf16 v[68:71], v[164:167], v[156:159], v[68:71]
    ds_read_b128 v[96:99], v10 offset:0
    v_mfma_f32_16x16x32_bf16 v[24:27], v[168:171], v[144:147], v[24:27]
    ds_read_b128 v[100:103], v10 offset:1024
    v_mfma_f32_16x16x32_bf16 v[40:43], v[168:171], v[148:151], v[40:43]
    v_mfma_f32_16x16x32_bf16 v[56:59], v[168:171], v[152:155], v[56:59]
    ds_read_b128 v[104:107], v10 offset:2048
    v_mfma_f32_16x16x32_bf16 v[72:75], v[168:171], v[156:159], v[72:75]
    ds_read_b128 v[108:111], v10 offset:3072
    v_mfma_f32_16x16x32_bf16 v[28:31], v[172:175], v[144:147], v[28:31]
    v_mfma_f32_16x16x32_bf16 v[44:47], v[172:175], v[148:151], v[44:47]
    v_mfma_f32_16x16x32_bf16 v[60:63], v[172:175], v[152:155], v[60:63]
    ds_read_b128 v[112:115], v9 offset:8192
    v_mfma_f32_16x16x32_bf16 v[76:79], v[172:175], v[156:159], v[76:79]
    ds_read_b128 v[116:119], v9 offset:9216
    v_mfma_f32_16x16x32_bf16 v[16:19], v[192:195], v[176:179], v[16:19]
    v_mfma_f32_16x16x32_bf16 v[32:35], v[192:195], v[180:183], v[32:35]
    ds_read_b128 v[120:123], v12 offset:10240
    v_mfma_f32_16x16x32_bf16 v[48:51], v[192:195], v[184:187], v[48:51]
    ds_read_b128 v[124:127], v12 offset:11264
    v_mfma_f32_16x16x32_bf16 v[64:67], v[192:195], v[188:191], v[64:67]
    v_mfma_f32_16x16x32_bf16 v[20:23], v[196:199], v[176:179], v[20:23]
    v_mfma_f32_16x16x32_bf16 v[36:39], v[196:199], v[180:183], v[36:39]
    ds_read_b128 v[128:131], v10 offset:8192
    v_mfma_f32_16x16x32_bf16 v[52:55], v[196:199], v[184:187], v[52:55]
    ds_read_b128 v[132:135], v10 offset:9216
    v_mfma_f32_16x16x32_bf16 v[68:71], v[196:199], v[188:191], v[68:71]
    v_mfma_f32_16x16x32_bf16 v[24:27], v[200:203], v[176:179], v[24:27]
    ds_read_b128 v[136:139], v10 offset:10240
    v_mfma_f32_16x16x32_bf16 v[40:43], v[200:203], v[180:183], v[40:43]
    ds_read_b128 v[140:143], v10 offset:11264
    v_mfma_f32_16x16x32_bf16 v[56:59], v[200:203], v[184:187], v[56:59]
    v_mfma_f32_16x16x32_bf16 v[72:75], v[200:203], v[188:191], v[72:75]
    v_mfma_f32_16x16x32_bf16 v[28:31], v[204:207], v[176:179], v[28:31]
    v_mfma_f32_16x16x32_bf16 v[44:47], v[204:207], v[180:183], v[44:47]
    v_mfma_f32_16x16x32_bf16 v[60:63], v[204:207], v[184:187], v[60:63]
    v_mfma_f32_16x16x32_bf16 v[76:79], v[204:207], v[188:191], v[76:79]
    v_add_u32 v9, s15, v7
    v_add_u32 v10, s15, v8
    v_add_u32 v12, s15, v15
    s_add_u32 s15, s15, 32768
    s_cmp_eq_u32 s15, 131072
    s_cselect_b32 s15, 0, s15
    s_waitcnt lgkmcnt(0)
    s_barrier
    v_mfma_f32_16x16x32_bf16 v[16:19], v[96:99], v[80:83], v[16:19]
    ds_read_b128 v[144:147], v9 offset:0
    v_mfma_f32_16x16x32_bf16 v[32:35], v[96:99], v[84:87], v[32:35]
    ds_read_b128 v[148:151], v9 offset:1024
    v_mfma_f32_16x16x32_bf16 v[48:51], v[96:99], v[88:91], v[48:51]
    v_mfma_f32_16x16x32_bf16 v[64:67], v[96:99], v[92:95], v[64:67]
    ds_read_b128 v[152:155], v12 offset:2048
    v_mfma_f32_16x16x32_bf16 v[20:23], v[100:103], v[80:83], v[20:23]
    ds_read_b128 v[156:159], v12 offset:3072
    v_mfma_f32_16x16x32_bf16 v[36:39], v[100:103], v[84:87], v[36:39]
    v_mfma_f32_16x16x32_bf16 v[52:55], v[100:103], v[88:91], v[52:55]
    v_mfma_f32_16x16x32_bf16 v[68:71], v[100:103], v[92:95], v[68:71]
    ds_read_b128 v[160:163], v10 offset:0
    v_mfma_f32_16x16x32_bf16 v[24:27], v[104:107], v[80:83], v[24:27]
    ds_read_b128 v[164:167], v10 offset:1024
    v_mfma_f32_16x16x32_bf16 v[40:43], v[104:107], v[84:87], v[40:43]
    v_mfma_f32_16x16x32_bf16 v[56:59], v[104:107], v[88:91], v[56:59]
    ds_read_b128 v[168:171], v10 offset:2048
    v_mfma_f32_16x16x32_bf16 v[72:75], v[104:107], v[92:95], v[72:75]
    ds_read_b128 v[172:175], v10 offset:3072
    v_mfma_f32_16x16x32_bf16 v[28:31], v[108:111], v[80:83], v[28:31]
    v_mfma_f32_16x16x32_bf16 v[44:47], v[108:111], v[84:87], v[44:47]
    v_mfma_f32_16x16x32_bf16 v[60:63], v[108:111], v[88:91], v[60:63]
    ds_read_b128 v[176:179], v9 offset:8192
    v_mfma_f32_16x16x32_bf16 v[76:79], v[108:111], v[92:95], v[76:79]
    ds_read_b128 v[180:183], v9 offset:9216
    v_mfma_f32_16x16x32_bf16 v[16:19], v[128:131], v[112:115], v[16:19]
    v_mfma_f32_16x16x32_bf16 v[32:35], v[128:131], v[116:119], v[32:35]
    ds_read_b128 v[184:187], v12 offset:10240
    v_mfma_f32_16x16x32_bf16 v[48:51], v[128:131], v[120:123], v[48:51]
    ds_read_b128 v[188:191], v12 offset:11264
    v_mfma_f32_16x16x32_bf16 v[64:67], v[128:131], v[124:127], v[64:67]
    v_mfma_f32_16x16x32_bf16 v[20:23], v[132:135], v[112:115], v[20:23]
    v_mfma_f32_16x16x32_bf16 v[36:39], v[132:135], v[116:119], v[36:39]
    ds_read_b128 v[192:195], v10 offset:8192
    v_mfma_f32_16x16x32_bf16 v[52:55], v[132:135], v[120:123], v[52:55]
    ds_read_b128 v[196:199], v10 offset:9216
    v_mfma_f32_16x16x32_bf16 v[68:71], v[132:135], v[124:127], v[68:71]
    v_mfma_f32_16x16x32_bf16 v[24:27], v[136:139], v[112:115], v[24:27]
    ds_read_b128 v[200:203], v10 offset:10240
    v_mfma_f32_16x16x32_bf16 v[40:43], v[136:139], v[116:119], v[40:43]
    ds_read_b128 v[204:207], v10 offset:11264
    v_mfma_f32_16x16x32_bf16 v[56:59], v[136:139], v[120:123], v[56:59]
    v_mfma_f32_16x16x32_bf16 v[72:75], v[136:139], v[124:127], v[72:75]
    v_mfma_f32_16x16x32_bf16 v[28:31], v[140:143], v[112:115], v[28:31]
    v_mfma_f32_16x16x32_bf16 v[44:47], v[140:143], v[116:119], v[44:47]
    v_mfma_f32_16x16x32_bf16 v[60:63], v[140:143], v[120:123], v[60:63]
    v_mfma_f32_16x16x32_bf16 v[76:79], v[140:143], v[124:127], v[76:79]
    s_sub_u32 s11, s11, 1
    s_cmp_lg_u32 s11, 0
    s_cbranch_scc1 down_kernel_loop
    v_add_u32 v9, s15, v7
    v_add_u32 v10, s15, v8
    v_add_u32 v12, s15, v15
    s_add_u32 s15, s15, 32768
    s_cmp_eq_u32 s15, 131072
    s_cselect_b32 s15, 0, s15
    s_waitcnt lgkmcnt(0)
    s_barrier
    v_mfma_f32_16x16x32_bf16 v[16:19], v[160:163], v[144:147], v[16:19]
    ds_read_b128 v[80:83], v9 offset:0
    v_mfma_f32_16x16x32_bf16 v[32:35], v[160:163], v[148:151], v[32:35]
    ds_read_b128 v[84:87], v9 offset:1024
    v_mfma_f32_16x16x32_bf16 v[48:51], v[160:163], v[152:155], v[48:51]
    v_mfma_f32_16x16x32_bf16 v[64:67], v[160:163], v[156:159], v[64:67]
    ds_read_b128 v[88:91], v12 offset:2048
    v_mfma_f32_16x16x32_bf16 v[20:23], v[164:167], v[144:147], v[20:23]
    ds_read_b128 v[92:95], v12 offset:3072
    v_mfma_f32_16x16x32_bf16 v[36:39], v[164:167], v[148:151], v[36:39]
    v_mfma_f32_16x16x32_bf16 v[52:55], v[164:167], v[152:155], v[52:55]
    v_mfma_f32_16x16x32_bf16 v[68:71], v[164:167], v[156:159], v[68:71]
    ds_read_b128 v[96:99], v10 offset:0
    v_mfma_f32_16x16x32_bf16 v[24:27], v[168:171], v[144:147], v[24:27]
    ds_read_b128 v[100:103], v10 offset:1024
    v_mfma_f32_16x16x32_bf16 v[40:43], v[168:171], v[148:151], v[40:43]
    v_mfma_f32_16x16x32_bf16 v[56:59], v[168:171], v[152:155], v[56:59]
    ds_read_b128 v[104:107], v10 offset:2048
    v_mfma_f32_16x16x32_bf16 v[72:75], v[168:171], v[156:159], v[72:75]
    ds_read_b128 v[108:111], v10 offset:3072
    v_mfma_f32_16x16x32_bf16 v[28:31], v[172:175], v[144:147], v[28:31]
    v_mfma_f32_16x16x32_bf16 v[44:47], v[172:175], v[148:151], v[44:47]
    v_mfma_f32_16x16x32_bf16 v[60:63], v[172:175], v[152:155], v[60:63]
    ds_read_b128 v[112:115], v9 offset:8192
    v_mfma_f32_16x16x32_bf16 v[76:79], v[172:175], v[156:159], v[76:79]
    ds_read_b128 v[116:119], v9 offset:9216
    v_mfma_f32_16x16x32_bf16 v[16:19], v[192:195], v[176:179], v[16:19]
    v_mfma_f32_16x16x32_bf16 v[32:35], v[192:195], v[180:183], v[32:35]
    ds_read_b128 v[120:123], v12 offset:10240
    v_mfma_f32_16x16x32_bf16 v[48:51], v[192:195], v[184:187], v[48:51]
    ds_read_b128 v[124:127], v12 offset:11264
    v_mfma_f32_16x16x32_bf16 v[64:67], v[192:195], v[188:191], v[64:67]
    v_mfma_f32_16x16x32_bf16 v[20:23], v[196:199], v[176:179], v[20:23]
    v_mfma_f32_16x16x32_bf16 v[36:39], v[196:199], v[180:183], v[36:39]
    ds_read_b128 v[128:131], v10 offset:8192
    v_mfma_f32_16x16x32_bf16 v[52:55], v[196:199], v[184:187], v[52:55]
    ds_read_b128 v[132:135], v10 offset:9216
    v_mfma_f32_16x16x32_bf16 v[68:71], v[196:199], v[188:191], v[68:71]
    v_mfma_f32_16x16x32_bf16 v[24:27], v[200:203], v[176:179], v[24:27]
    ds_read_b128 v[136:139], v10 offset:10240
    v_mfma_f32_16x16x32_bf16 v[40:43], v[200:203], v[180:183], v[40:43]
    ds_read_b128 v[140:143], v10 offset:11264
    v_mfma_f32_16x16x32_bf16 v[56:59], v[200:203], v[184:187], v[56:59]
    v_mfma_f32_16x16x32_bf16 v[72:75], v[200:203], v[188:191], v[72:75]
    v_mfma_f32_16x16x32_bf16 v[28:31], v[204:207], v[176:179], v[28:31]
    v_mfma_f32_16x16x32_bf16 v[44:47], v[204:207], v[180:183], v[44:47]
    v_mfma_f32_16x16x32_bf16 v[60:63], v[204:207], v[184:187], v[60:63]
    v_mfma_f32_16x16x32_bf16 v[76:79], v[204:207], v[188:191], v[76:79]
    v_add_u32 v9, s15, v7
    v_add_u32 v10, s15, v8
    v_add_u32 v12, s15, v15
    s_add_u32 s15, s15, 32768
    s_cmp_eq_u32 s15, 131072
    s_cselect_b32 s15, 0, s15
    s_waitcnt lgkmcnt(0)
    s_barrier
    v_mfma_f32_16x16x32_bf16 v[16:19], v[96:99], v[80:83], v[16:19]
    ds_read_b128 v[144:147], v9 offset:0
    s_lshl_b32 s5, s5, 1
    v_mfma_f32_16x16x32_bf16 v[32:35], v[96:99], v[84:87], v[32:35]
    ds_read_b128 v[148:151], v9 offset:1024
    s_add_u32 s5, s5, s7
    v_mfma_f32_16x16x32_bf16 v[48:51], v[96:99], v[88:91], v[48:51]
    s_lshl_b32 s6, s6, 1
    v_mfma_f32_16x16x32_bf16 v[64:67], v[96:99], v[92:95], v[64:67]
    ds_read_b128 v[152:155], v12 offset:2048
    s_add_u32 s6, s6, s61
    v_mfma_f32_16x16x32_bf16 v[20:23], v[100:103], v[80:83], v[20:23]
    v_lshlrev_b32 v11, 2, v1
    v_mfma_f32_16x16x32_bf16 v[36:39], v[100:103], v[84:87], v[36:39]
    ds_read_b128 v[156:159], v12 offset:3072
    s_lshl_b32 s8, s5, 8
    v_mfma_f32_16x16x32_bf16 v[52:55], v[100:103], v[88:91], v[52:55]
    s_add_u32 s9, s8, 20480
    v_mfma_f32_16x16x32_bf16 v[68:71], v[100:103], v[92:95], v[68:71]
    ds_read_b128 v[160:163], v10 offset:0
    s_add_u32 s48, s42, s9
    v_mfma_f32_16x16x32_bf16 v[24:27], v[104:107], v[80:83], v[24:27]
    ds_read_b128 v[164:167], v10 offset:1024
    s_addc_u32 s49, s43, 0
    v_mfma_f32_16x16x32_bf16 v[40:43], v[104:107], v[84:87], v[40:43]
    global_load_dword v240, v11, s[48:49]
    v_mfma_f32_16x16x32_bf16 v[56:59], v[104:107], v[88:91], v[56:59]
    ds_read_b128 v[168:171], v10 offset:2048
    s_add_u32 s48, s48, 24576
    v_mfma_f32_16x16x32_bf16 v[72:75], v[104:107], v[92:95], v[72:75]
    s_addc_u32 s49, s49, 0
    v_mfma_f32_16x16x32_bf16 v[28:31], v[108:111], v[80:83], v[28:31]
    ds_read_b128 v[172:175], v10 offset:3072
    global_load_dword v241, v11, s[48:49]
    v_mfma_f32_16x16x32_bf16 v[44:47], v[108:111], v[84:87], v[44:47]
    s_add_u32 s48, s48, 24576
    v_mfma_f32_16x16x32_bf16 v[60:63], v[108:111], v[88:91], v[60:63]
    ds_read_b128 v[176:179], v9 offset:8192
    s_addc_u32 s49, s49, 0
    v_mfma_f32_16x16x32_bf16 v[76:79], v[108:111], v[92:95], v[76:79]
    ds_read_b128 v[180:183], v9 offset:9216
    global_load_dword v242, v11, s[48:49]
    v_mfma_f32_16x16x32_bf16 v[16:19], v[128:131], v[112:115], v[16:19]
    s_add_u32 s48, s48, 24576
    v_mfma_f32_16x16x32_bf16 v[32:35], v[128:131], v[116:119], v[32:35]
    ds_read_b128 v[184:187], v12 offset:10240
    s_addc_u32 s49, s49, 0
    v_mfma_f32_16x16x32_bf16 v[48:51], v[128:131], v[120:123], v[48:51]
    global_load_dword v243, v11, s[48:49]
    v_mfma_f32_16x16x32_bf16 v[64:67], v[128:131], v[124:127], v[64:67]
    ds_read_b128 v[188:191], v12 offset:11264
    s_lshl_b32 s8, s4, 4
    v_mfma_f32_16x16x32_bf16 v[20:23], v[132:135], v[112:115], v[20:23]
    s_add_u32 s8, s8, s5
    v_mfma_f32_16x16x32_bf16 v[36:39], v[132:135], v[116:119], v[36:39]
    ds_read_b128 v[192:195], v10 offset:8192
    s_lshl_b32 s8, s8, 2
    v_mfma_f32_16x16x32_bf16 v[52:55], v[132:135], v[120:123], v[52:55]
    ds_read_b128 v[196:199], v10 offset:9216
    s_add_u32 s8, s8, s6
    v_mfma_f32_16x16x32_bf16 v[68:71], v[132:135], v[124:127], v[68:71]
    s_lshl_b32 s8, s8, 12
    v_mfma_f32_16x16x32_bf16 v[24:27], v[136:139], v[112:115], v[24:27]
    ds_read_b128 v[200:203], v10 offset:10240
    s_add_u32 s8, s8, 14680064
    v_mfma_f32_16x16x32_bf16 v[40:43], v[136:139], v[116:119], v[40:43]
    s_add_u32 s48, s42, s8
    v_mfma_f32_16x16x32_bf16 v[56:59], v[136:139], v[120:123], v[56:59]
    ds_read_b128 v[204:207], v10 offset:11264
    s_addc_u32 s49, s43, 0
    v_mfma_f32_16x16x32_bf16 v[72:75], v[136:139], v[124:127], v[72:75]
    global_load_dwordx4 v[208:211], v2, s[48:49] offset:0 sc1
    v_mfma_f32_16x16x32_bf16 v[28:31], v[140:143], v[112:115], v[28:31]
    global_load_dwordx4 v[212:215], v2, s[48:49] offset:1024 sc1
    v_mfma_f32_16x16x32_bf16 v[44:47], v[140:143], v[116:119], v[44:47]
    global_load_dwordx4 v[216:219], v2, s[48:49] offset:2048 sc1
    v_mfma_f32_16x16x32_bf16 v[60:63], v[140:143], v[120:123], v[60:63]
    global_load_dwordx4 v[220:223], v2, s[48:49] offset:3072 sc1
    v_mfma_f32_16x16x32_bf16 v[76:79], v[140:143], v[124:127], v[76:79]
    v_add_u32 v9, s15, v7
    v_add_u32 v10, s15, v8
    v_add_u32 v12, s15, v15
    s_add_u32 s15, s15, 32768
    s_cmp_eq_u32 s15, 131072
    s_cselect_b32 s15, 0, s15
    s_waitcnt lgkmcnt(0)
    s_barrier
    v_mfma_f32_16x16x32_bf16 v[16:19], v[160:163], v[144:147], v[16:19]
    ds_read_b128 v[80:83], v9 offset:0
    s_waitcnt vmcnt(0)
    v_mfma_f32_16x16x32_bf16 v[32:35], v[160:163], v[148:151], v[32:35]
    ds_read_b128 v[84:87], v9 offset:1024
    v_add_f32 v240, v240, v241
    v_mfma_f32_16x16x32_bf16 v[48:51], v[160:163], v[152:155], v[48:51]
    v_add_f32 v242, v242, v243
    v_mfma_f32_16x16x32_bf16 v[64:67], v[160:163], v[156:159], v[64:67]
    ds_read_b128 v[88:91], v12 offset:2048
    s_lshl_b32 s8, s3, 9
    v_mfma_f32_16x16x32_bf16 v[20:23], v[164:167], v[144:147], v[20:23]
    s_add_u32 s8, s8, 131072
    v_mfma_f32_16x16x32_bf16 v[36:39], v[164:167], v[148:151], v[36:39]
    ds_read_b128 v[92:95], v12 offset:3072
    v_add_f32 v240, v240, v242
    v_mfma_f32_16x16x32_bf16 v[52:55], v[164:167], v[152:155], v[52:55]
    v_add_u32 v11, s8, v11
    v_mfma_f32_16x16x32_bf16 v[68:71], v[164:167], v[156:159], v[68:71]
    ds_read_b128 v[96:99], v10 offset:0
    v_cvt_pk_bf16_f32 v240, v240, v240
    v_mfma_f32_16x16x32_bf16 v[24:27], v[168:171], v[144:147], v[24:27]
    ds_read_b128 v[100:103], v10 offset:1024
    v_lshlrev_b32 v240, 16, v240
    v_mfma_f32_16x16x32_bf16 v[40:43], v[168:171], v[148:151], v[40:43]
    ds_write_b32 v11, v240
    v_mfma_f32_16x16x32_bf16 v[56:59], v[168:171], v[152:155], v[56:59]
    ds_read_b128 v[104:107], v10 offset:2048
    v_lshlrev_b32 v13, 4, v4
    v_mfma_f32_16x16x32_bf16 v[72:75], v[168:171], v[156:159], v[72:75]
    v_add_u32 v13, s8, v13
    v_mfma_f32_16x16x32_bf16 v[28:31], v[172:175], v[144:147], v[28:31]
    ds_read_b128 v[108:111], v10 offset:3072
    s_lshl_b32 s8, s2, 2
    v_mfma_f32_16x16x32_bf16 v[44:47], v[172:175], v[148:151], v[44:47]
    s_add_u32 s8, s8, s3
    v_mfma_f32_16x16x32_bf16 v[60:63], v[172:175], v[152:155], v[60:63]
    ds_read_b128 v[112:115], v9 offset:8192
    s_lshl_b32 s8, s8, 13
    v_mfma_f32_16x16x32_bf16 v[76:79], v[172:175], v[156:159], v[76:79]
    ds_read_b128 v[116:119], v9 offset:9216
    s_add_u32 s8, s8, 63963136
    v_mfma_f32_16x16x32_bf16 v[16:19], v[192:195], v[176:179], v[16:19]
    s_add_u32 s50, s42, s8
    v_mfma_f32_16x16x32_bf16 v[32:35], v[192:195], v[180:183], v[32:35]
    ds_read_b128 v[120:123], v12 offset:10240
    s_addc_u32 s51, s43, 0
    v_mfma_f32_16x16x32_bf16 v[48:51], v[192:195], v[184:187], v[48:51]
    s_add_u32 s52, s50, 4096
    v_mfma_f32_16x16x32_bf16 v[64:67], v[192:195], v[188:191], v[64:67]
    ds_read_b128 v[124:127], v12 offset:11264
    s_addc_u32 s53, s51, 0
    v_mfma_f32_16x16x32_bf16 v[20:23], v[196:199], v[176:179], v[20:23]
    s_xor_b32 s8, s8, 0x8000
    v_mfma_f32_16x16x32_bf16 v[36:39], v[196:199], v[180:183], v[36:39]
    ds_read_b128 v[128:131], v10 offset:8192
    s_add_u32 s54, s42, s8
    v_mfma_f32_16x16x32_bf16 v[52:55], v[196:199], v[184:187], v[52:55]
    ds_read_b128 v[132:135], v10 offset:9216
    s_addc_u32 s55, s43, 0
    v_mfma_f32_16x16x32_bf16 v[68:71], v[196:199], v[188:191], v[68:71]
    s_add_u32 s56, s54, 4096
    v_mfma_f32_16x16x32_bf16 v[24:27], v[200:203], v[176:179], v[24:27]
    ds_read_b128 v[136:139], v10 offset:10240
    s_addc_u32 s57, s55, 0
    v_mfma_f32_16x16x32_bf16 v[40:43], v[200:203], v[180:183], v[40:43]
    s_lshl_b32 s8, s2, 6
    v_mfma_f32_16x16x32_bf16 v[56:59], v[200:203], v[184:187], v[56:59]
    ds_read_b128 v[140:143], v10 offset:11264
    s_add_u32 s8, s8, 655360
    v_mfma_f32_16x16x32_bf16 v[72:75], v[200:203], v[188:191], v[72:75]
    s_add_u32 s58, s42, s8
    v_mfma_f32_16x16x32_bf16 v[28:31], v[204:207], v[176:179], v[28:31]
    s_addc_u32 s59, s43, 0
    v_mfma_f32_16x16x32_bf16 v[44:47], v[204:207], v[180:183], v[44:47]
    v_mfma_f32_16x16x32_bf16 v[60:63], v[204:207], v[184:187], v[60:63]
    v_mfma_f32_16x16x32_bf16 v[76:79], v[204:207], v[188:191], v[76:79]
    v_add_u32 v9, s15, v7
    v_add_u32 v10, s15, v8
    v_add_u32 v12, s15, v15
    s_add_u32 s15, s15, 32768
    s_cmp_eq_u32 s15, 131072
    s_cselect_b32 s15, 0, s15
    s_waitcnt lgkmcnt(0)
    s_barrier
    v_mfma_f32_16x16x32_bf16 v[16:19], v[96:99], v[80:83], v[16:19]
    ds_read_b128 v[144:147], v9 offset:0
    v_mfma_f32_16x16x32_bf16 v[32:35], v[96:99], v[84:87], v[32:35]
    ds_read_b128 v[148:151], v9 offset:1024
    v_mfma_f32_16x16x32_bf16 v[48:51], v[96:99], v[88:91], v[48:51]
    v_mfma_f32_16x16x32_bf16 v[64:67], v[96:99], v[92:95], v[64:67]
    ds_read_b128 v[152:155], v12 offset:2048
    v_mfma_f32_16x16x32_bf16 v[20:23], v[100:103], v[80:83], v[20:23]
    v_mfma_f32_16x16x32_bf16 v[36:39], v[100:103], v[84:87], v[36:39]
    ds_read_b128 v[156:159], v12 offset:3072
    v_mfma_f32_16x16x32_bf16 v[52:55], v[100:103], v[88:91], v[52:55]
    v_mfma_f32_16x16x32_bf16 v[68:71], v[100:103], v[92:95], v[68:71]
    ds_read_b128 v[160:163], v10 offset:0
    v_mfma_f32_16x16x32_bf16 v[24:27], v[104:107], v[80:83], v[24:27]
    ds_read_b128 v[164:167], v10 offset:1024
    v_mfma_f32_16x16x32_bf16 v[40:43], v[104:107], v[84:87], v[40:43]
    v_mfma_f32_16x16x32_bf16 v[56:59], v[104:107], v[88:91], v[56:59]
    ds_read_b128 v[168:171], v10 offset:2048
    v_mfma_f32_16x16x32_bf16 v[72:75], v[104:107], v[92:95], v[72:75]
    v_mfma_f32_16x16x32_bf16 v[28:31], v[108:111], v[80:83], v[28:31]
    ds_read_b128 v[172:175], v10 offset:3072
    v_mfma_f32_16x16x32_bf16 v[44:47], v[108:111], v[84:87], v[44:47]
    v_mfma_f32_16x16x32_bf16 v[60:63], v[108:111], v[88:91], v[60:63]
    ds_read_b128 v[176:179], v9 offset:8192
    v_mfma_f32_16x16x32_bf16 v[76:79], v[108:111], v[92:95], v[76:79]
    ds_read_b128 v[180:183], v9 offset:9216
    v_mfma_f32_16x16x32_bf16 v[16:19], v[128:131], v[112:115], v[16:19]
    v_mfma_f32_16x16x32_bf16 v[32:35], v[128:131], v[116:119], v[32:35]
    ds_read_b128 v[184:187], v12 offset:10240
    v_mfma_f32_16x16x32_bf16 v[48:51], v[128:131], v[120:123], v[48:51]
    v_mfma_f32_16x16x32_bf16 v[64:67], v[128:131], v[124:127], v[64:67]
    ds_read_b128 v[188:191], v12 offset:11264
    v_mfma_f32_16x16x32_bf16 v[20:23], v[132:135], v[112:115], v[20:23]
    v_mfma_f32_16x16x32_bf16 v[36:39], v[132:135], v[116:119], v[36:39]
    ds_read_b128 v[192:195], v10 offset:8192
    v_mfma_f32_16x16x32_bf16 v[52:55], v[132:135], v[120:123], v[52:55]
    ds_read_b128 v[196:199], v10 offset:9216
    v_mfma_f32_16x16x32_bf16 v[68:71], v[132:135], v[124:127], v[68:71]
    v_mfma_f32_16x16x32_bf16 v[24:27], v[136:139], v[112:115], v[24:27]
    ds_read_b128 v[200:203], v10 offset:10240
    v_mfma_f32_16x16x32_bf16 v[40:43], v[136:139], v[116:119], v[40:43]
    v_mfma_f32_16x16x32_bf16 v[56:59], v[136:139], v[120:123], v[56:59]
    ds_read_b128 v[204:207], v10 offset:11264
    v_mfma_f32_16x16x32_bf16 v[72:75], v[136:139], v[124:127], v[72:75]
    v_mfma_f32_16x16x32_bf16 v[28:31], v[140:143], v[112:115], v[28:31]
    v_mfma_f32_16x16x32_bf16 v[44:47], v[140:143], v[116:119], v[44:47]
    v_mfma_f32_16x16x32_bf16 v[60:63], v[140:143], v[120:123], v[60:63]
    v_mfma_f32_16x16x32_bf16 v[76:79], v[140:143], v[124:127], v[76:79]
    s_waitcnt lgkmcnt(0)
    v_mfma_f32_16x16x32_bf16 v[16:19], v[160:163], v[144:147], v[16:19]
    v_mfma_f32_16x16x32_bf16 v[32:35], v[160:163], v[148:151], v[32:35]
    v_mfma_f32_16x16x32_bf16 v[48:51], v[160:163], v[152:155], v[48:51]
    v_mfma_f32_16x16x32_bf16 v[64:67], v[160:163], v[156:159], v[64:67]
    v_mfma_f32_16x16x32_bf16 v[20:23], v[164:167], v[144:147], v[20:23]
    v_mfma_f32_16x16x32_bf16 v[36:39], v[164:167], v[148:151], v[36:39]
    v_mfma_f32_16x16x32_bf16 v[52:55], v[164:167], v[152:155], v[52:55]
    v_mfma_f32_16x16x32_bf16 v[68:71], v[164:167], v[156:159], v[68:71]
    v_mfma_f32_16x16x32_bf16 v[24:27], v[168:171], v[144:147], v[24:27]
    v_mfma_f32_16x16x32_bf16 v[40:43], v[168:171], v[148:151], v[40:43]
    v_mfma_f32_16x16x32_bf16 v[56:59], v[168:171], v[152:155], v[56:59]
    v_mfma_f32_16x16x32_bf16 v[72:75], v[168:171], v[156:159], v[72:75]
    v_mfma_f32_16x16x32_bf16 v[28:31], v[172:175], v[144:147], v[28:31]
    v_mfma_f32_16x16x32_bf16 v[44:47], v[172:175], v[148:151], v[44:47]
    v_mfma_f32_16x16x32_bf16 v[60:63], v[172:175], v[152:155], v[60:63]
    v_mfma_f32_16x16x32_bf16 v[76:79], v[172:175], v[156:159], v[76:79]
    v_mfma_f32_16x16x32_bf16 v[16:19], v[192:195], v[176:179], v[16:19]
    v_mfma_f32_16x16x32_bf16 v[32:35], v[192:195], v[180:183], v[32:35]
    v_mfma_f32_16x16x32_bf16 v[48:51], v[192:195], v[184:187], v[48:51]
    v_mfma_f32_16x16x32_bf16 v[64:67], v[192:195], v[188:191], v[64:67]
    v_mfma_f32_16x16x32_bf16 v[20:23], v[196:199], v[176:179], v[20:23]
    v_mfma_f32_16x16x32_bf16 v[36:39], v[196:199], v[180:183], v[36:39]
    v_mfma_f32_16x16x32_bf16 v[52:55], v[196:199], v[184:187], v[52:55]
    v_mfma_f32_16x16x32_bf16 v[68:71], v[196:199], v[188:191], v[68:71]
    v_mfma_f32_16x16x32_bf16 v[24:27], v[200:203], v[176:179], v[24:27]
    v_mfma_f32_16x16x32_bf16 v[40:43], v[200:203], v[180:183], v[40:43]
    v_mfma_f32_16x16x32_bf16 v[56:59], v[200:203], v[184:187], v[56:59]
    v_mfma_f32_16x16x32_bf16 v[72:75], v[200:203], v[188:191], v[72:75]
    v_mfma_f32_16x16x32_bf16 v[28:31], v[204:207], v[176:179], v[28:31]
    v_mfma_f32_16x16x32_bf16 v[44:47], v[204:207], v[180:183], v[44:47]
    v_mfma_f32_16x16x32_bf16 v[60:63], v[204:207], v[184:187], v[60:63]
    v_mfma_f32_16x16x32_bf16 v[76:79], v[204:207], v[188:191], v[76:79]
    v_cvt_pk_bf16_f32 v144, v48, v49
    v_cvt_pk_bf16_f32 v145, v50, v51
    v_cvt_pk_bf16_f32 v146, v52, v53
    v_cvt_pk_bf16_f32 v147, v54, v55
    global_store_dwordx4 v2, v[144:147], s[50:51] offset:0 sc1
    v_cvt_pk_bf16_f32 v148, v56, v57
    v_cvt_pk_bf16_f32 v149, v58, v59
    v_cvt_pk_bf16_f32 v150, v60, v61
    v_cvt_pk_bf16_f32 v151, v62, v63
    global_store_dwordx4 v2, v[148:151], s[50:51] offset:1024 sc1
    v_cvt_pk_bf16_f32 v152, v64, v65
    v_cvt_pk_bf16_f32 v153, v66, v67
    v_cvt_pk_bf16_f32 v154, v68, v69
    v_cvt_pk_bf16_f32 v155, v70, v71
    global_store_dwordx4 v2, v[152:155], s[50:51] offset:2048 sc1
    v_cvt_pk_bf16_f32 v156, v72, v73
    v_cvt_pk_bf16_f32 v157, v74, v75
    v_cvt_pk_bf16_f32 v158, v76, v77
    v_cvt_pk_bf16_f32 v159, v78, v79
    global_store_dwordx4 v2, v[156:159], s[50:51] offset:3072 sc1
    ds_read_b128 v[224:227], v13 offset:0
    ds_read_b128 v[228:231], v13 offset:64
    ds_read_b128 v[232:235], v13 offset:128
    ds_read_b128 v[236:239], v13 offset:192
    s_lshl_b32 s8, s4, 18
    s_lshl_b32 s9, s6, 16
    s_add_u32 s8, s8, s9
    s_lshl_b32 s9, s5, 7
    s_add_u32 s8, s8, s9
    s_add_u32 s48, s38, s8
    s_addc_u32 s49, s39, 0
    v_and_b32 v11, 1, v4
    v_lshlrev_b32 v11, 5, v11
    v_lshrrev_b32 v12, 1, v4
    v_lshl_add_u32 v11, v12, 4, v11
    v_lshl_add_u32 v11, v3, 11, v11
    v_lshlrev_b32 v80, 16, v208
    v_and_b32 v81, 0xffff0000, v208
    v_lshlrev_b32 v82, 16, v209
    v_and_b32 v83, 0xffff0000, v209
    v_lshlrev_b32 v84, 16, v210
    v_and_b32 v85, 0xffff0000, v210
    v_lshlrev_b32 v86, 16, v211
    v_and_b32 v87, 0xffff0000, v211
    v_lshlrev_b32 v88, 16, v212
    v_and_b32 v89, 0xffff0000, v212
    v_lshlrev_b32 v90, 16, v213
    v_and_b32 v91, 0xffff0000, v213
    v_lshlrev_b32 v92, 16, v214
    v_and_b32 v93, 0xffff0000, v214
    v_lshlrev_b32 v94, 16, v215
    v_and_b32 v95, 0xffff0000, v215
    v_lshlrev_b32 v112, 16, v216
    v_and_b32 v113, 0xffff0000, v216
    v_lshlrev_b32 v114, 16, v217
    v_and_b32 v115, 0xffff0000, v217
    v_lshlrev_b32 v116, 16, v218
    v_and_b32 v117, 0xffff0000, v218
    v_lshlrev_b32 v118, 16, v219
    v_and_b32 v119, 0xffff0000, v219
    v_lshlrev_b32 v120, 16, v220
    v_and_b32 v121, 0xffff0000, v220
    v_lshlrev_b32 v122, 16, v221
    v_and_b32 v123, 0xffff0000, v221
    v_lshlrev_b32 v124, 16, v222
    v_and_b32 v125, 0xffff0000, v222
    v_lshlrev_b32 v126, 16, v223
    v_and_b32 v127, 0xffff0000, v223
    s_and_b32 s8, s2, 1
    s_lshl_b32 s8, s8, 7
    s_sub_u32 s8, 64, s8
    v_mov_b32 v12, 0
    v_mov_b32 v13, 1
    v_mov_b32 v14, s8
    s_waitcnt vmcnt(0)
    s_barrier
    s_cmp_lg_u32 s3, 0
    s_cbranch_scc1 down2_wait
    s_mov_b64 exec, 1
    global_store_dword v12, v13, s[58:59] sc1
    v_ashrrev_i32 v15, 31, v14
    v_mov_b32 v9, s58
    v_mov_b32 v10, s59
    v_add_co_u32 v14, vcc, v9, v14
    s_nop 1
    v_addc_co_u32 v15, vcc, v10, v15, vcc
    s_mov_b32 s11, 131072
down2_poll:
    s_sub_u32 s11, s11, 1
    s_cbranch_scc1 ffn_kernel_end
    global_load_dword v13, v[14:15], off sc1
    s_waitcnt vmcnt(0)
    v_cmp_eq_u32 vcc, 1, v13
    s_nop 4
    s_cbranch_vccz down2_poll
    s_mov_b64 exec, -1
down2_wait:
    s_barrier
    global_load_dwordx4 v[160:163], v2, s[54:55] offset:0 sc1
    global_load_dwordx4 v[164:167], v2, s[54:55] offset:1024 sc1
    global_load_dwordx4 v[168:171], v2, s[54:55] offset:2048 sc1
    global_load_dwordx4 v[172:175], v2, s[54:55] offset:3072 sc1
    s_waitcnt lgkmcnt(0)
    s_waitcnt vmcnt(2)
    v_lshlrev_b32 v48, 16, v160
    v_and_b32 v49, 0xffff0000, v160
    v_lshlrev_b32 v50, 16, v161
    v_and_b32 v51, 0xffff0000, v161
    v_lshlrev_b32 v52, 16, v162
    v_and_b32 v53, 0xffff0000, v162
    v_lshlrev_b32 v54, 16, v163
    v_and_b32 v55, 0xffff0000, v163
    v_lshlrev_b32 v56, 16, v164
    v_and_b32 v57, 0xffff0000, v164
    v_lshlrev_b32 v58, 16, v165
    v_and_b32 v59, 0xffff0000, v165
    v_lshlrev_b32 v60, 16, v166
    v_and_b32 v61, 0xffff0000, v166
    v_lshlrev_b32 v62, 16, v167
    v_and_b32 v63, 0xffff0000, v167
    v_pk_add_f32 v[16:17], v[16:17], v[48:49]
    v_pk_add_f32 v[18:19], v[18:19], v[50:51]
    v_pk_add_f32 v[20:21], v[20:21], v[52:53]
    v_pk_add_f32 v[22:23], v[22:23], v[54:55]
    v_pk_add_f32 v[24:25], v[24:25], v[56:57]
    v_pk_add_f32 v[26:27], v[26:27], v[58:59]
    v_pk_add_f32 v[28:29], v[28:29], v[60:61]
    v_pk_add_f32 v[30:31], v[30:31], v[62:63]
    v_pk_fma_f32 v[80:81], v[224:225], v[16:17], v[80:81]
    v_pk_fma_f32 v[82:83], v[226:227], v[18:19], v[82:83]
    v_pk_fma_f32 v[84:85], v[228:229], v[20:21], v[84:85]
    v_pk_fma_f32 v[86:87], v[230:231], v[22:23], v[86:87]
    v_pk_fma_f32 v[88:89], v[232:233], v[24:25], v[88:89]
    v_pk_fma_f32 v[90:91], v[234:235], v[26:27], v[90:91]
    v_pk_fma_f32 v[92:93], v[236:237], v[28:29], v[92:93]
    v_pk_fma_f32 v[94:95], v[238:239], v[30:31], v[94:95]
    v_cvt_pk_bf16_f32 v96, v80, v81
    v_cvt_pk_bf16_f32 v97, v82, v83
    v_cvt_pk_bf16_f32 v98, v84, v85
    v_cvt_pk_bf16_f32 v99, v86, v87
    v_cvt_pk_bf16_f32 v100, v88, v89
    v_cvt_pk_bf16_f32 v101, v90, v91
    v_cvt_pk_bf16_f32 v102, v92, v93
    v_cvt_pk_bf16_f32 v103, v94, v95
    v_permlane16_swap_b32 v96, v98
    v_permlane16_swap_b32 v97, v99
    global_store_dwordx4 v11, v[96:99], s[48:49] offset:0 sc1
    v_permlane16_swap_b32 v100, v102
    v_permlane16_swap_b32 v101, v103
    global_store_dwordx4 v11, v[100:103], s[48:49] offset:64 sc1
    s_add_u32 s48, s48, 32768
    s_addc_u32 s49, s49, 0
    s_waitcnt vmcnt(2)
    v_lshlrev_b32 v64, 16, v168
    v_and_b32 v65, 0xffff0000, v168
    v_lshlrev_b32 v66, 16, v169
    v_and_b32 v67, 0xffff0000, v169
    v_lshlrev_b32 v68, 16, v170
    v_and_b32 v69, 0xffff0000, v170
    v_lshlrev_b32 v70, 16, v171
    v_and_b32 v71, 0xffff0000, v171
    v_lshlrev_b32 v72, 16, v172
    v_and_b32 v73, 0xffff0000, v172
    v_lshlrev_b32 v74, 16, v173
    v_and_b32 v75, 0xffff0000, v173
    v_lshlrev_b32 v76, 16, v174
    v_and_b32 v77, 0xffff0000, v174
    v_lshlrev_b32 v78, 16, v175
    v_and_b32 v79, 0xffff0000, v175
    v_pk_add_f32 v[32:33], v[32:33], v[64:65]
    v_pk_add_f32 v[34:35], v[34:35], v[66:67]
    v_pk_add_f32 v[36:37], v[36:37], v[68:69]
    v_pk_add_f32 v[38:39], v[38:39], v[70:71]
    v_pk_add_f32 v[40:41], v[40:41], v[72:73]
    v_pk_add_f32 v[42:43], v[42:43], v[74:75]
    v_pk_add_f32 v[44:45], v[44:45], v[76:77]
    v_pk_add_f32 v[46:47], v[46:47], v[78:79]
    v_pk_fma_f32 v[112:113], v[224:225], v[32:33], v[112:113]
    v_pk_fma_f32 v[114:115], v[226:227], v[34:35], v[114:115]
    v_pk_fma_f32 v[116:117], v[228:229], v[36:37], v[116:117]
    v_pk_fma_f32 v[118:119], v[230:231], v[38:39], v[118:119]
    v_pk_fma_f32 v[120:121], v[232:233], v[40:41], v[120:121]
    v_pk_fma_f32 v[122:123], v[234:235], v[42:43], v[122:123]
    v_pk_fma_f32 v[124:125], v[236:237], v[44:45], v[124:125]
    v_pk_fma_f32 v[126:127], v[238:239], v[46:47], v[126:127]
    v_cvt_pk_bf16_f32 v128, v112, v113
    v_cvt_pk_bf16_f32 v129, v114, v115
    v_cvt_pk_bf16_f32 v130, v116, v117
    v_cvt_pk_bf16_f32 v131, v118, v119
    v_cvt_pk_bf16_f32 v132, v120, v121
    v_cvt_pk_bf16_f32 v133, v122, v123
    v_cvt_pk_bf16_f32 v134, v124, v125
    v_cvt_pk_bf16_f32 v135, v126, v127
    v_permlane16_swap_b32 v128, v130
    v_permlane16_swap_b32 v129, v131
    global_store_dwordx4 v11, v[128:131], s[48:49] offset:0 sc1
    v_permlane16_swap_b32 v132, v134
    v_permlane16_swap_b32 v133, v135
    global_store_dwordx4 v11, v[132:135], s[48:49] offset:64 sc1
ffn_kernel_end:
    s_endpgm
code_end:
    s_endpgm
.section .rodata,"a"
.p2align 6
.amdhsa_kernel prep_kernel
  .amdhsa_next_free_vgpr 96
  .amdhsa_next_free_sgpr 100
  .amdhsa_accum_offset 96
  .amdhsa_group_segment_fixed_size 0
  .amdhsa_kernarg_size 112
  .amdhsa_user_sgpr_count 2
  .amdhsa_user_sgpr_kernarg_segment_ptr 1
  .amdhsa_system_sgpr_workgroup_id_x 1
.end_amdhsa_kernel
.p2align 6
.amdhsa_kernel qkv_kernel
  .amdhsa_next_free_vgpr 512
  .amdhsa_next_free_sgpr 100
  .amdhsa_accum_offset 256
  .amdhsa_group_segment_fixed_size 0
  .amdhsa_kernarg_size 112
  .amdhsa_user_sgpr_count 2
  .amdhsa_user_sgpr_kernarg_segment_ptr 1
  .amdhsa_system_sgpr_workgroup_id_x 1
.end_amdhsa_kernel
.p2align 6
.amdhsa_kernel attn_kernel
  .amdhsa_next_free_vgpr 160
  .amdhsa_next_free_sgpr 100
  .amdhsa_accum_offset 160
  .amdhsa_group_segment_fixed_size 0
  .amdhsa_kernarg_size 112
  .amdhsa_user_sgpr_count 2
  .amdhsa_user_sgpr_kernarg_segment_ptr 1
  .amdhsa_system_sgpr_workgroup_id_x 1
.end_amdhsa_kernel
.p2align 6
.amdhsa_kernel ffn_kernel
  .amdhsa_next_free_vgpr 248
  .amdhsa_next_free_sgpr 100
  .amdhsa_accum_offset 248
  .amdhsa_group_segment_fixed_size 0
  .amdhsa_kernarg_size 112
  .amdhsa_user_sgpr_count 2
  .amdhsa_user_sgpr_kernarg_segment_ptr 1
  .amdhsa_system_sgpr_workgroup_id_x 1
.end_amdhsa_kernel
```
